```python
import torch

def _softmax(x, axis=-1):
    return torch.softmax(x, dim=axis)
def _gelu(x):
    return torch.nn.functional.gelu(x, approximate="tanh")
def _silu(x):
    return torch.nn.functional.silu(x)
def _sigmoid(x):
    return torch.sigmoid(x)
def _layernorm(x, axis=-1, eps=1e-5):
    m = x.mean(dim=axis, keepdim=True)
    v = x.var(dim=axis, keepdim=True, unbiased=False)
    return (x - m) / torch.sqrt(v + eps)
def _scatter_add(tgt, idx, src, axis=0):
    return tgt.clone().index_add_(axis, idx, src)
def _segment_sum(src, seg, n):
    out = torch.zeros((n,) + src.shape[1:], dtype=src.dtype)
    return out.index_add_(0, seg, src)
def _pad(x, pw):
    flat = tuple(v for pair in reversed(pw) for v in pair)
    return torch.nn.functional.pad(x, flat)

kernel_name = 'parallel_sum__linear_kernel_hedgehog__dense_activation_squared_relu__prompt'

def setup_inputs():

    _w = (lambda a: (lambda t: t.to(torch.bfloat16) if t.is_floating_point() else t)(torch.as_tensor(a)))
    def _A_setup():
        B, S, D, H = 1, 2048, 1024, 32
        Dh = D // H
        return {
            "x": _w((lambda *s: torch.randn(*s, dtype=torch.bfloat16) * 0.05)(B, S, D)),
            "wqkv": _w((lambda *s: torch.randn(*s, dtype=torch.bfloat16) * 0.8)(D, 3 * D)),
            "w_phi": _w((lambda *s: torch.randn(*s, dtype=torch.bfloat16) * 0.8)(H, Dh, Dh) * (Dh ** -0.5)),
            "wo": _w((lambda *s: torch.randn(*s, dtype=torch.bfloat16) * 0.2)(D, D)),
        }
    _A_in = _A_setup()

    def _B_setup():
        B, S, D, F = 1, 2048, 1024, 3584
        return {
            "x": _w((lambda *s: torch.randn(*s, dtype=torch.bfloat16) * 0.05)(B, S, D)),
            "w1": _w((lambda *s: torch.randn(*s, dtype=torch.bfloat16) * 0.05)(D, F)),
            "b1": _w((lambda *s: torch.randn(*s, dtype=torch.bfloat16) * 1.6)(F)),
            "w2": _w((lambda *s: torch.randn(*s, dtype=torch.bfloat16) * 0.05)(F, D)),
            "b2": _w((lambda *s: torch.randn(*s, dtype=torch.bfloat16) * 12.8)(D)),
        }
    _B_in = _B_setup()

    return {
        "A_x": _A_in["x"],
        "A_wqkv": _A_in["wqkv"],
        "A_w_phi": _A_in["w_phi"],
        "A_wo": _A_in["wo"],
        "B_x": _B_in["x"],
        "B_w1": _B_in["w1"],
        "B_b1": _B_in["b1"],
        "B_w2": _B_in["w2"],
        "B_b2": _B_in["b2"],
    }

def reference(A_x, A_wqkv, A_w_phi, A_wo, B_x, B_w1, B_b1, B_w2, B_b2):
    def _A_ref(x, wqkv, w_phi, wo):
        B, S, D = x.shape
        H = 32; Dh = D // H
        qkv = (lambda x, *d: x.permute(*d))((x @ wqkv).reshape(B, S, 3, H, Dh), 2, 0, 3, 1, 4)
        q, k, v = qkv[0], qkv[1], qkv[2]
        pq = torch.einsum("bhsd,hdf->bhsf", q, w_phi)
        pk = torch.einsum("bhsd,hdf->bhsf", k, w_phi)
        phi_q = torch.concatenate([_softmax(pq, axis=-1), _softmax(-pq, axis=-1)], axis=-1)
        phi_k = torch.concatenate([_softmax(pk, axis=-1), _softmax(-pk, axis=-1)], axis=-1)
        kv = torch.einsum("bhsf,bhsd->bhfd", phi_k, v)
        z  = torch.einsum("bhsf->bhf", phi_k)
        num = torch.einsum("bhqf,bhfd->bhqd", phi_q, kv)
        den = torch.einsum("bhqf,bhf->bhq", phi_q, z)[..., None] + 1e-6
        o = num / den
        return (lambda x, *d: x.permute(*d))(o, 0, 2, 1, 3).reshape(B, S, D) @ wo

    def _B_ref(x, w1, b1, w2, b2):
        h = torch.einsum("bsd,df->bsf", x, w1) + b1
        zero = torch.zeros_like(h)
        r = torch.where(h > zero, h, zero)
        h = r * r
        out = torch.einsum("bsf,fd->bsd", h, w2) + b2
        return out

    x = A_x
    xn = _layernorm(x, axis=-1)
    return x + _A_ref(xn, A_wqkv, A_w_phi, A_wo) + _B_ref(xn, B_w1, B_b1, B_w2, B_b2)
```

```asm
; @launch grid=(256,1,1) block=(512,1,1) lds=163840
.amdgcn_target "amdgcn-amd-amdhsa--gfx950"
.text
.globl parallel_sum__linear_kernel_hedgehog__dense_activation_squared_relu__prompt_kernel
.p2align 8
.type parallel_sum__linear_kernel_hedgehog__dense_activation_squared_relu__prompt_kernel,@function
parallel_sum__linear_kernel_hedgehog__dense_activation_squared_relu__prompt_kernel:
  s_cmp_ge_u32 s2, 256
  s_cbranch_scc1 L1_end
  s_load_dwordx2 s[8:9], s[0:1], 88
  s_load_dwordx2 s[4:5], s[0:1], 8
  s_load_dwordx2 s[6:7], s[0:1], 40
  s_load_dwordx2 s[10:11], s[0:1], 16
  s_load_dwordx2 s[12:13], s[0:1], 48
  s_load_dwordx2 s[14:15], s[0:1], 56
  s_load_dwordx2 s[60:61], s[0:1], 24
  s_load_dwordx2 s[62:63], s[0:1], 0
  s_load_dwordx2 s[64:65], s[0:1], 64
  s_load_dwordx2 s[66:67], s[0:1], 72
  s_load_dwordx2 s[76:77], s[0:1], 80
  v_lshrrev_b32 v36, 6, v0
  v_and_b32 v1, 63, v0
  v_readfirstlane_b32 s36, v36
  s_and_b32 s46, s2, 7
  s_lshr_b32 s47, s2, 3
  s_lshr_b32 s37, s46, 0
  s_lshl_b32 s37, s37, 2
  s_lshr_b32 s48, s47, 3
  s_add_u32 s37, s37, s48
  s_and_b32 s38, s46, 0
  s_lshl_b32 s38, s38, 3
  s_and_b32 s48, s47, 7
  s_add_u32 s38, s38, s48
  s_mov_b32 s95, s2
  v_lshlrev_b32 v2, 4, v1
  s_lshr_b32 s48, s36, 1
  s_mul_i32 s48, s48, 1
  s_add_u32 s48, s48, 14
  v_lshrrev_b32 v31, 3, v1
  v_add_u32 v31, s48, v31
  v_and_b32 v32, 7, v1
  v_lshl_add_u32 v33, v31, 5, s47
  s_and_b32 s48, s36, 1
  s_cmp_eq_u32 s48, 0
  s_cbranch_scc0 L1_pfw1
  v_mul_u32_u24 v28, 6144, v33
  v_lshrrev_b32 v34, 1, v32
  v_lshl_add_u32 v28, v34, 11, v28
  v_and_b32 v34, 1, v32
  v_lshl_add_u32 v28, v34, 7, v28
  s_lshl_b32 s48, s46, 8
  v_add_u32 v28, s48, v28
  s_mov_b32 s82, 6291456
  s_mov_b32 s48, 6
  s_mov_b32 s85, 786432
  s_mov_b32 s86, 196608
  s_branch L1_pfj
L1_pfw1:
  v_mul_u32_u24 v28, 7168, v33
  s_mul_i32 s48, s46, 768
  v_lshl_add_u32 v34, v32, 7, s48
  s_lshl_b32 s48, s46, 7
  s_add_u32 s48, s48, 6144
  v_mov_b32 v35, s48
  v_cmp_gt_u32 vcc, 6, v32
  s_nop 1
  v_cndmask_b32 v34, v35, v34, vcc
  v_add_u32 v28, v28, v34
  s_mov_b32 s82, 7340032
  s_mov_b32 s48, 7
  s_mov_b32 s85, 917504
  s_mov_b32 s86, 229376
L1_pfj:
  s_mov_b32 s83, 0x20000
  v_mov_b32 v35, 2130706432
  v_cmp_gt_u32 vcc, s48, v32
  s_nop 1
  v_cndmask_b32 v28, v35, v28, vcc
  v_mov_b32 v29, v28
  v_cmp_gt_u32 vcc, 8, v1
  s_mov_b32 s84, 0
  s_nop 0
  v_cndmask_b32 v28, v35, v28, vcc
  s_mul_i32 s48, s86, 16
  v_subrev_u32 v29, s48, v29
  s_lshr_b32 s48, s36, 1
  s_cmp_eq_u32 s48, 2
  s_cselect_b32 s48, 56, 0
  v_cmp_gt_u32 vcc, s48, v1
  s_mul_i32 s87, s86, 7
  v_mov_b32 v30, 2130706432
  v_cndmask_b32 v29, v30, v29, vcc
  s_lshl_b32 s48, s95, 3
  s_add_u32 s48, s48, s36
  s_lshl_b32 s48, s48, 11
  s_mov_b32 s34, 4194304
  s_mov_b32 s35, 0x20000
  s_mov_b32 s78, 256
  s_mov_b32 s79, 0x20000
  s_mov_b32 s30, 50331648
  s_mov_b32 s31, 0x20000
  s_cmp_eq_u32 s36, 6
  s_cselect_b32 s49, 16, 0
  v_mov_b32 v160, 0
  v_mov_b32 v161, 0
  v_mov_b32 v162, 0
  v_mov_b32 v163, 0
  s_cmp_eq_u32 s46, 1
  s_cselect_b32 s94, s47, 255
  s_lshl_b32 s50, s94, 12
  s_add_u32 s50, s50, 29360128
  s_lshl_b32 s69, s94, 2
  s_cmp_lt_u32 s94, s49
  s_cselect_b32 s69, s69, 2130706432
  s_waitcnt lgkmcnt(0)
  s_mov_b32 s32, s62
  s_mov_b32 s33, s63
  s_mov_b32 s28, s8
  s_mov_b32 s29, s9
  s_cbranch_scc0 L1_nz
  buffer_store_dwordx4 v[160:163], v2, s[28:31], s50 offen sc1
  buffer_store_dwordx4 v[160:163], v2, s[28:31], s50 offen offset:1024 sc1
  buffer_store_dwordx4 v[160:163], v2, s[28:31], s50 offen offset:2048 sc1
  buffer_store_dwordx4 v[160:163], v2, s[28:31], s50 offen offset:3072 sc1
L1_nz:
  buffer_load_dword v30, v30, s[28:31], 0 offen
  buffer_load_dwordx4 v[152:155], v2, s[32:35], s48 offen
  buffer_load_dwordx4 v[156:159], v2, s[32:35], s48 offen offset:1024
  s_getpc_b64 s[100:101]
L1_pc:
  s_lshl_b32 s48, s47, 3
  s_add_u32 s48, s48, s36
  s_lshl_b32 s48, s48, 7
  v_and_b32 v31, 1, v1
  v_lshl_add_u32 v31, v31, 6, s48
  global_load_dword v30, v31, s[100:101]
  v_mov_b32 v176, 0
  v_mov_b32 v210, 131072
  ds_write_b32 v210, v176
  v_lshrrev_b32 v209, 2, v1
  v_and_b32 v210, 1, v1
  v_lshl_add_u32 v209, v209, 1, v210
  v_add_u32 v210, s36, v209
  v_and_b32 v210, 7, v210
  v_lshlrev_b32 v209, 8, v209
  v_lshl_add_u32 v209, v210, 4, v209
  v_bfe_u32 v210, v1, 1, 1
  v_lshl_add_u32 v209, v210, 3, v209
  v_add_u32 v216, 114688, v209
  v_lshrrev_b32 v209, 4, v1
  v_add_u32 v209, v209, v1
  v_and_b32 v209, 7, v209
  v_lshrrev_b32 v210, 3, v1
  v_lshlrev_b32 v211, 7, v210
  v_lshl_add_u32 v209, v209, 4, v211
  s_lshl_b32 s48, s36, 12
  s_add_u32 s48, s48, 114688
  v_add_u32 v217, s48, v209
  v_xor_b32 v218, 64, v217
  v_lshrrev_b32 v209, 5, v1
  v_and_b32 v210, 3, v210
  v_lshlrev_b32 v209, 11, v209
  v_lshl_add_u32 v209, v210, 8, v209
  v_and_b32 v210, 7, v1
  v_lshl_add_u32 v219, v210, 4, v209
  s_lshr_b32 s70, s95, 2
  s_lshl_b32 s70, s70, 16
  s_and_b32 s48, s95, 2
  s_lshl_b32 s48, s48, 9
  s_add_u32 s70, s70, s48
  s_and_b32 s48, s95, 1
  s_lshl_b32 s48, s48, 7
  s_add_u32 s70, s70, s48
  s_lshl_b32 s48, s36, 14
  s_add_u32 s70, s70, s48
  s_mov_b32 s71, 0xffff0000
  s_bitcmp0_b32 s36, 0
  s_cselect_b32 s80, s4, s6
  s_cselect_b32 s81, s5, s7
  s_lshl_b32 s39, s38, 3
  s_add_u32 s39, s39, s36
  s_lshl_b32 s40, s36, 10
  s_lshl_b32 s48, s36, 6
  v_add_u32 v36, s48, v1
  v_mul_u32_u24 v37, 5462, v36
  v_lshrrev_b32 v37, 16, v37
  v_mul_u32_u24 v38, 12, v37
  v_sub_u32 v38, v36, v38
  v_bfe_u32 v39, v37, 2, 1
  v_lshlrev_b32 v39, 1, v39
  v_xor_b32 v38, v38, v39
  v_mul_u32_u24 v3, 6144, v37
  v_lshrrev_b32 v39, 2, v38
  v_lshl_add_u32 v3, v39, 11, v3
  v_and_b32 v39, 3, v38
  v_lshl_add_u32 v3, v39, 4, v3
  s_lshl_b32 s48, s37, 6
  v_add_u32 v3, s48, v3
  s_mul_i32 s49, s37, 192
  s_lshl_b32 s50, s37, 5
  s_add_u32 s50, s50, 5952
  s_lshl_b32 s48, s36, 6
  v_add_u32 v36, s48, v1
  v_mul_u32_u24 v37, 4682, v36
  v_lshrrev_b32 v37, 16, v37
  v_mul_u32_u24 v38, 14, v37
  v_sub_u32 v38, v36, v38
  v_mul_u32_u24 v4, 7168, v37
  v_lshl_add_u32 v4, v38, 4, v4
  v_mov_b32 v39, s49
  v_mov_b32 v40, s50
  v_cmp_gt_u32 vcc, 12, v38
  s_nop 1
  v_cndmask_b32 v39, v40, v39, vcc
  v_add_u32 v4, v4, v39
  s_cmp_lt_u32 s36, 6
  s_cbranch_scc1 L1_dok
  v_mov_b32 v3, v4
  v_mov_b32 v4, 2130706432
  s_cmp_eq_u32 s36, 6
  s_cbranch_scc1 L1_dok
  v_mov_b32 v3, 2130706432
L1_dok:
  v_lshrrev_b32 v36, 2, v1
  v_and_b32 v37, 3, v1
  v_lshlrev_b32 v37, 3, v37
  v_mul_u32_u24 v7, 224, v36
  v_add_u32 v7, v7, v37
  v_add_u32 v7, 6144, v7
  v_mul_u32_u24 v5, 192, v36
  v_add_u32 v5, v5, v37
  v_bfe_u32 v38, v1, 4, 1
  v_lshlrev_b32 v38, 5, v38
  v_sub_u32 v6, v5, v38
  v_add_u32 v5, v5, v38
  v_add_u32 v8, 57344, v5
  v_add_u32 v9, 57344, v6
  v_add_u32 v10, 57344, v7
  v_lshl_add_u32 v11, v36, 6, v37
  v_add_u32 v11, 161792, v11
  v_lshrrev_b32 v12, 4, v1
  v_lshlrev_b32 v12, 3, v12
  s_mov_b32 s18, 65536
  s_mov_b32 s19, 0x20000
  s_mov_b32 s23, 0x20000
  s_mov_b32 s27, 0x20000
  s_lshl_b32 s48, s39, 16
  s_mov_b32 s41, 0
  s_waitcnt lgkmcnt(0)
  s_add_u32 s16, s8, s48
  s_addc_u32 s17, s9, 0
  s_cmp_lg_u32 s36, 6
  s_cselect_b32 s20, s4, s6
  s_cselect_b32 s21, s5, s7
  s_mov_b32 s22, 7340032
  s_cselect_b32 s22, 6291456, s22
  s_mov_b32 s45, 229376
  s_cselect_b32 s45, 196608, s45
  s_cselect_b32 s68, s40, 12288
  s_mov_b32 s24, s6
  s_mov_b32 s25, s7
  s_mov_b32 s26, 7340032
  s_mov_b32 s51, 229376
  s_add_u32 s44, s40, 6144
  s_cmp_lt_u32 s36, 6
  s_cselect_b32 s44, s44, 13312
  s_sub_u32 s42, 0, s45
  s_sub_u32 s43, 0, s51
  s_cmp_eq_u32 s36, 7
  s_cselect_b32 s68, 13312, s68
  s_mov_b32 s32, s10
  s_mov_b32 s33, s11
  s_mov_b32 s34, 65536
  s_mov_b32 s35, 0x20000
  s_mov_b32 s52, s12
  s_mov_b32 s53, s13
  s_mov_b32 s54, 7168
  s_mov_b32 s55, 0x20000
  s_and_b32 s49, s36, 1
  s_lshl_b32 s49, s49, 10
  s_add_u32 s58, s49, 161792
  s_lshl_b32 s59, s37, 11
  s_add_u32 s59, s59, s49
  s_mul_i32 s56, s37, 192
  s_lshl_b32 s57, s37, 5
  s_add_u32 s57, s57, 6144
  s_mov_b32 s88, s64
  s_mov_b32 s89, s65
  s_mov_b32 s90, 2048
  s_mov_b32 s91, 0x20000
  s_lshl_b32 s49, s37, 11
  s_cmp_eq_u32 s36, 6
  s_cselect_b32 s48, 0, 2130706432
  s_cselect_b32 s49, s49, 2130706432
  v_lshlrev_b32 v209, 7, v1
  v_lshlrev_b32 v210, 5, v1
  buffer_load_dword v30, v210, s[32:35], s49 offen
  buffer_load_dword v30, v209, s[52:55], s48 offen
  buffer_load_dword v30, v209, s[88:91], s48 offen
  v_mov_b32 v164, 1
  v_lshlrev_b32 v160, 6, v1
  s_mov_b64 exec, 15
  s_waitcnt vmcnt(6)
  buffer_store_dword v164, v160, s[76:79], s69 offen sc1
  s_mov_b64 exec, -1
  s_waitcnt vmcnt(5)
  s_mul_i32 s48, s87, 0
  buffer_load_dword v30, v29, s[80:83], s48 offen
  v_lshlrev_b32 v160, 16, v152
  v_and_b32 v161, s71, v152
  v_lshlrev_b32 v162, 16, v153
  v_and_b32 v163, s71, v153
  v_lshlrev_b32 v164, 16, v154
  v_and_b32 v165, s71, v154
  v_lshlrev_b32 v166, 16, v155
  v_and_b32 v167, s71, v155
  v_lshlrev_b32 v168, 16, v156
  v_and_b32 v169, s71, v156
  v_lshlrev_b32 v170, 16, v157
  v_and_b32 v171, s71, v157
  v_lshlrev_b32 v172, 16, v158
  v_and_b32 v173, s71, v158
  v_lshlrev_b32 v174, 16, v159
  v_and_b32 v175, s71, v159
  v_pk_add_f32 v[176:177], v[160:161], v[162:163]
  v_pk_add_f32 v[178:179], v[164:165], v[166:167]
  v_pk_add_f32 v[180:181], v[168:169], v[170:171]
  v_pk_add_f32 v[182:183], v[172:173], v[174:175]
  v_pk_add_f32 v[176:177], v[176:177], v[178:179]
  v_pk_add_f32 v[178:179], v[180:181], v[182:183]
  v_pk_add_f32 v[176:177], v[176:177], v[178:179]
  v_add_f32 v208, v176, v177
  s_nop 1
  v_add_f32 v208, v208, v208 row_ror:8
  s_nop 1
  v_add_f32 v208, v208, v208 row_ror:4
  s_nop 1
  v_add_f32 v208, v208, v208 row_ror:2
  s_nop 1
  v_add_f32 v208, v208, v208 row_ror:1
  v_mov_b32 v209, v208
  s_nop 1
  v_permlane16_swap_b32 v208, v209
  v_add_f32 v208, v208, v209
  v_mov_b32 v209, v208
  s_nop 1
  v_permlane32_swap_b32 v208, v209
  v_add_f32 v208, v208, v209
  v_mul_f32 v210, 0x3a800000, v208
  v_mov_b32 v211, v210
  v_pk_add_f32 v[176:177], v[160:161], v[210:211] neg_lo:[0,1] neg_hi:[0,1]
  v_pk_add_f32 v[178:179], v[162:163], v[210:211] neg_lo:[0,1] neg_hi:[0,1]
  v_pk_add_f32 v[180:181], v[164:165], v[210:211] neg_lo:[0,1] neg_hi:[0,1]
  v_pk_add_f32 v[182:183], v[166:167], v[210:211] neg_lo:[0,1] neg_hi:[0,1]
  v_pk_add_f32 v[184:185], v[168:169], v[210:211] neg_lo:[0,1] neg_hi:[0,1]
  v_pk_add_f32 v[186:187], v[170:171], v[210:211] neg_lo:[0,1] neg_hi:[0,1]
  v_pk_add_f32 v[188:189], v[172:173], v[210:211] neg_lo:[0,1] neg_hi:[0,1]
  v_pk_add_f32 v[190:191], v[174:175], v[210:211] neg_lo:[0,1] neg_hi:[0,1]
  v_pk_mul_f32 v[192:193], v[176:177], v[176:177]
  v_pk_mul_f32 v[194:195], v[178:179], v[178:179]
  v_pk_mul_f32 v[196:197], v[180:181], v[180:181]
  v_pk_mul_f32 v[198:199], v[182:183], v[182:183]
  v_pk_fma_f32 v[192:193], v[184:185], v[184:185], v[192:193]
  v_pk_fma_f32 v[194:195], v[186:187], v[186:187], v[194:195]
  v_pk_fma_f32 v[196:197], v[188:189], v[188:189], v[196:197]
  v_pk_fma_f32 v[198:199], v[190:191], v[190:191], v[198:199]
  v_cvt_pk_bf16_f32 v210, 0, v210
  v_mov_b32 v211, v210
  v_pk_add_f32 v[192:193], v[192:193], v[194:195]
  v_pk_add_f32 v[194:195], v[196:197], v[198:199]
  v_pk_add_f32 v[192:193], v[192:193], v[194:195]
  v_add_f32 v208, v192, v193
  s_nop 1
  v_add_f32 v208, v208, v208 row_ror:8
  s_nop 1
  v_add_f32 v208, v208, v208 row_ror:4
  s_nop 1
  v_add_f32 v208, v208, v208 row_ror:2
  s_nop 1
  v_add_f32 v208, v208, v208 row_ror:1
  v_mov_b32 v209, v208
  s_nop 1
  v_permlane16_swap_b32 v208, v209
  v_add_f32 v208, v208, v209
  v_mov_b32 v209, v208
  s_nop 1
  v_permlane32_swap_b32 v208, v209
  v_add_f32 v208, v208, v209
  v_mul_f32 v208, 0x3a800000, v208
  v_pk_add_f32 v[160:161], v[160:161], v[210:211] neg_lo:[0,1] neg_hi:[0,1]
  v_pk_add_f32 v[162:163], v[162:163], v[210:211] neg_lo:[0,1] neg_hi:[0,1]
  v_pk_add_f32 v[164:165], v[164:165], v[210:211] neg_lo:[0,1] neg_hi:[0,1]
  v_pk_add_f32 v[166:167], v[166:167], v[210:211] neg_lo:[0,1] neg_hi:[0,1]
  v_pk_add_f32 v[168:169], v[168:169], v[210:211] neg_lo:[0,1] neg_hi:[0,1]
  v_pk_add_f32 v[170:171], v[170:171], v[210:211] neg_lo:[0,1] neg_hi:[0,1]
  v_pk_add_f32 v[172:173], v[172:173], v[210:211] neg_lo:[0,1] neg_hi:[0,1]
  v_pk_add_f32 v[174:175], v[174:175], v[210:211] neg_lo:[0,1] neg_hi:[0,1]
  v_cvt_pk_bf16_f32 v208, 0, v208
  v_add_f32 v208, 0x3727c5ac, v208
  v_cvt_pk_bf16_f32 v208, 0, v208
  v_sqrt_f32 v208, v208
  v_cvt_pk_bf16_f32 v160, 0, v160
  v_cvt_pk_bf16_f32 v161, 0, v161
  v_cvt_pk_bf16_f32 v162, 0, v162
  v_cvt_pk_bf16_f32 v163, 0, v163
  v_cvt_pk_bf16_f32 v164, 0, v164
  v_cvt_pk_bf16_f32 v165, 0, v165
  v_cvt_pk_bf16_f32 v166, 0, v166
  v_cvt_pk_bf16_f32 v167, 0, v167
  v_cvt_pk_bf16_f32 v208, 0, v208
  v_rcp_f32 v208, v208
  v_cvt_pk_bf16_f32 v168, 0, v168
  v_cvt_pk_bf16_f32 v169, 0, v169
  v_cvt_pk_bf16_f32 v170, 0, v170
  v_cvt_pk_bf16_f32 v171, 0, v171
  v_cvt_pk_bf16_f32 v172, 0, v172
  v_cvt_pk_bf16_f32 v173, 0, v173
  v_cvt_pk_bf16_f32 v174, 0, v174
  v_cvt_pk_bf16_f32 v175, 0, v175
  v_mov_b32 v209, v208
  v_pk_mul_f32 v[160:161], v[160:161], v[208:209]
  v_pk_mul_f32 v[162:163], v[162:163], v[208:209]
  v_pk_mul_f32 v[164:165], v[164:165], v[208:209]
  v_pk_mul_f32 v[166:167], v[166:167], v[208:209]
  v_cvt_pk_bf16_f32 v152, v160, v161
  v_cvt_pk_bf16_f32 v153, v162, v163
  v_cvt_pk_bf16_f32 v154, v164, v165
  v_cvt_pk_bf16_f32 v155, v166, v167
  ds_write_b64 v216, v[152:153] offset:0
  ds_write_b64 v216, v[154:155] offset:128
  v_pk_mul_f32 v[168:169], v[168:169], v[208:209]
  v_pk_mul_f32 v[170:171], v[170:171], v[208:209]
  v_pk_mul_f32 v[172:173], v[172:173], v[208:209]
  v_pk_mul_f32 v[174:175], v[174:175], v[208:209]
  v_cvt_pk_bf16_f32 v156, v168, v169
  v_cvt_pk_bf16_f32 v157, v170, v171
  v_cvt_pk_bf16_f32 v158, v172, v173
  v_cvt_pk_bf16_f32 v159, v174, v175
  ds_write_b64 v216, v[156:157] offset:8192
  ds_write_b64 v216, v[158:159] offset:8320
  s_waitcnt lgkmcnt(0)
  s_barrier
  s_cmp_lt_u32 s36, 4
  s_cbranch_scc0 L1_nst
  ds_read_b128 v[176:179], v217
  ds_read_b128 v[180:183], v218 offset:1024
  ds_read_b128 v[184:187], v217 offset:2048
  ds_read_b128 v[188:191], v218 offset:3072
  s_add_u32 s71, s70, 4096
  s_add_u32 s72, s70, 8192
  s_add_u32 s73, s70, 12288
  s_waitcnt lgkmcnt(3)
  buffer_store_dwordx4 v[176:179], v219, s[28:31], s70 offen sc1
  s_waitcnt lgkmcnt(2)
  buffer_store_dwordx4 v[180:183], v219, s[28:31], s71 offen sc1
  s_waitcnt lgkmcnt(1)
  buffer_store_dwordx4 v[184:187], v219, s[28:31], s72 offen sc1
  s_waitcnt lgkmcnt(0)
  buffer_store_dwordx4 v[188:191], v219, s[28:31], s73 offen sc1
L1_nst:
  s_cmp_eq_u32 s36, 7
  s_cbranch_scc0 L1_ld
  v_and_b32 v208, 15, v1
  v_lshlrev_b32 v208, 2, v208
  s_and_b32 s48, s47, 3
  s_lshl_b32 s48, s48, 6
  s_mov_b32 s3, 0
  s_sleep 4
L1_zp:
  buffer_load_dword v209, v208, s[76:79], s48 offen sc1
  s_waitcnt vmcnt(0)
  v_cmp_ne_u32 vcc, 1, v209
  s_add_u32 s3, s3, 1
  s_nop 0
  s_cmp_eq_u64 vcc, 0
  s_cbranch_scc1 L1_arr
  s_sleep 16
  s_cmp_lt_u32 s3, 0x40000
  s_cbranch_scc1 L1_zp
L1_arr:
  v_mov_b32 v192, 1
  v_mov_b32 v193, 1
  v_mov_b32 v194, 1
  v_mov_b32 v195, 1
  v_mov_b32 v210, 131072
  s_lshl_b32 s49, s95, 7
  s_add_u32 s49, s49, 29392896
  s_waitcnt vmcnt(0)
  s_mov_b64 exec, 1
  ds_read_b32 v209, v210
  s_waitcnt lgkmcnt(0)
  v_readfirstlane_b32 s48, v209
  s_mov_b64 exec, 0xff
  s_nop 0
  s_cmp_eq_u32 s48, 4
  s_cselect_b32 s48, s49, 2130706432
  s_nop 0
  buffer_store_dwordx4 v[192:195], v2, s[28:31], s48 offen sc1
  s_mov_b64 exec, -1
  v_and_b32 v208, 31, v1
  v_lshlrev_b32 v208, 7, v208
  s_lshl_b32 s48, s38, 12
  s_add_u32 s48, s48, 29392896
  s_mov_b32 s3, 0
  s_mov_b64 exec, 0xffffffff
  buffer_load_dword v209, v208, s[28:31], s48 offen sc1
L1_xp:
  s_waitcnt vmcnt(0)
  v_cmp_ne_u32 vcc, 1, v209
  s_add_u32 s3, s3, 1
  s_nop 0
  s_and_b64 exec, exec, vcc
  s_cbranch_scc0 L1_xd
  s_sleep 2
  buffer_load_dword v209, v208, s[28:31], s48 offen sc1
  s_cmp_lt_u32 s3, 0x80000
  s_cbranch_scc1 L1_xp
L1_xd:
  s_mov_b64 exec, -1
  s_mov_b32 m0, s58
  s_nop 0
  buffer_load_dwordx4 v2, s[32:35], s59 offen lds
  buffer_load_dwordx2 v[14:15], v12, s[52:55], s56 offen offset:0
  buffer_load_dwordx2 v[16:17], v12, s[52:55], s56 offen offset:32
  buffer_load_dwordx2 v[18:19], v12, s[52:55], s56 offen offset:64
  buffer_load_dwordx2 v[20:21], v12, s[52:55], s56 offen offset:96
  buffer_load_dwordx2 v[22:23], v12, s[52:55], s56 offen offset:128
  buffer_load_dwordx2 v[24:25], v12, s[52:55], s56 offen offset:160
  buffer_load_dwordx2 v[26:27], v12, s[52:55], s57 offen
  s_branch L1_go
L1_ld:
  s_cmp_lt_u32 s36, 4
  s_cbranch_scc0 L1_ld2
  v_mov_b32 v192, 1
  v_mov_b32 v193, 1
  v_mov_b32 v194, 1
  v_mov_b32 v195, 1
  v_mov_b32 v210, 131072
  s_lshl_b32 s49, s95, 7
  s_add_u32 s49, s49, 29392896
  s_waitcnt vmcnt(0)
  s_mov_b64 exec, 1
  ds_add_rtn_u32 v209, v210, v192
  s_waitcnt lgkmcnt(0)
  v_readfirstlane_b32 s48, v209
  s_mov_b64 exec, 0xff
  s_nop 0
  s_cmp_eq_u32 s48, 3
  s_cselect_b32 s48, s49, 2130706432
  s_nop 0
  buffer_store_dwordx4 v[192:195], v2, s[28:31], s48 offen sc1
  s_mov_b64 exec, -1
L1_ld2:
  s_add_u32 m0, s68, 57344
  s_add_u32 s42, s42, s45
  buffer_load_dwordx4 v3, s[20:23], s42 offen lds
  s_add_u32 m0, s44, 57344
  s_add_u32 s43, s43, s51
  buffer_load_dwordx4 v4, s[24:27], s43 offen lds
  s_add_u32 m0, s68, 71680
  s_add_u32 s42, s42, s45
  buffer_load_dwordx4 v3, s[20:23], s42 offen lds
  s_add_u32 m0, s44, 71680
  s_add_u32 s43, s43, s51
  buffer_load_dwordx4 v4, s[24:27], s43 offen lds
  s_add_u32 m0, s68, 86016
  s_add_u32 s42, s42, s45
  buffer_load_dwordx4 v3, s[20:23], s42 offen lds
  s_add_u32 m0, s44, 86016
  s_add_u32 s43, s43, s51
  buffer_load_dwordx4 v4, s[24:27], s43 offen lds
  s_add_u32 m0, s68, 100352
  s_add_u32 s42, s42, s45
  buffer_load_dwordx4 v3, s[20:23], s42 offen lds
  s_add_u32 m0, s44, 100352
  s_add_u32 s43, s43, s51
  buffer_load_dwordx4 v4, s[24:27], s43 offen lds
  s_add_u32 m0, s68, 0
  s_add_u32 s42, s42, s45
  buffer_load_dwordx4 v3, s[20:23], s42 offen lds
  s_add_u32 m0, s44, 0
  s_add_u32 s43, s43, s51
  buffer_load_dwordx4 v4, s[24:27], s43 offen lds
  s_add_u32 m0, s68, 14336
  s_add_u32 s42, s42, s45
  buffer_load_dwordx4 v3, s[20:23], s42 offen lds
  s_add_u32 m0, s44, 14336
  s_add_u32 s43, s43, s51
  buffer_load_dwordx4 v4, s[24:27], s43 offen lds
  s_mov_b32 m0, s58
  s_nop 0
  buffer_load_dwordx4 v2, s[32:35], s59 offen lds
  buffer_load_dwordx2 v[14:15], v12, s[52:55], s56 offen offset:0
  buffer_load_dwordx2 v[16:17], v12, s[52:55], s56 offen offset:32
  buffer_load_dwordx2 v[18:19], v12, s[52:55], s56 offen offset:64
  buffer_load_dwordx2 v[20:21], v12, s[52:55], s56 offen offset:96
  buffer_load_dwordx2 v[22:23], v12, s[52:55], s56 offen offset:128
  buffer_load_dwordx2 v[24:25], v12, s[52:55], s56 offen offset:160
  buffer_load_dwordx2 v[26:27], v12, s[52:55], s57 offen
L1_go:
  s_waitcnt vmcnt(16)
  s_barrier
  buffer_load_dwordx4 v[36:39], v2, s[16:19], s41 offen offset:0 sc1
  buffer_load_dwordx4 v[40:43], v2, s[16:19], s41 offen offset:1024 sc1
  buffer_load_dwordx4 v[44:47], v2, s[16:19], s41 offen offset:2048 sc1
  buffer_load_dwordx4 v[48:51], v2, s[16:19], s41 offen offset:3072 sc1
  s_add_u32 s41, s41, 4096
  buffer_load_dwordx4 v[52:55], v2, s[16:19], s41 offen offset:0 sc1
  buffer_load_dwordx4 v[56:59], v2, s[16:19], s41 offen offset:1024 sc1
  buffer_load_dwordx4 v[60:63], v2, s[16:19], s41 offen offset:2048 sc1
  buffer_load_dwordx4 v[64:67], v2, s[16:19], s41 offen offset:3072 sc1
  s_add_u32 s41, s41, 4096
  s_mul_i32 s48, s87, 1
  buffer_load_dword v30, v29, s[80:83], s48 offen
  ds_read_b64_tr_b16 v[100:101], v8 offset:0
  ds_read_b64_tr_b16 v[102:103], v8 offset:3072
  ds_read_b64_tr_b16 v[104:105], v9 offset:32
  ds_read_b64_tr_b16 v[106:107], v9 offset:3104
  ds_read_b64_tr_b16 v[108:109], v8 offset:64
  ds_read_b64_tr_b16 v[110:111], v8 offset:3136
  ds_read_b64_tr_b16 v[112:113], v9 offset:96
  ds_read_b64_tr_b16 v[114:115], v9 offset:3168
  ds_read_b64_tr_b16 v[116:117], v8 offset:128
  ds_read_b64_tr_b16 v[118:119], v8 offset:3200
  ds_read_b64_tr_b16 v[120:121], v9 offset:160
  ds_read_b64_tr_b16 v[122:123], v9 offset:3232
  ds_read_b64_tr_b16 v[124:125], v10 offset:0
  ds_read_b64_tr_b16 v[126:127], v10 offset:3584
  ds_read_b64_tr_b16 v[128:129], v10 offset:32
  ds_read_b64_tr_b16 v[130:131], v10 offset:3616
  ds_read_b64_tr_b16 v[132:133], v10 offset:64
  ds_read_b64_tr_b16 v[134:135], v10 offset:3648
  ds_read_b64_tr_b16 v[136:137], v10 offset:96
  ds_read_b64_tr_b16 v[138:139], v10 offset:3680
  ds_read_b64_tr_b16 v[140:141], v10 offset:128
  ds_read_b64_tr_b16 v[142:143], v10 offset:3712
  ds_read_b64_tr_b16 v[144:145], v10 offset:160
  ds_read_b64_tr_b16 v[146:147], v10 offset:3744
  ds_read_b64_tr_b16 v[148:149], v10 offset:192
  ds_read_b64_tr_b16 v[150:151], v10 offset:3776
  s_waitcnt vmcnt(7)
  s_setprio 3
  s_barrier
  s_waitcnt lgkmcnt(8)
  v_mfma_f32_16x16x32_bf16 v[152:155], v[100:103], v[36:39], 0
  v_mfma_f32_16x16x32_bf16 v[204:207], v[100:103], v[40:43], 0
  ds_read_b64_tr_b16 v[100:101], v8 offset:14336
  ds_read_b64_tr_b16 v[102:103], v8 offset:17408
  v_mfma_f32_16x16x32_bf16 v[156:159], v[104:107], v[36:39], 0
  v_mfma_f32_16x16x32_bf16 v[208:211], v[104:107], v[40:43], 0
  ds_read_b64_tr_b16 v[104:105], v9 offset:14368
  ds_read_b64_tr_b16 v[106:107], v9 offset:17440
  s_add_u32 m0, s68, 28672
  s_add_u32 s42, s42, s45
  buffer_load_dwordx4 v3, s[20:23], s42 offen lds
  v_mfma_f32_16x16x32_bf16 v[160:163], v[108:111], v[36:39], 0
  v_mfma_f32_16x16x32_bf16 v[212:215], v[108:111], v[40:43], 0
  s_setprio 2
  ds_read_b64_tr_b16 v[108:109], v8 offset:14400
  ds_read_b64_tr_b16 v[110:111], v8 offset:17472
  s_add_u32 m0, s44, 28672
  s_add_u32 s43, s43, s51
  buffer_load_dwordx4 v4, s[24:27], s43 offen lds
  v_mfma_f32_16x16x32_bf16 v[164:167], v[112:115], v[36:39], 0
  v_mfma_f32_16x16x32_bf16 v[216:219], v[112:115], v[40:43], 0
  ds_read_b64_tr_b16 v[112:113], v9 offset:14432
  ds_read_b64_tr_b16 v[114:115], v9 offset:17504
  v_mfma_f32_16x16x32_bf16 v[168:171], v[116:119], v[36:39], 0
  v_mfma_f32_16x16x32_bf16 v[220:223], v[116:119], v[40:43], 0
  ds_read_b64_tr_b16 v[116:117], v8 offset:14464
  ds_read_b64_tr_b16 v[118:119], v8 offset:17536
  buffer_load_dwordx4 v[68:71], v2, s[16:19], s41 offen offset:0 sc1
  v_mfma_f32_16x16x32_bf16 v[172:175], v[120:123], v[36:39], 0
  v_mfma_f32_16x16x32_bf16 v[224:227], v[120:123], v[40:43], 0
  ds_read_b64_tr_b16 v[120:121], v9 offset:14496
  ds_read_b64_tr_b16 v[122:123], v9 offset:17568
  v_mfma_f32_16x16x32_bf16 v[176:179], v[124:127], v[36:39], 0
  s_setprio 1
  v_mfma_f32_16x16x32_bf16 v[228:231], v[124:127], v[40:43], 0
  ds_read_b64_tr_b16 v[124:125], v10 offset:14336
  ds_read_b64_tr_b16 v[126:127], v10 offset:17920
  buffer_load_dwordx4 v[72:75], v2, s[16:19], s41 offen offset:1024 sc1
  v_mfma_f32_16x16x32_bf16 v[180:183], v[128:131], v[36:39], 0
  v_mfma_f32_16x16x32_bf16 v[232:235], v[128:131], v[40:43], 0
  ds_read_b64_tr_b16 v[128:129], v10 offset:14368
  ds_read_b64_tr_b16 v[130:131], v10 offset:17952
  v_mfma_f32_16x16x32_bf16 v[184:187], v[132:135], v[36:39], 0
  v_mfma_f32_16x16x32_bf16 v[236:239], v[132:135], v[40:43], 0
  ds_read_b64_tr_b16 v[132:133], v10 offset:14400
  ds_read_b64_tr_b16 v[134:135], v10 offset:17984
  buffer_load_dwordx4 v[76:79], v2, s[16:19], s41 offen offset:2048 sc1
  s_waitcnt lgkmcnt(15)
  v_mfma_f32_16x16x32_bf16 v[188:191], v[136:139], v[36:39], 0
  v_mfma_f32_16x16x32_bf16 v[240:243], v[136:139], v[40:43], 0
  s_setprio 0
  ds_read_b64_tr_b16 v[136:137], v10 offset:14432
  ds_read_b64_tr_b16 v[138:139], v10 offset:18016
  v_mfma_f32_16x16x32_bf16 v[192:195], v[140:143], v[36:39], 0
  v_mfma_f32_16x16x32_bf16 v[244:247], v[140:143], v[40:43], 0
  ds_read_b64_tr_b16 v[140:141], v10 offset:14464
  ds_read_b64_tr_b16 v[142:143], v10 offset:18048
  buffer_load_dwordx4 v[80:83], v2, s[16:19], s41 offen offset:3072 sc1
  s_add_u32 s41, s41, 4096
  v_mfma_f32_16x16x32_bf16 v[196:199], v[144:147], v[36:39], 0
  v_mfma_f32_16x16x32_bf16 v[248:251], v[144:147], v[40:43], 0
  ds_read_b64_tr_b16 v[144:145], v10 offset:14496
  ds_read_b64_tr_b16 v[146:147], v10 offset:18080
  v_mfma_f32_16x16x32_bf16 v[200:203], v[148:151], v[36:39], 0
  v_mfma_f32_16x16x32_bf16 v[252:255], v[148:151], v[40:43], 0
  ds_read_b64_tr_b16 v[148:149], v10 offset:14528
  ds_read_b64_tr_b16 v[150:151], v10 offset:18112
  s_waitcnt vmcnt(11)
  s_setprio 3
  s_barrier
  s_waitcnt lgkmcnt(8)
  v_mfma_f32_16x16x32_bf16 v[152:155], v[100:103], v[44:47], v[152:155]
  v_mfma_f32_16x16x32_bf16 v[204:207], v[100:103], v[48:51], v[204:207]
  ds_read_b64_tr_b16 v[100:101], v8 offset:28672
  ds_read_b64_tr_b16 v[102:103], v8 offset:31744
  v_mfma_f32_16x16x32_bf16 v[156:159], v[104:107], v[44:47], v[156:159]
  v_mfma_f32_16x16x32_bf16 v[208:211], v[104:107], v[48:51], v[208:211]
  ds_read_b64_tr_b16 v[104:105], v9 offset:28704
  ds_read_b64_tr_b16 v[106:107], v9 offset:31776
  s_add_u32 m0, s68, 43008
  s_add_u32 s42, s42, s45
  buffer_load_dwordx4 v3, s[20:23], s42 offen lds
  v_mfma_f32_16x16x32_bf16 v[160:163], v[108:111], v[44:47], v[160:163]
  v_mfma_f32_16x16x32_bf16 v[212:215], v[108:111], v[48:51], v[212:215]
  s_setprio 2
  ds_read_b64_tr_b16 v[108:109], v8 offset:28736
  ds_read_b64_tr_b16 v[110:111], v8 offset:31808
  s_add_u32 m0, s44, 43008
  s_add_u32 s43, s43, s51
  buffer_load_dwordx4 v4, s[24:27], s43 offen lds
  v_mfma_f32_16x16x32_bf16 v[164:167], v[112:115], v[44:47], v[164:167]
  v_mfma_f32_16x16x32_bf16 v[216:219], v[112:115], v[48:51], v[216:219]
  ds_read_b64_tr_b16 v[112:113], v9 offset:28768
  ds_read_b64_tr_b16 v[114:115], v9 offset:31840
  v_mfma_f32_16x16x32_bf16 v[168:171], v[116:119], v[44:47], v[168:171]
  v_mfma_f32_16x16x32_bf16 v[220:223], v[116:119], v[48:51], v[220:223]
  ds_read_b64_tr_b16 v[116:117], v8 offset:28800
  ds_read_b64_tr_b16 v[118:119], v8 offset:31872
  buffer_load_dwordx4 v[84:87], v2, s[16:19], s41 offen offset:0 sc1
  v_mfma_f32_16x16x32_bf16 v[172:175], v[120:123], v[44:47], v[172:175]
  v_mfma_f32_16x16x32_bf16 v[224:227], v[120:123], v[48:51], v[224:227]
  ds_read_b64_tr_b16 v[120:121], v9 offset:28832
  ds_read_b64_tr_b16 v[122:123], v9 offset:31904
  v_mfma_f32_16x16x32_bf16 v[176:179], v[124:127], v[44:47], v[176:179]
  s_setprio 1
  v_mfma_f32_16x16x32_bf16 v[228:231], v[124:127], v[48:51], v[228:231]
  ds_read_b64_tr_b16 v[124:125], v10 offset:28672
  ds_read_b64_tr_b16 v[126:127], v10 offset:32256
  buffer_load_dwordx4 v[88:91], v2, s[16:19], s41 offen offset:1024 sc1
  v_mfma_f32_16x16x32_bf16 v[180:183], v[128:131], v[44:47], v[180:183]
  v_mfma_f32_16x16x32_bf16 v[232:235], v[128:131], v[48:51], v[232:235]
  ds_read_b64_tr_b16 v[128:129], v10 offset:28704
  ds_read_b64_tr_b16 v[130:131], v10 offset:32288
  v_mfma_f32_16x16x32_bf16 v[184:187], v[132:135], v[44:47], v[184:187]
  v_mfma_f32_16x16x32_bf16 v[236:239], v[132:135], v[48:51], v[236:239]
  ds_read_b64_tr_b16 v[132:133], v10 offset:28736
  ds_read_b64_tr_b16 v[134:135], v10 offset:32320
  buffer_load_dwordx4 v[92:95], v2, s[16:19], s41 offen offset:2048 sc1
  s_waitcnt lgkmcnt(15)
  v_mfma_f32_16x16x32_bf16 v[188:191], v[136:139], v[44:47], v[188:191]
  v_mfma_f32_16x16x32_bf16 v[240:243], v[136:139], v[48:51], v[240:243]
  s_setprio 0
  ds_read_b64_tr_b16 v[136:137], v10 offset:28768
  ds_read_b64_tr_b16 v[138:139], v10 offset:32352
  v_mfma_f32_16x16x32_bf16 v[192:195], v[140:143], v[44:47], v[192:195]
  v_mfma_f32_16x16x32_bf16 v[244:247], v[140:143], v[48:51], v[244:247]
  ds_read_b64_tr_b16 v[140:141], v10 offset:28800
  ds_read_b64_tr_b16 v[142:143], v10 offset:32384
  buffer_load_dwordx4 v[96:99], v2, s[16:19], s41 offen offset:3072 sc1
  s_add_u32 s41, s41, 4096
  v_mfma_f32_16x16x32_bf16 v[196:199], v[144:147], v[44:47], v[196:199]
  v_mfma_f32_16x16x32_bf16 v[248:251], v[144:147], v[48:51], v[248:251]
  ds_read_b64_tr_b16 v[144:145], v10 offset:28832
  ds_read_b64_tr_b16 v[146:147], v10 offset:32416
  v_mfma_f32_16x16x32_bf16 v[200:203], v[148:151], v[44:47], v[200:203]
  v_mfma_f32_16x16x32_bf16 v[252:255], v[148:151], v[48:51], v[252:255]
  ds_read_b64_tr_b16 v[148:149], v10 offset:28864
  ds_read_b64_tr_b16 v[150:151], v10 offset:32448
  s_waitcnt vmcnt(15)
  s_setprio 3
  s_barrier
  s_waitcnt lgkmcnt(8)
  v_mfma_f32_16x16x32_bf16 v[152:155], v[100:103], v[52:55], v[152:155]
  v_mfma_f32_16x16x32_bf16 v[204:207], v[100:103], v[56:59], v[204:207]
  ds_read_b64_tr_b16 v[100:101], v8 offset:43008
  ds_read_b64_tr_b16 v[102:103], v8 offset:46080
  v_mfma_f32_16x16x32_bf16 v[156:159], v[104:107], v[52:55], v[156:159]
  v_mfma_f32_16x16x32_bf16 v[208:211], v[104:107], v[56:59], v[208:211]
  ds_read_b64_tr_b16 v[104:105], v9 offset:43040
  ds_read_b64_tr_b16 v[106:107], v9 offset:46112
  s_add_u32 m0, s68, 57344
  s_add_u32 s42, s42, s45
  buffer_load_dwordx4 v3, s[20:23], s42 offen lds
  v_mfma_f32_16x16x32_bf16 v[160:163], v[108:111], v[52:55], v[160:163]
  v_mfma_f32_16x16x32_bf16 v[212:215], v[108:111], v[56:59], v[212:215]
  s_setprio 2
  ds_read_b64_tr_b16 v[108:109], v8 offset:43072
  ds_read_b64_tr_b16 v[110:111], v8 offset:46144
  s_add_u32 m0, s44, 57344
  s_add_u32 s43, s43, s51
  buffer_load_dwordx4 v4, s[24:27], s43 offen lds
  v_mfma_f32_16x16x32_bf16 v[164:167], v[112:115], v[52:55], v[164:167]
  v_mfma_f32_16x16x32_bf16 v[216:219], v[112:115], v[56:59], v[216:219]
  ds_read_b64_tr_b16 v[112:113], v9 offset:43104
  ds_read_b64_tr_b16 v[114:115], v9 offset:46176
  v_mfma_f32_16x16x32_bf16 v[168:171], v[116:119], v[52:55], v[168:171]
  v_mfma_f32_16x16x32_bf16 v[220:223], v[116:119], v[56:59], v[220:223]
  ds_read_b64_tr_b16 v[116:117], v8 offset:43136
  ds_read_b64_tr_b16 v[118:119], v8 offset:46208
  buffer_load_dwordx4 v[36:39], v2, s[16:19], s41 offen offset:0 sc1
  v_mfma_f32_16x16x32_bf16 v[172:175], v[120:123], v[52:55], v[172:175]
  v_mfma_f32_16x16x32_bf16 v[224:227], v[120:123], v[56:59], v[224:227]
  ds_read_b64_tr_b16 v[120:121], v9 offset:43168
  ds_read_b64_tr_b16 v[122:123], v9 offset:46240
  v_mfma_f32_16x16x32_bf16 v[176:179], v[124:127], v[52:55], v[176:179]
  s_setprio 1
  v_mfma_f32_16x16x32_bf16 v[228:231], v[124:127], v[56:59], v[228:231]
  ds_read_b64_tr_b16 v[124:125], v10 offset:43008
  ds_read_b64_tr_b16 v[126:127], v10 offset:46592
  buffer_load_dwordx4 v[40:43], v2, s[16:19], s41 offen offset:1024 sc1
  v_mfma_f32_16x16x32_bf16 v[180:183], v[128:131], v[52:55], v[180:183]
  v_mfma_f32_16x16x32_bf16 v[232:235], v[128:131], v[56:59], v[232:235]
  ds_read_b64_tr_b16 v[128:129], v10 offset:43040
  ds_read_b64_tr_b16 v[130:131], v10 offset:46624
  v_mfma_f32_16x16x32_bf16 v[184:187], v[132:135], v[52:55], v[184:187]
  v_mfma_f32_16x16x32_bf16 v[236:239], v[132:135], v[56:59], v[236:239]
  ds_read_b64_tr_b16 v[132:133], v10 offset:43072
  ds_read_b64_tr_b16 v[134:135], v10 offset:46656
  buffer_load_dwordx4 v[44:47], v2, s[16:19], s41 offen offset:2048 sc1
  s_waitcnt lgkmcnt(15)
  v_mfma_f32_16x16x32_bf16 v[188:191], v[136:139], v[52:55], v[188:191]
  v_mfma_f32_16x16x32_bf16 v[240:243], v[136:139], v[56:59], v[240:243]
  s_setprio 0
  ds_read_b64_tr_b16 v[136:137], v10 offset:43104
  ds_read_b64_tr_b16 v[138:139], v10 offset:46688
  v_mfma_f32_16x16x32_bf16 v[192:195], v[140:143], v[52:55], v[192:195]
  v_mfma_f32_16x16x32_bf16 v[244:247], v[140:143], v[56:59], v[244:247]
  ds_read_b64_tr_b16 v[140:141], v10 offset:43136
  ds_read_b64_tr_b16 v[142:143], v10 offset:46720
  buffer_load_dwordx4 v[48:51], v2, s[16:19], s41 offen offset:3072 sc1
  s_add_u32 s41, s41, 4096
  v_mfma_f32_16x16x32_bf16 v[196:199], v[144:147], v[52:55], v[196:199]
  v_mfma_f32_16x16x32_bf16 v[248:251], v[144:147], v[56:59], v[248:251]
  ds_read_b64_tr_b16 v[144:145], v10 offset:43168
  ds_read_b64_tr_b16 v[146:147], v10 offset:46752
  v_mfma_f32_16x16x32_bf16 v[200:203], v[148:151], v[52:55], v[200:203]
  v_mfma_f32_16x16x32_bf16 v[252:255], v[148:151], v[56:59], v[252:255]
  ds_read_b64_tr_b16 v[148:149], v10 offset:43200
  ds_read_b64_tr_b16 v[150:151], v10 offset:46784
  s_waitcnt vmcnt(19)
  s_setprio 3
  s_barrier
  s_waitcnt lgkmcnt(8)
  v_mfma_f32_16x16x32_bf16 v[152:155], v[100:103], v[60:63], v[152:155]
  v_mfma_f32_16x16x32_bf16 v[204:207], v[100:103], v[64:67], v[204:207]
  ds_read_b64_tr_b16 v[100:101], v5 offset:0
  ds_read_b64_tr_b16 v[102:103], v5 offset:3072
  v_mfma_f32_16x16x32_bf16 v[156:159], v[104:107], v[60:63], v[156:159]
  v_mfma_f32_16x16x32_bf16 v[208:211], v[104:107], v[64:67], v[208:211]
  ds_read_b64_tr_b16 v[104:105], v6 offset:32
  ds_read_b64_tr_b16 v[106:107], v6 offset:3104
  s_add_u32 m0, s68, 71680
  s_add_u32 s42, s42, s45
  buffer_load_dwordx4 v3, s[20:23], s42 offen lds
  v_mfma_f32_16x16x32_bf16 v[160:163], v[108:111], v[60:63], v[160:163]
  v_mfma_f32_16x16x32_bf16 v[212:215], v[108:111], v[64:67], v[212:215]
  s_setprio 2
  ds_read_b64_tr_b16 v[108:109], v5 offset:64
  ds_read_b64_tr_b16 v[110:111], v5 offset:3136
  s_add_u32 m0, s44, 71680
  s_add_u32 s43, s43, s51
  buffer_load_dwordx4 v4, s[24:27], s43 offen lds
  v_mfma_f32_16x16x32_bf16 v[164:167], v[112:115], v[60:63], v[164:167]
  v_mfma_f32_16x16x32_bf16 v[216:219], v[112:115], v[64:67], v[216:219]
  ds_read_b64_tr_b16 v[112:113], v6 offset:96
  ds_read_b64_tr_b16 v[114:115], v6 offset:3168
  v_mfma_f32_16x16x32_bf16 v[168:171], v[116:119], v[60:63], v[168:171]
  v_mfma_f32_16x16x32_bf16 v[220:223], v[116:119], v[64:67], v[220:223]
  ds_read_b64_tr_b16 v[116:117], v5 offset:128
  ds_read_b64_tr_b16 v[118:119], v5 offset:3200
  buffer_load_dwordx4 v[52:55], v2, s[16:19], s41 offen offset:0 sc1
  v_mfma_f32_16x16x32_bf16 v[172:175], v[120:123], v[60:63], v[172:175]
  v_mfma_f32_16x16x32_bf16 v[224:227], v[120:123], v[64:67], v[224:227]
  ds_read_b64_tr_b16 v[120:121], v6 offset:160
  ds_read_b64_tr_b16 v[122:123], v6 offset:3232
  v_mfma_f32_16x16x32_bf16 v[176:179], v[124:127], v[60:63], v[176:179]
  s_setprio 1
  v_mfma_f32_16x16x32_bf16 v[228:231], v[124:127], v[64:67], v[228:231]
  ds_read_b64_tr_b16 v[124:125], v7 offset:0
  ds_read_b64_tr_b16 v[126:127], v7 offset:3584
  buffer_load_dwordx4 v[56:59], v2, s[16:19], s41 offen offset:1024 sc1
  v_mfma_f32_16x16x32_bf16 v[180:183], v[128:131], v[60:63], v[180:183]
  v_mfma_f32_16x16x32_bf16 v[232:235], v[128:131], v[64:67], v[232:235]
  ds_read_b64_tr_b16 v[128:129], v7 offset:32
  ds_read_b64_tr_b16 v[130:131], v7 offset:3616
  v_mfma_f32_16x16x32_bf16 v[184:187], v[132:135], v[60:63], v[184:187]
  v_mfma_f32_16x16x32_bf16 v[236:239], v[132:135], v[64:67], v[236:239]
  ds_read_b64_tr_b16 v[132:133], v7 offset:64
  ds_read_b64_tr_b16 v[134:135], v7 offset:3648
  buffer_load_dword v0, v28, s[80:83], s84 offen
  s_add_u32 s84, s84, s85
  s_waitcnt lgkmcnt(15)
  v_mfma_f32_16x16x32_bf16 v[188:191], v[136:139], v[60:63], v[188:191]
  v_mfma_f32_16x16x32_bf16 v[240:243], v[136:139], v[64:67], v[240:243]
  s_setprio 0
  ds_read_b64_tr_b16 v[136:137], v7 offset:96
  ds_read_b64_tr_b16 v[138:139], v7 offset:3680
  v_mfma_f32_16x16x32_bf16 v[192:195], v[140:143], v[60:63], v[192:195]
  v_mfma_f32_16x16x32_bf16 v[244:247], v[140:143], v[64:67], v[244:247]
  ds_read_b64_tr_b16 v[140:141], v7 offset:128
  ds_read_b64_tr_b16 v[142:143], v7 offset:3712
  v_mfma_f32_16x16x32_bf16 v[196:199], v[144:147], v[60:63], v[196:199]
  v_mfma_f32_16x16x32_bf16 v[248:251], v[144:147], v[64:67], v[248:251]
  ds_read_b64_tr_b16 v[144:145], v7 offset:160
  ds_read_b64_tr_b16 v[146:147], v7 offset:3744
  v_mfma_f32_16x16x32_bf16 v[200:203], v[148:151], v[60:63], v[200:203]
  v_mfma_f32_16x16x32_bf16 v[252:255], v[148:151], v[64:67], v[252:255]
  ds_read_b64_tr_b16 v[148:149], v7 offset:192
  ds_read_b64_tr_b16 v[150:151], v7 offset:3776
  s_waitcnt vmcnt(19)
  s_setprio 3
  s_barrier
  s_waitcnt lgkmcnt(8)
  v_mfma_f32_16x16x32_bf16 v[152:155], v[100:103], v[68:71], v[152:155]
  v_mfma_f32_16x16x32_bf16 v[204:207], v[100:103], v[72:75], v[204:207]
  ds_read_b64_tr_b16 v[100:101], v5 offset:14336
  ds_read_b64_tr_b16 v[102:103], v5 offset:17408
  v_mfma_f32_16x16x32_bf16 v[156:159], v[104:107], v[68:71], v[156:159]
  v_mfma_f32_16x16x32_bf16 v[208:211], v[104:107], v[72:75], v[208:211]
  ds_read_b64_tr_b16 v[104:105], v6 offset:14368
  ds_read_b64_tr_b16 v[106:107], v6 offset:17440
  s_add_u32 m0, s68, 86016
  s_add_u32 s42, s42, s45
  buffer_load_dwordx4 v3, s[20:23], s42 offen lds
  v_mfma_f32_16x16x32_bf16 v[160:163], v[108:111], v[68:71], v[160:163]
  v_mfma_f32_16x16x32_bf16 v[212:215], v[108:111], v[72:75], v[212:215]
  ds_read_b64_tr_b16 v[108:109], v5 offset:14400
  ds_read_b64_tr_b16 v[110:111], v5 offset:17472
  s_add_u32 m0, s44, 86016
  s_add_u32 s43, s43, s51
  buffer_load_dwordx4 v4, s[24:27], s43 offen lds
  v_mfma_f32_16x16x32_bf16 v[164:167], v[112:115], v[68:71], v[164:167]
  v_mfma_f32_16x16x32_bf16 v[216:219], v[112:115], v[72:75], v[216:219]
  ds_read_b64_tr_b16 v[112:113], v6 offset:14432
  ds_read_b64_tr_b16 v[114:115], v6 offset:17504
  v_mfma_f32_16x16x32_bf16 v[168:171], v[116:119], v[68:71], v[168:171]
  v_mfma_f32_16x16x32_bf16 v[220:223], v[116:119], v[72:75], v[220:223]
  ds_read_b64_tr_b16 v[116:117], v5 offset:14464
  ds_read_b64_tr_b16 v[118:119], v5 offset:17536
  buffer_load_dwordx4 v[60:63], v2, s[16:19], s41 offen offset:2048 sc1
  v_mfma_f32_16x16x32_bf16 v[172:175], v[120:123], v[68:71], v[172:175]
  v_mfma_f32_16x16x32_bf16 v[224:227], v[120:123], v[72:75], v[224:227]
  ds_read_b64_tr_b16 v[120:121], v6 offset:14496
  ds_read_b64_tr_b16 v[122:123], v6 offset:17568
  v_mfma_f32_16x16x32_bf16 v[176:179], v[124:127], v[68:71], v[176:179]
  s_setprio 2
  v_mfma_f32_16x16x32_bf16 v[228:231], v[124:127], v[72:75], v[228:231]
  ds_read_b64_tr_b16 v[124:125], v7 offset:14336
  ds_read_b64_tr_b16 v[126:127], v7 offset:17920
  buffer_load_dwordx4 v[64:67], v2, s[16:19], s41 offen offset:3072 sc1
  s_add_u32 s41, s41, 4096
  v_mfma_f32_16x16x32_bf16 v[180:183], v[128:131], v[68:71], v[180:183]
  v_mfma_f32_16x16x32_bf16 v[232:235], v[128:131], v[72:75], v[232:235]
  ds_read_b64_tr_b16 v[128:129], v7 offset:14368
  ds_read_b64_tr_b16 v[130:131], v7 offset:17952
  v_mfma_f32_16x16x32_bf16 v[184:187], v[132:135], v[68:71], v[184:187]
  v_mfma_f32_16x16x32_bf16 v[236:239], v[132:135], v[72:75], v[236:239]
  ds_read_b64_tr_b16 v[132:133], v7 offset:14400
  ds_read_b64_tr_b16 v[134:135], v7 offset:17984
  s_waitcnt lgkmcnt(15)
  v_mfma_f32_16x16x32_bf16 v[188:191], v[136:139], v[68:71], v[188:191]
  v_mfma_f32_16x16x32_bf16 v[240:243], v[136:139], v[72:75], v[240:243]
  ds_read_b64_tr_b16 v[136:137], v7 offset:14432
  ds_read_b64_tr_b16 v[138:139], v7 offset:18016
  v_mfma_f32_16x16x32_bf16 v[192:195], v[140:143], v[68:71], v[192:195]
  v_mfma_f32_16x16x32_bf16 v[244:247], v[140:143], v[72:75], v[244:247]
  ds_read_b64_tr_b16 v[140:141], v7 offset:14464
  ds_read_b64_tr_b16 v[142:143], v7 offset:18048
  v_mfma_f32_16x16x32_bf16 v[196:199], v[144:147], v[68:71], v[196:199]
  v_mfma_f32_16x16x32_bf16 v[248:251], v[144:147], v[72:75], v[248:251]
  ds_read_b64_tr_b16 v[144:145], v7 offset:14496
  ds_read_b64_tr_b16 v[146:147], v7 offset:18080
  v_mfma_f32_16x16x32_bf16 v[200:203], v[148:151], v[68:71], v[200:203]
  v_mfma_f32_16x16x32_bf16 v[252:255], v[148:151], v[72:75], v[252:255]
  s_setprio 1
  ds_read_b64_tr_b16 v[148:149], v7 offset:14528
  ds_read_b64_tr_b16 v[150:151], v7 offset:18112
  s_waitcnt vmcnt(21)
  s_waitcnt lgkmcnt(8)
  v_mfma_f32_16x16x32_bf16 v[152:155], v[100:103], v[76:79], v[152:155]
  v_mfma_f32_16x16x32_bf16 v[204:207], v[100:103], v[80:83], v[204:207]
  ds_read_b64_tr_b16 v[100:101], v5 offset:28672
  ds_read_b64_tr_b16 v[102:103], v5 offset:31744
  v_mfma_f32_16x16x32_bf16 v[156:159], v[104:107], v[76:79], v[156:159]
  v_mfma_f32_16x16x32_bf16 v[208:211], v[104:107], v[80:83], v[208:211]
  ds_read_b64_tr_b16 v[104:105], v6 offset:28704
  ds_read_b64_tr_b16 v[106:107], v6 offset:31776
  s_add_u32 m0, s68, 100352
  s_add_u32 s42, s42, s45
  buffer_load_dwordx4 v3, s[20:23], s42 offen lds
  v_mfma_f32_16x16x32_bf16 v[160:163], v[108:111], v[76:79], v[160:163]
  v_mfma_f32_16x16x32_bf16 v[212:215], v[108:111], v[80:83], v[212:215]
  ds_read_b64_tr_b16 v[108:109], v5 offset:28736
  ds_read_b64_tr_b16 v[110:111], v5 offset:31808
  s_add_u32 m0, s44, 100352
  s_add_u32 s43, s43, s51
  buffer_load_dwordx4 v4, s[24:27], s43 offen lds
  v_mfma_f32_16x16x32_bf16 v[164:167], v[112:115], v[76:79], v[164:167]
  v_mfma_f32_16x16x32_bf16 v[216:219], v[112:115], v[80:83], v[216:219]
  ds_read_b64_tr_b16 v[112:113], v6 offset:28768
  ds_read_b64_tr_b16 v[114:115], v6 offset:31840
  v_mfma_f32_16x16x32_bf16 v[168:171], v[116:119], v[76:79], v[168:171]
  v_mfma_f32_16x16x32_bf16 v[220:223], v[116:119], v[80:83], v[220:223]
  ds_read_b64_tr_b16 v[116:117], v5 offset:28800
  ds_read_b64_tr_b16 v[118:119], v5 offset:31872
  buffer_load_dwordx4 v[68:71], v2, s[16:19], s41 offen offset:0 sc1
  v_mfma_f32_16x16x32_bf16 v[172:175], v[120:123], v[76:79], v[172:175]
  v_mfma_f32_16x16x32_bf16 v[224:227], v[120:123], v[80:83], v[224:227]
  ds_read_b64_tr_b16 v[120:121], v6 offset:28832
  ds_read_b64_tr_b16 v[122:123], v6 offset:31904
  v_mfma_f32_16x16x32_bf16 v[176:179], v[124:127], v[76:79], v[176:179]
  s_setprio 0
  v_mfma_f32_16x16x32_bf16 v[228:231], v[124:127], v[80:83], v[228:231]
  ds_read_b64_tr_b16 v[124:125], v7 offset:28672
  ds_read_b64_tr_b16 v[126:127], v7 offset:32256
  buffer_load_dwordx4 v[72:75], v2, s[16:19], s41 offen offset:1024 sc1
  v_mfma_f32_16x16x32_bf16 v[180:183], v[128:131], v[76:79], v[180:183]
  v_mfma_f32_16x16x32_bf16 v[232:235], v[128:131], v[80:83], v[232:235]
  ds_read_b64_tr_b16 v[128:129], v7 offset:28704
  ds_read_b64_tr_b16 v[130:131], v7 offset:32288
  v_mfma_f32_16x16x32_bf16 v[184:187], v[132:135], v[76:79], v[184:187]
  v_mfma_f32_16x16x32_bf16 v[236:239], v[132:135], v[80:83], v[236:239]
  ds_read_b64_tr_b16 v[132:133], v7 offset:28736
  ds_read_b64_tr_b16 v[134:135], v7 offset:32320
  s_waitcnt lgkmcnt(15)
  v_mfma_f32_16x16x32_bf16 v[188:191], v[136:139], v[76:79], v[188:191]
  v_mfma_f32_16x16x32_bf16 v[240:243], v[136:139], v[80:83], v[240:243]
  ds_read_b64_tr_b16 v[136:137], v7 offset:28768
  ds_read_b64_tr_b16 v[138:139], v7 offset:32352
  v_mfma_f32_16x16x32_bf16 v[192:195], v[140:143], v[76:79], v[192:195]
  v_mfma_f32_16x16x32_bf16 v[244:247], v[140:143], v[80:83], v[244:247]
  ds_read_b64_tr_b16 v[140:141], v7 offset:28800
  ds_read_b64_tr_b16 v[142:143], v7 offset:32384
  v_mfma_f32_16x16x32_bf16 v[196:199], v[144:147], v[76:79], v[196:199]
  v_mfma_f32_16x16x32_bf16 v[248:251], v[144:147], v[80:83], v[248:251]
  ds_read_b64_tr_b16 v[144:145], v7 offset:28832
  ds_read_b64_tr_b16 v[146:147], v7 offset:32416
  v_mfma_f32_16x16x32_bf16 v[200:203], v[148:151], v[76:79], v[200:203]
  v_mfma_f32_16x16x32_bf16 v[252:255], v[148:151], v[80:83], v[252:255]
  ds_read_b64_tr_b16 v[148:149], v7 offset:28864
  ds_read_b64_tr_b16 v[150:151], v7 offset:32448
  s_waitcnt vmcnt(17)
  s_setprio 3
  s_barrier
  s_waitcnt lgkmcnt(8)
  v_mfma_f32_16x16x32_bf16 v[152:155], v[100:103], v[84:87], v[152:155]
  v_mfma_f32_16x16x32_bf16 v[204:207], v[100:103], v[88:91], v[204:207]
  ds_read_b64_tr_b16 v[100:101], v5 offset:43008
  ds_read_b64_tr_b16 v[102:103], v5 offset:46080
  v_mfma_f32_16x16x32_bf16 v[156:159], v[104:107], v[84:87], v[156:159]
  v_mfma_f32_16x16x32_bf16 v[208:211], v[104:107], v[88:91], v[208:211]
  ds_read_b64_tr_b16 v[104:105], v6 offset:43040
  ds_read_b64_tr_b16 v[106:107], v6 offset:46112
  s_add_u32 m0, s68, 0
  s_add_u32 s42, s42, s45
  buffer_load_dwordx4 v3, s[20:23], s42 offen lds
  v_mfma_f32_16x16x32_bf16 v[160:163], v[108:111], v[84:87], v[160:163]
  v_mfma_f32_16x16x32_bf16 v[212:215], v[108:111], v[88:91], v[212:215]
  ds_read_b64_tr_b16 v[108:109], v5 offset:43072
  ds_read_b64_tr_b16 v[110:111], v5 offset:46144
  s_add_u32 m0, s44, 0
  s_add_u32 s43, s43, s51
  buffer_load_dwordx4 v4, s[24:27], s43 offen lds
  v_mfma_f32_16x16x32_bf16 v[164:167], v[112:115], v[84:87], v[164:167]
  v_mfma_f32_16x16x32_bf16 v[216:219], v[112:115], v[88:91], v[216:219]
  ds_read_b64_tr_b16 v[112:113], v6 offset:43104
  ds_read_b64_tr_b16 v[114:115], v6 offset:46176
  v_mfma_f32_16x16x32_bf16 v[168:171], v[116:119], v[84:87], v[168:171]
  v_mfma_f32_16x16x32_bf16 v[220:223], v[116:119], v[88:91], v[220:223]
  ds_read_b64_tr_b16 v[116:117], v5 offset:43136
  ds_read_b64_tr_b16 v[118:119], v5 offset:46208
  buffer_load_dwordx4 v[76:79], v2, s[16:19], s41 offen offset:2048 sc1
  v_mfma_f32_16x16x32_bf16 v[172:175], v[120:123], v[84:87], v[172:175]
  v_mfma_f32_16x16x32_bf16 v[224:227], v[120:123], v[88:91], v[224:227]
  ds_read_b64_tr_b16 v[120:121], v6 offset:43168
  ds_read_b64_tr_b16 v[122:123], v6 offset:46240
  v_mfma_f32_16x16x32_bf16 v[176:179], v[124:127], v[84:87], v[176:179]
  s_setprio 2
  v_mfma_f32_16x16x32_bf16 v[228:231], v[124:127], v[88:91], v[228:231]
  ds_read_b64_tr_b16 v[124:125], v7 offset:43008
  ds_read_b64_tr_b16 v[126:127], v7 offset:46592
  buffer_load_dwordx4 v[80:83], v2, s[16:19], s41 offen offset:3072 sc1
  s_add_u32 s41, s41, 4096
  v_mfma_f32_16x16x32_bf16 v[180:183], v[128:131], v[84:87], v[180:183]
  v_mfma_f32_16x16x32_bf16 v[232:235], v[128:131], v[88:91], v[232:235]
  ds_read_b64_tr_b16 v[128:129], v7 offset:43040
  ds_read_b64_tr_b16 v[130:131], v7 offset:46624
  v_mfma_f32_16x16x32_bf16 v[184:187], v[132:135], v[84:87], v[184:187]
  v_mfma_f32_16x16x32_bf16 v[236:239], v[132:135], v[88:91], v[236:239]
  ds_read_b64_tr_b16 v[132:133], v7 offset:43072
  ds_read_b64_tr_b16 v[134:135], v7 offset:46656
  s_waitcnt lgkmcnt(15)
  v_mfma_f32_16x16x32_bf16 v[188:191], v[136:139], v[84:87], v[188:191]
  v_mfma_f32_16x16x32_bf16 v[240:243], v[136:139], v[88:91], v[240:243]
  ds_read_b64_tr_b16 v[136:137], v7 offset:43104
  ds_read_b64_tr_b16 v[138:139], v7 offset:46688
  v_mfma_f32_16x16x32_bf16 v[192:195], v[140:143], v[84:87], v[192:195]
  v_mfma_f32_16x16x32_bf16 v[244:247], v[140:143], v[88:91], v[244:247]
  ds_read_b64_tr_b16 v[140:141], v7 offset:43136
  ds_read_b64_tr_b16 v[142:143], v7 offset:46720
  v_mfma_f32_16x16x32_bf16 v[196:199], v[144:147], v[84:87], v[196:199]
  v_mfma_f32_16x16x32_bf16 v[248:251], v[144:147], v[88:91], v[248:251]
  ds_read_b64_tr_b16 v[144:145], v7 offset:43168
  ds_read_b64_tr_b16 v[146:147], v7 offset:46752
  v_mfma_f32_16x16x32_bf16 v[200:203], v[148:151], v[84:87], v[200:203]
  v_mfma_f32_16x16x32_bf16 v[252:255], v[148:151], v[88:91], v[252:255]
  s_setprio 1
  ds_read_b64_tr_b16 v[148:149], v7 offset:43200
  ds_read_b64_tr_b16 v[150:151], v7 offset:46784
  s_waitcnt lgkmcnt(8)
  v_mfma_f32_16x16x32_bf16 v[152:155], v[100:103], v[92:95], v[152:155]
  v_mfma_f32_16x16x32_bf16 v[204:207], v[100:103], v[96:99], v[204:207]
  ds_read_b64_tr_b16 v[100:101], v8 offset:0
  ds_read_b64_tr_b16 v[102:103], v8 offset:3072
  v_mfma_f32_16x16x32_bf16 v[156:159], v[104:107], v[92:95], v[156:159]
  v_mfma_f32_16x16x32_bf16 v[208:211], v[104:107], v[96:99], v[208:211]
  ds_read_b64_tr_b16 v[104:105], v9 offset:32
  ds_read_b64_tr_b16 v[106:107], v9 offset:3104
  s_add_u32 m0, s68, 14336
  s_add_u32 s42, s42, s45
  buffer_load_dwordx4 v3, s[20:23], s42 offen lds
  v_mfma_f32_16x16x32_bf16 v[160:163], v[108:111], v[92:95], v[160:163]
  v_mfma_f32_16x16x32_bf16 v[212:215], v[108:111], v[96:99], v[212:215]
  ds_read_b64_tr_b16 v[108:109], v8 offset:64
  ds_read_b64_tr_b16 v[110:111], v8 offset:3136
  s_add_u32 m0, s44, 14336
  s_add_u32 s43, s43, s51
  buffer_load_dwordx4 v4, s[24:27], s43 offen lds
  v_mfma_f32_16x16x32_bf16 v[164:167], v[112:115], v[92:95], v[164:167]
  v_mfma_f32_16x16x32_bf16 v[216:219], v[112:115], v[96:99], v[216:219]
  ds_read_b64_tr_b16 v[112:113], v9 offset:96
  ds_read_b64_tr_b16 v[114:115], v9 offset:3168
  v_mfma_f32_16x16x32_bf16 v[168:171], v[116:119], v[92:95], v[168:171]
  v_mfma_f32_16x16x32_bf16 v[220:223], v[116:119], v[96:99], v[220:223]
  ds_read_b64_tr_b16 v[116:117], v8 offset:128
  ds_read_b64_tr_b16 v[118:119], v8 offset:3200
  buffer_load_dwordx4 v[84:87], v2, s[16:19], s41 offen offset:0 sc1
  v_mfma_f32_16x16x32_bf16 v[172:175], v[120:123], v[92:95], v[172:175]
  v_mfma_f32_16x16x32_bf16 v[224:227], v[120:123], v[96:99], v[224:227]
  ds_read_b64_tr_b16 v[120:121], v9 offset:160
  ds_read_b64_tr_b16 v[122:123], v9 offset:3232
  v_mfma_f32_16x16x32_bf16 v[176:179], v[124:127], v[92:95], v[176:179]
  s_setprio 0
  v_mfma_f32_16x16x32_bf16 v[228:231], v[124:127], v[96:99], v[228:231]
  ds_read_b64_tr_b16 v[124:125], v10 offset:0
  ds_read_b64_tr_b16 v[126:127], v10 offset:3584
  buffer_load_dwordx4 v[88:91], v2, s[16:19], s41 offen offset:1024 sc1
  v_mfma_f32_16x16x32_bf16 v[180:183], v[128:131], v[92:95], v[180:183]
  v_mfma_f32_16x16x32_bf16 v[232:235], v[128:131], v[96:99], v[232:235]
  ds_read_b64_tr_b16 v[128:129], v10 offset:32
  ds_read_b64_tr_b16 v[130:131], v10 offset:3616
  v_mfma_f32_16x16x32_bf16 v[184:187], v[132:135], v[92:95], v[184:187]
  v_mfma_f32_16x16x32_bf16 v[236:239], v[132:135], v[96:99], v[236:239]
  ds_read_b64_tr_b16 v[132:133], v10 offset:64
  ds_read_b64_tr_b16 v[134:135], v10 offset:3648
  buffer_load_dword v0, v28, s[80:83], s84 offen
  s_add_u32 s84, s84, s85
  s_waitcnt lgkmcnt(15)
  v_mfma_f32_16x16x32_bf16 v[188:191], v[136:139], v[92:95], v[188:191]
  v_mfma_f32_16x16x32_bf16 v[240:243], v[136:139], v[96:99], v[240:243]
  ds_read_b64_tr_b16 v[136:137], v10 offset:96
  ds_read_b64_tr_b16 v[138:139], v10 offset:3680
  v_mfma_f32_16x16x32_bf16 v[192:195], v[140:143], v[92:95], v[192:195]
  v_mfma_f32_16x16x32_bf16 v[244:247], v[140:143], v[96:99], v[244:247]
  ds_read_b64_tr_b16 v[140:141], v10 offset:128
  ds_read_b64_tr_b16 v[142:143], v10 offset:3712
  v_mfma_f32_16x16x32_bf16 v[196:199], v[144:147], v[92:95], v[196:199]
  v_mfma_f32_16x16x32_bf16 v[248:251], v[144:147], v[96:99], v[248:251]
  ds_read_b64_tr_b16 v[144:145], v10 offset:160
  ds_read_b64_tr_b16 v[146:147], v10 offset:3744
  v_mfma_f32_16x16x32_bf16 v[200:203], v[148:151], v[92:95], v[200:203]
  v_mfma_f32_16x16x32_bf16 v[252:255], v[148:151], v[96:99], v[252:255]
  ds_read_b64_tr_b16 v[148:149], v10 offset:192
  ds_read_b64_tr_b16 v[150:151], v10 offset:3776
  s_waitcnt vmcnt(15)
  s_setprio 3
  s_barrier
  s_waitcnt lgkmcnt(8)
  v_mfma_f32_16x16x32_bf16 v[152:155], v[100:103], v[36:39], v[152:155]
  v_mfma_f32_16x16x32_bf16 v[204:207], v[100:103], v[40:43], v[204:207]
  ds_read_b64_tr_b16 v[100:101], v8 offset:14336
  ds_read_b64_tr_b16 v[102:103], v8 offset:17408
  v_mfma_f32_16x16x32_bf16 v[156:159], v[104:107], v[36:39], v[156:159]
  v_mfma_f32_16x16x32_bf16 v[208:211], v[104:107], v[40:43], v[208:211]
  ds_read_b64_tr_b16 v[104:105], v9 offset:14368
  ds_read_b64_tr_b16 v[106:107], v9 offset:17440
  s_add_u32 m0, s68, 28672
  s_add_u32 s42, s42, s45
  buffer_load_dwordx4 v3, s[20:23], s42 offen lds
  v_mfma_f32_16x16x32_bf16 v[160:163], v[108:111], v[36:39], v[160:163]
  v_mfma_f32_16x16x32_bf16 v[212:215], v[108:111], v[40:43], v[212:215]
  ds_read_b64_tr_b16 v[108:109], v8 offset:14400
  ds_read_b64_tr_b16 v[110:111], v8 offset:17472
  s_add_u32 m0, s44, 28672
  s_add_u32 s43, s43, s51
  buffer_load_dwordx4 v4, s[24:27], s43 offen lds
  v_mfma_f32_16x16x32_bf16 v[164:167], v[112:115], v[36:39], v[164:167]
  v_mfma_f32_16x16x32_bf16 v[216:219], v[112:115], v[40:43], v[216:219]
  ds_read_b64_tr_b16 v[112:113], v9 offset:14432
  ds_read_b64_tr_b16 v[114:115], v9 offset:17504
  v_mfma_f32_16x16x32_bf16 v[168:171], v[116:119], v[36:39], v[168:171]
  v_mfma_f32_16x16x32_bf16 v[220:223], v[116:119], v[40:43], v[220:223]
  ds_read_b64_tr_b16 v[116:117], v8 offset:14464
  ds_read_b64_tr_b16 v[118:119], v8 offset:17536
  buffer_load_dwordx4 v[92:95], v2, s[16:19], s41 offen offset:2048 sc1
  v_mfma_f32_16x16x32_bf16 v[172:175], v[120:123], v[36:39], v[172:175]
  v_mfma_f32_16x16x32_bf16 v[224:227], v[120:123], v[40:43], v[224:227]
  ds_read_b64_tr_b16 v[120:121], v9 offset:14496
  ds_read_b64_tr_b16 v[122:123], v9 offset:17568
  v_mfma_f32_16x16x32_bf16 v[176:179], v[124:127], v[36:39], v[176:179]
  s_setprio 2
  v_mfma_f32_16x16x32_bf16 v[228:231], v[124:127], v[40:43], v[228:231]
  ds_read_b64_tr_b16 v[124:125], v10 offset:14336
  ds_read_b64_tr_b16 v[126:127], v10 offset:17920
  buffer_load_dwordx4 v[96:99], v2, s[16:19], s41 offen offset:3072 sc1
  s_add_u32 s41, s41, 4096
  v_mfma_f32_16x16x32_bf16 v[180:183], v[128:131], v[36:39], v[180:183]
  v_mfma_f32_16x16x32_bf16 v[232:235], v[128:131], v[40:43], v[232:235]
  ds_read_b64_tr_b16 v[128:129], v10 offset:14368
  ds_read_b64_tr_b16 v[130:131], v10 offset:17952
  v_mfma_f32_16x16x32_bf16 v[184:187], v[132:135], v[36:39], v[184:187]
  v_mfma_f32_16x16x32_bf16 v[236:239], v[132:135], v[40:43], v[236:239]
  ds_read_b64_tr_b16 v[132:133], v10 offset:14400
  ds_read_b64_tr_b16 v[134:135], v10 offset:17984
  s_waitcnt lgkmcnt(15)
  v_mfma_f32_16x16x32_bf16 v[188:191], v[136:139], v[36:39], v[188:191]
  v_mfma_f32_16x16x32_bf16 v[240:243], v[136:139], v[40:43], v[240:243]
  ds_read_b64_tr_b16 v[136:137], v10 offset:14432
  ds_read_b64_tr_b16 v[138:139], v10 offset:18016
  v_mfma_f32_16x16x32_bf16 v[192:195], v[140:143], v[36:39], v[192:195]
  v_mfma_f32_16x16x32_bf16 v[244:247], v[140:143], v[40:43], v[244:247]
  ds_read_b64_tr_b16 v[140:141], v10 offset:14464
  ds_read_b64_tr_b16 v[142:143], v10 offset:18048
  v_mfma_f32_16x16x32_bf16 v[196:199], v[144:147], v[36:39], v[196:199]
  v_mfma_f32_16x16x32_bf16 v[248:251], v[144:147], v[40:43], v[248:251]
  ds_read_b64_tr_b16 v[144:145], v10 offset:14496
  ds_read_b64_tr_b16 v[146:147], v10 offset:18080
  v_mfma_f32_16x16x32_bf16 v[200:203], v[148:151], v[36:39], v[200:203]
  v_mfma_f32_16x16x32_bf16 v[252:255], v[148:151], v[40:43], v[252:255]
  s_setprio 1
  ds_read_b64_tr_b16 v[148:149], v10 offset:14528
  ds_read_b64_tr_b16 v[150:151], v10 offset:18112
  s_waitcnt lgkmcnt(8)
  v_mfma_f32_16x16x32_bf16 v[152:155], v[100:103], v[44:47], v[152:155]
  v_mfma_f32_16x16x32_bf16 v[204:207], v[100:103], v[48:51], v[204:207]
  ds_read_b64_tr_b16 v[100:101], v8 offset:28672
  ds_read_b64_tr_b16 v[102:103], v8 offset:31744
  v_mfma_f32_16x16x32_bf16 v[156:159], v[104:107], v[44:47], v[156:159]
  v_mfma_f32_16x16x32_bf16 v[208:211], v[104:107], v[48:51], v[208:211]
  ds_read_b64_tr_b16 v[104:105], v9 offset:28704
  ds_read_b64_tr_b16 v[106:107], v9 offset:31776
  s_add_u32 m0, s68, 43008
  s_add_u32 s42, s42, s45
  buffer_load_dwordx4 v3, s[20:23], s42 offen lds
  v_mfma_f32_16x16x32_bf16 v[160:163], v[108:111], v[44:47], v[160:163]
  v_mfma_f32_16x16x32_bf16 v[212:215], v[108:111], v[48:51], v[212:215]
  ds_read_b64_tr_b16 v[108:109], v8 offset:28736
  ds_read_b64_tr_b16 v[110:111], v8 offset:31808
  s_add_u32 m0, s44, 43008
  s_add_u32 s43, s43, s51
  buffer_load_dwordx4 v4, s[24:27], s43 offen lds
  v_mfma_f32_16x16x32_bf16 v[164:167], v[112:115], v[44:47], v[164:167]
  v_mfma_f32_16x16x32_bf16 v[216:219], v[112:115], v[48:51], v[216:219]
  ds_read_b64_tr_b16 v[112:113], v9 offset:28768
  ds_read_b64_tr_b16 v[114:115], v9 offset:31840
  v_mfma_f32_16x16x32_bf16 v[168:171], v[116:119], v[44:47], v[168:171]
  v_mfma_f32_16x16x32_bf16 v[220:223], v[116:119], v[48:51], v[220:223]
  ds_read_b64_tr_b16 v[116:117], v8 offset:28800
  ds_read_b64_tr_b16 v[118:119], v8 offset:31872
  buffer_load_dwordx4 v[36:39], v2, s[16:19], s41 offen offset:0 sc1
  v_mfma_f32_16x16x32_bf16 v[172:175], v[120:123], v[44:47], v[172:175]
  v_mfma_f32_16x16x32_bf16 v[224:227], v[120:123], v[48:51], v[224:227]
  ds_read_b64_tr_b16 v[120:121], v9 offset:28832
  ds_read_b64_tr_b16 v[122:123], v9 offset:31904
  v_mfma_f32_16x16x32_bf16 v[176:179], v[124:127], v[44:47], v[176:179]
  s_setprio 0
  v_mfma_f32_16x16x32_bf16 v[228:231], v[124:127], v[48:51], v[228:231]
  ds_read_b64_tr_b16 v[124:125], v10 offset:28672
  ds_read_b64_tr_b16 v[126:127], v10 offset:32256
  buffer_load_dwordx4 v[40:43], v2, s[16:19], s41 offen offset:1024 sc1
  v_mfma_f32_16x16x32_bf16 v[180:183], v[128:131], v[44:47], v[180:183]
  v_mfma_f32_16x16x32_bf16 v[232:235], v[128:131], v[48:51], v[232:235]
  ds_read_b64_tr_b16 v[128:129], v10 offset:28704
  ds_read_b64_tr_b16 v[130:131], v10 offset:32288
  v_mfma_f32_16x16x32_bf16 v[184:187], v[132:135], v[44:47], v[184:187]
  v_mfma_f32_16x16x32_bf16 v[236:239], v[132:135], v[48:51], v[236:239]
  ds_read_b64_tr_b16 v[132:133], v10 offset:28736
  ds_read_b64_tr_b16 v[134:135], v10 offset:32320
  s_waitcnt lgkmcnt(15)
  v_mfma_f32_16x16x32_bf16 v[188:191], v[136:139], v[44:47], v[188:191]
  v_mfma_f32_16x16x32_bf16 v[240:243], v[136:139], v[48:51], v[240:243]
  ds_read_b64_tr_b16 v[136:137], v10 offset:28768
  ds_read_b64_tr_b16 v[138:139], v10 offset:32352
  v_mfma_f32_16x16x32_bf16 v[192:195], v[140:143], v[44:47], v[192:195]
  v_mfma_f32_16x16x32_bf16 v[244:247], v[140:143], v[48:51], v[244:247]
  ds_read_b64_tr_b16 v[140:141], v10 offset:28800
  ds_read_b64_tr_b16 v[142:143], v10 offset:32384
  v_mfma_f32_16x16x32_bf16 v[196:199], v[144:147], v[44:47], v[196:199]
  v_mfma_f32_16x16x32_bf16 v[248:251], v[144:147], v[48:51], v[248:251]
  ds_read_b64_tr_b16 v[144:145], v10 offset:28832
  ds_read_b64_tr_b16 v[146:147], v10 offset:32416
  v_mfma_f32_16x16x32_bf16 v[200:203], v[148:151], v[44:47], v[200:203]
  v_mfma_f32_16x16x32_bf16 v[252:255], v[148:151], v[48:51], v[252:255]
  ds_read_b64_tr_b16 v[148:149], v10 offset:28864
  ds_read_b64_tr_b16 v[150:151], v10 offset:32448
  s_waitcnt vmcnt(15)
  s_setprio 3
  s_barrier
  s_waitcnt lgkmcnt(8)
  v_mfma_f32_16x16x32_bf16 v[152:155], v[100:103], v[52:55], v[152:155]
  v_mfma_f32_16x16x32_bf16 v[204:207], v[100:103], v[56:59], v[204:207]
  ds_read_b64_tr_b16 v[100:101], v8 offset:43008
  ds_read_b64_tr_b16 v[102:103], v8 offset:46080
  v_mfma_f32_16x16x32_bf16 v[156:159], v[104:107], v[52:55], v[156:159]
  v_mfma_f32_16x16x32_bf16 v[208:211], v[104:107], v[56:59], v[208:211]
  ds_read_b64_tr_b16 v[104:105], v9 offset:43040
  ds_read_b64_tr_b16 v[106:107], v9 offset:46112
  s_add_u32 m0, s68, 57344
  s_add_u32 s42, s42, s45
  buffer_load_dwordx4 v3, s[20:23], s42 offen lds
  v_mfma_f32_16x16x32_bf16 v[160:163], v[108:111], v[52:55], v[160:163]
  v_mfma_f32_16x16x32_bf16 v[212:215], v[108:111], v[56:59], v[212:215]
  ds_read_b64_tr_b16 v[108:109], v8 offset:43072
  ds_read_b64_tr_b16 v[110:111], v8 offset:46144
  s_add_u32 m0, s44, 57344
  s_add_u32 s43, s43, s51
  buffer_load_dwordx4 v4, s[24:27], s43 offen lds
  v_mfma_f32_16x16x32_bf16 v[164:167], v[112:115], v[52:55], v[164:167]
  v_mfma_f32_16x16x32_bf16 v[216:219], v[112:115], v[56:59], v[216:219]
  ds_read_b64_tr_b16 v[112:113], v9 offset:43104
  ds_read_b64_tr_b16 v[114:115], v9 offset:46176
  v_mfma_f32_16x16x32_bf16 v[168:171], v[116:119], v[52:55], v[168:171]
  v_mfma_f32_16x16x32_bf16 v[220:223], v[116:119], v[56:59], v[220:223]
  ds_read_b64_tr_b16 v[116:117], v8 offset:43136
  ds_read_b64_tr_b16 v[118:119], v8 offset:46208
  buffer_load_dwordx4 v[44:47], v2, s[16:19], s41 offen offset:2048 sc1
  v_mfma_f32_16x16x32_bf16 v[172:175], v[120:123], v[52:55], v[172:175]
  v_mfma_f32_16x16x32_bf16 v[224:227], v[120:123], v[56:59], v[224:227]
  ds_read_b64_tr_b16 v[120:121], v9 offset:43168
  ds_read_b64_tr_b16 v[122:123], v9 offset:46240
  v_mfma_f32_16x16x32_bf16 v[176:179], v[124:127], v[52:55], v[176:179]
  s_setprio 2
  v_mfma_f32_16x16x32_bf16 v[228:231], v[124:127], v[56:59], v[228:231]
  ds_read_b64_tr_b16 v[124:125], v10 offset:43008
  ds_read_b64_tr_b16 v[126:127], v10 offset:46592
  buffer_load_dwordx4 v[48:51], v2, s[16:19], s41 offen offset:3072 sc1
  s_add_u32 s41, s41, 4096
  v_mfma_f32_16x16x32_bf16 v[180:183], v[128:131], v[52:55], v[180:183]
  v_mfma_f32_16x16x32_bf16 v[232:235], v[128:131], v[56:59], v[232:235]
  ds_read_b64_tr_b16 v[128:129], v10 offset:43040
  ds_read_b64_tr_b16 v[130:131], v10 offset:46624
  v_mfma_f32_16x16x32_bf16 v[184:187], v[132:135], v[52:55], v[184:187]
  v_mfma_f32_16x16x32_bf16 v[236:239], v[132:135], v[56:59], v[236:239]
  ds_read_b64_tr_b16 v[132:133], v10 offset:43072
  ds_read_b64_tr_b16 v[134:135], v10 offset:46656
  s_waitcnt lgkmcnt(15)
  v_mfma_f32_16x16x32_bf16 v[188:191], v[136:139], v[52:55], v[188:191]
  v_mfma_f32_16x16x32_bf16 v[240:243], v[136:139], v[56:59], v[240:243]
  ds_read_b64_tr_b16 v[136:137], v10 offset:43104
  ds_read_b64_tr_b16 v[138:139], v10 offset:46688
  v_mfma_f32_16x16x32_bf16 v[192:195], v[140:143], v[52:55], v[192:195]
  v_mfma_f32_16x16x32_bf16 v[244:247], v[140:143], v[56:59], v[244:247]
  ds_read_b64_tr_b16 v[140:141], v10 offset:43136
  ds_read_b64_tr_b16 v[142:143], v10 offset:46720
  v_mfma_f32_16x16x32_bf16 v[196:199], v[144:147], v[52:55], v[196:199]
  v_mfma_f32_16x16x32_bf16 v[248:251], v[144:147], v[56:59], v[248:251]
  ds_read_b64_tr_b16 v[144:145], v10 offset:43168
  ds_read_b64_tr_b16 v[146:147], v10 offset:46752
  v_mfma_f32_16x16x32_bf16 v[200:203], v[148:151], v[52:55], v[200:203]
  v_mfma_f32_16x16x32_bf16 v[252:255], v[148:151], v[56:59], v[252:255]
  s_setprio 1
  ds_read_b64_tr_b16 v[148:149], v10 offset:43200
  ds_read_b64_tr_b16 v[150:151], v10 offset:46784
  s_waitcnt lgkmcnt(8)
  v_mfma_f32_16x16x32_bf16 v[152:155], v[100:103], v[60:63], v[152:155]
  v_mfma_f32_16x16x32_bf16 v[204:207], v[100:103], v[64:67], v[204:207]
  ds_read_b64_tr_b16 v[100:101], v5 offset:0
  ds_read_b64_tr_b16 v[102:103], v5 offset:3072
  v_mfma_f32_16x16x32_bf16 v[156:159], v[104:107], v[60:63], v[156:159]
  v_mfma_f32_16x16x32_bf16 v[208:211], v[104:107], v[64:67], v[208:211]
  ds_read_b64_tr_b16 v[104:105], v6 offset:32
  ds_read_b64_tr_b16 v[106:107], v6 offset:3104
  s_add_u32 m0, s68, 71680
  s_add_u32 s42, s42, s45
  buffer_load_dwordx4 v3, s[20:23], s42 offen lds
  v_mfma_f32_16x16x32_bf16 v[160:163], v[108:111], v[60:63], v[160:163]
  v_mfma_f32_16x16x32_bf16 v[212:215], v[108:111], v[64:67], v[212:215]
  ds_read_b64_tr_b16 v[108:109], v5 offset:64
  ds_read_b64_tr_b16 v[110:111], v5 offset:3136
  s_add_u32 m0, s44, 71680
  s_add_u32 s43, s43, s51
  buffer_load_dwordx4 v4, s[24:27], s43 offen lds
  v_mfma_f32_16x16x32_bf16 v[164:167], v[112:115], v[60:63], v[164:167]
  v_mfma_f32_16x16x32_bf16 v[216:219], v[112:115], v[64:67], v[216:219]
  ds_read_b64_tr_b16 v[112:113], v6 offset:96
  ds_read_b64_tr_b16 v[114:115], v6 offset:3168
  v_mfma_f32_16x16x32_bf16 v[168:171], v[116:119], v[60:63], v[168:171]
  v_mfma_f32_16x16x32_bf16 v[220:223], v[116:119], v[64:67], v[220:223]
  ds_read_b64_tr_b16 v[116:117], v5 offset:128
  ds_read_b64_tr_b16 v[118:119], v5 offset:3200
  buffer_load_dwordx4 v[52:55], v2, s[16:19], s41 offen offset:0 sc1
  v_mfma_f32_16x16x32_bf16 v[172:175], v[120:123], v[60:63], v[172:175]
  v_mfma_f32_16x16x32_bf16 v[224:227], v[120:123], v[64:67], v[224:227]
  ds_read_b64_tr_b16 v[120:121], v6 offset:160
  ds_read_b64_tr_b16 v[122:123], v6 offset:3232
  v_mfma_f32_16x16x32_bf16 v[176:179], v[124:127], v[60:63], v[176:179]
  s_setprio 0
  v_mfma_f32_16x16x32_bf16 v[228:231], v[124:127], v[64:67], v[228:231]
  ds_read_b64_tr_b16 v[124:125], v7 offset:0
  ds_read_b64_tr_b16 v[126:127], v7 offset:3584
  buffer_load_dwordx4 v[56:59], v2, s[16:19], s41 offen offset:1024 sc1
  v_mfma_f32_16x16x32_bf16 v[180:183], v[128:131], v[60:63], v[180:183]
  v_mfma_f32_16x16x32_bf16 v[232:235], v[128:131], v[64:67], v[232:235]
  ds_read_b64_tr_b16 v[128:129], v7 offset:32
  ds_read_b64_tr_b16 v[130:131], v7 offset:3616
  v_mfma_f32_16x16x32_bf16 v[184:187], v[132:135], v[60:63], v[184:187]
  v_mfma_f32_16x16x32_bf16 v[236:239], v[132:135], v[64:67], v[236:239]
  ds_read_b64_tr_b16 v[132:133], v7 offset:64
  ds_read_b64_tr_b16 v[134:135], v7 offset:3648
  buffer_load_dword v0, v28, s[80:83], s84 offen
  s_add_u32 s84, s84, s85
  s_waitcnt lgkmcnt(15)
  v_mfma_f32_16x16x32_bf16 v[188:191], v[136:139], v[60:63], v[188:191]
  v_mfma_f32_16x16x32_bf16 v[240:243], v[136:139], v[64:67], v[240:243]
  ds_read_b64_tr_b16 v[136:137], v7 offset:96
  ds_read_b64_tr_b16 v[138:139], v7 offset:3680
  v_mfma_f32_16x16x32_bf16 v[192:195], v[140:143], v[60:63], v[192:195]
  v_mfma_f32_16x16x32_bf16 v[244:247], v[140:143], v[64:67], v[244:247]
  ds_read_b64_tr_b16 v[140:141], v7 offset:128
  ds_read_b64_tr_b16 v[142:143], v7 offset:3712
  v_mfma_f32_16x16x32_bf16 v[196:199], v[144:147], v[60:63], v[196:199]
  v_mfma_f32_16x16x32_bf16 v[248:251], v[144:147], v[64:67], v[248:251]
  ds_read_b64_tr_b16 v[144:145], v7 offset:160
  ds_read_b64_tr_b16 v[146:147], v7 offset:3744
  v_mfma_f32_16x16x32_bf16 v[200:203], v[148:151], v[60:63], v[200:203]
  v_mfma_f32_16x16x32_bf16 v[252:255], v[148:151], v[64:67], v[252:255]
  ds_read_b64_tr_b16 v[148:149], v7 offset:192
  ds_read_b64_tr_b16 v[150:151], v7 offset:3776
  s_waitcnt vmcnt(15)
  s_setprio 3
  s_barrier
  s_waitcnt lgkmcnt(8)
  v_mfma_f32_16x16x32_bf16 v[152:155], v[100:103], v[68:71], v[152:155]
  v_mfma_f32_16x16x32_bf16 v[204:207], v[100:103], v[72:75], v[204:207]
  ds_read_b64_tr_b16 v[100:101], v5 offset:14336
  ds_read_b64_tr_b16 v[102:103], v5 offset:17408
  v_mfma_f32_16x16x32_bf16 v[156:159], v[104:107], v[68:71], v[156:159]
  v_mfma_f32_16x16x32_bf16 v[208:211], v[104:107], v[72:75], v[208:211]
  ds_read_b64_tr_b16 v[104:105], v6 offset:14368
  ds_read_b64_tr_b16 v[106:107], v6 offset:17440
  s_add_u32 m0, s68, 86016
  s_add_u32 s42, s42, s45
  buffer_load_dwordx4 v3, s[20:23], s42 offen lds
  v_mfma_f32_16x16x32_bf16 v[160:163], v[108:111], v[68:71], v[160:163]
  v_mfma_f32_16x16x32_bf16 v[212:215], v[108:111], v[72:75], v[212:215]
  ds_read_b64_tr_b16 v[108:109], v5 offset:14400
  ds_read_b64_tr_b16 v[110:111], v5 offset:17472
  s_add_u32 m0, s44, 86016
  s_add_u32 s43, s43, s51
  buffer_load_dwordx4 v4, s[24:27], s43 offen lds
  v_mfma_f32_16x16x32_bf16 v[164:167], v[112:115], v[68:71], v[164:167]
  v_mfma_f32_16x16x32_bf16 v[216:219], v[112:115], v[72:75], v[216:219]
  ds_read_b64_tr_b16 v[112:113], v6 offset:14432
  ds_read_b64_tr_b16 v[114:115], v6 offset:17504
  v_mfma_f32_16x16x32_bf16 v[168:171], v[116:119], v[68:71], v[168:171]
  v_mfma_f32_16x16x32_bf16 v[220:223], v[116:119], v[72:75], v[220:223]
  ds_read_b64_tr_b16 v[116:117], v5 offset:14464
  ds_read_b64_tr_b16 v[118:119], v5 offset:17536
  buffer_load_dwordx4 v[60:63], v2, s[16:19], s41 offen offset:2048 sc1
  v_mfma_f32_16x16x32_bf16 v[172:175], v[120:123], v[68:71], v[172:175]
  v_mfma_f32_16x16x32_bf16 v[224:227], v[120:123], v[72:75], v[224:227]
  ds_read_b64_tr_b16 v[120:121], v6 offset:14496
  ds_read_b64_tr_b16 v[122:123], v6 offset:17568
  v_mfma_f32_16x16x32_bf16 v[176:179], v[124:127], v[68:71], v[176:179]
  s_setprio 2
  v_mfma_f32_16x16x32_bf16 v[228:231], v[124:127], v[72:75], v[228:231]
  ds_read_b64_tr_b16 v[124:125], v7 offset:14336
  ds_read_b64_tr_b16 v[126:127], v7 offset:17920
  buffer_load_dwordx4 v[64:67], v2, s[16:19], s41 offen offset:3072 sc1
  s_add_u32 s41, s41, 4096
  v_mfma_f32_16x16x32_bf16 v[180:183], v[128:131], v[68:71], v[180:183]
  v_mfma_f32_16x16x32_bf16 v[232:235], v[128:131], v[72:75], v[232:235]
  ds_read_b64_tr_b16 v[128:129], v7 offset:14368
  ds_read_b64_tr_b16 v[130:131], v7 offset:17952
  v_mfma_f32_16x16x32_bf16 v[184:187], v[132:135], v[68:71], v[184:187]
  v_mfma_f32_16x16x32_bf16 v[236:239], v[132:135], v[72:75], v[236:239]
  ds_read_b64_tr_b16 v[132:133], v7 offset:14400
  ds_read_b64_tr_b16 v[134:135], v7 offset:17984
  s_waitcnt lgkmcnt(15)
  v_mfma_f32_16x16x32_bf16 v[188:191], v[136:139], v[68:71], v[188:191]
  v_mfma_f32_16x16x32_bf16 v[240:243], v[136:139], v[72:75], v[240:243]
  ds_read_b64_tr_b16 v[136:137], v7 offset:14432
  ds_read_b64_tr_b16 v[138:139], v7 offset:18016
  v_mfma_f32_16x16x32_bf16 v[192:195], v[140:143], v[68:71], v[192:195]
  v_mfma_f32_16x16x32_bf16 v[244:247], v[140:143], v[72:75], v[244:247]
  ds_read_b64_tr_b16 v[140:141], v7 offset:14464
  ds_read_b64_tr_b16 v[142:143], v7 offset:18048
  v_mfma_f32_16x16x32_bf16 v[196:199], v[144:147], v[68:71], v[196:199]
  v_mfma_f32_16x16x32_bf16 v[248:251], v[144:147], v[72:75], v[248:251]
  ds_read_b64_tr_b16 v[144:145], v7 offset:14496
  ds_read_b64_tr_b16 v[146:147], v7 offset:18080
  v_mfma_f32_16x16x32_bf16 v[200:203], v[148:151], v[68:71], v[200:203]
  v_mfma_f32_16x16x32_bf16 v[252:255], v[148:151], v[72:75], v[252:255]
  s_setprio 1
  ds_read_b64_tr_b16 v[148:149], v7 offset:14528
  ds_read_b64_tr_b16 v[150:151], v7 offset:18112
  s_waitcnt lgkmcnt(8)
  v_mfma_f32_16x16x32_bf16 v[152:155], v[100:103], v[76:79], v[152:155]
  v_mfma_f32_16x16x32_bf16 v[204:207], v[100:103], v[80:83], v[204:207]
  ds_read_b64_tr_b16 v[100:101], v5 offset:28672
  ds_read_b64_tr_b16 v[102:103], v5 offset:31744
  v_mfma_f32_16x16x32_bf16 v[156:159], v[104:107], v[76:79], v[156:159]
  v_mfma_f32_16x16x32_bf16 v[208:211], v[104:107], v[80:83], v[208:211]
  ds_read_b64_tr_b16 v[104:105], v6 offset:28704
  ds_read_b64_tr_b16 v[106:107], v6 offset:31776
  s_add_u32 m0, s68, 100352
  s_add_u32 s42, s42, s45
  buffer_load_dwordx4 v3, s[20:23], s42 offen lds
  v_mfma_f32_16x16x32_bf16 v[160:163], v[108:111], v[76:79], v[160:163]
  v_mfma_f32_16x16x32_bf16 v[212:215], v[108:111], v[80:83], v[212:215]
  ds_read_b64_tr_b16 v[108:109], v5 offset:28736
  ds_read_b64_tr_b16 v[110:111], v5 offset:31808
  s_add_u32 m0, s44, 100352
  s_add_u32 s43, s43, s51
  buffer_load_dwordx4 v4, s[24:27], s43 offen lds
  v_mfma_f32_16x16x32_bf16 v[164:167], v[112:115], v[76:79], v[164:167]
  v_mfma_f32_16x16x32_bf16 v[216:219], v[112:115], v[80:83], v[216:219]
  ds_read_b64_tr_b16 v[112:113], v6 offset:28768
  ds_read_b64_tr_b16 v[114:115], v6 offset:31840
  v_mfma_f32_16x16x32_bf16 v[168:171], v[116:119], v[76:79], v[168:171]
  v_mfma_f32_16x16x32_bf16 v[220:223], v[116:119], v[80:83], v[220:223]
  ds_read_b64_tr_b16 v[116:117], v5 offset:28800
  ds_read_b64_tr_b16 v[118:119], v5 offset:31872
  buffer_load_dwordx4 v[68:71], v2, s[16:19], s41 offen offset:0 sc1
  v_mfma_f32_16x16x32_bf16 v[172:175], v[120:123], v[76:79], v[172:175]
  v_mfma_f32_16x16x32_bf16 v[224:227], v[120:123], v[80:83], v[224:227]
  ds_read_b64_tr_b16 v[120:121], v6 offset:28832
  ds_read_b64_tr_b16 v[122:123], v6 offset:31904
  v_mfma_f32_16x16x32_bf16 v[176:179], v[124:127], v[76:79], v[176:179]
  s_setprio 0
  v_mfma_f32_16x16x32_bf16 v[228:231], v[124:127], v[80:83], v[228:231]
  ds_read_b64_tr_b16 v[124:125], v7 offset:28672
  ds_read_b64_tr_b16 v[126:127], v7 offset:32256
  buffer_load_dwordx4 v[72:75], v2, s[16:19], s41 offen offset:1024 sc1
  v_mfma_f32_16x16x32_bf16 v[180:183], v[128:131], v[76:79], v[180:183]
  v_mfma_f32_16x16x32_bf16 v[232:235], v[128:131], v[80:83], v[232:235]
  ds_read_b64_tr_b16 v[128:129], v7 offset:28704
  ds_read_b64_tr_b16 v[130:131], v7 offset:32288
  v_mfma_f32_16x16x32_bf16 v[184:187], v[132:135], v[76:79], v[184:187]
  v_mfma_f32_16x16x32_bf16 v[236:239], v[132:135], v[80:83], v[236:239]
  ds_read_b64_tr_b16 v[132:133], v7 offset:28736
  ds_read_b64_tr_b16 v[134:135], v7 offset:32320
  s_waitcnt lgkmcnt(15)
  v_mfma_f32_16x16x32_bf16 v[188:191], v[136:139], v[76:79], v[188:191]
  v_mfma_f32_16x16x32_bf16 v[240:243], v[136:139], v[80:83], v[240:243]
  ds_read_b64_tr_b16 v[136:137], v7 offset:28768
  ds_read_b64_tr_b16 v[138:139], v7 offset:32352
  v_mfma_f32_16x16x32_bf16 v[192:195], v[140:143], v[76:79], v[192:195]
  v_mfma_f32_16x16x32_bf16 v[244:247], v[140:143], v[80:83], v[244:247]
  ds_read_b64_tr_b16 v[140:141], v7 offset:28800
  ds_read_b64_tr_b16 v[142:143], v7 offset:32384
  v_mfma_f32_16x16x32_bf16 v[196:199], v[144:147], v[76:79], v[196:199]
  v_mfma_f32_16x16x32_bf16 v[248:251], v[144:147], v[80:83], v[248:251]
  ds_read_b64_tr_b16 v[144:145], v7 offset:28832
  ds_read_b64_tr_b16 v[146:147], v7 offset:32416
  v_mfma_f32_16x16x32_bf16 v[200:203], v[148:151], v[76:79], v[200:203]
  v_mfma_f32_16x16x32_bf16 v[252:255], v[148:151], v[80:83], v[252:255]
  ds_read_b64_tr_b16 v[148:149], v7 offset:28864
  ds_read_b64_tr_b16 v[150:151], v7 offset:32448
  s_waitcnt vmcnt(15)
  s_setprio 3
  s_barrier
  s_waitcnt lgkmcnt(8)
  v_mfma_f32_16x16x32_bf16 v[152:155], v[100:103], v[84:87], v[152:155]
  v_mfma_f32_16x16x32_bf16 v[204:207], v[100:103], v[88:91], v[204:207]
  ds_read_b64_tr_b16 v[100:101], v5 offset:43008
  ds_read_b64_tr_b16 v[102:103], v5 offset:46080
  v_mfma_f32_16x16x32_bf16 v[156:159], v[104:107], v[84:87], v[156:159]
  v_mfma_f32_16x16x32_bf16 v[208:211], v[104:107], v[88:91], v[208:211]
  ds_read_b64_tr_b16 v[104:105], v6 offset:43040
  ds_read_b64_tr_b16 v[106:107], v6 offset:46112
  s_add_u32 m0, s68, 0
  s_add_u32 s42, s42, s45
  buffer_load_dwordx4 v3, s[20:23], s42 offen lds
  v_mfma_f32_16x16x32_bf16 v[160:163], v[108:111], v[84:87], v[160:163]
  v_mfma_f32_16x16x32_bf16 v[212:215], v[108:111], v[88:91], v[212:215]
  ds_read_b64_tr_b16 v[108:109], v5 offset:43072
  ds_read_b64_tr_b16 v[110:111], v5 offset:46144
  s_add_u32 m0, s44, 0
  s_add_u32 s43, s43, s51
  buffer_load_dwordx4 v4, s[24:27], s43 offen lds
  v_mfma_f32_16x16x32_bf16 v[164:167], v[112:115], v[84:87], v[164:167]
  v_mfma_f32_16x16x32_bf16 v[216:219], v[112:115], v[88:91], v[216:219]
  ds_read_b64_tr_b16 v[112:113], v6 offset:43104
  ds_read_b64_tr_b16 v[114:115], v6 offset:46176
  v_mfma_f32_16x16x32_bf16 v[168:171], v[116:119], v[84:87], v[168:171]
  v_mfma_f32_16x16x32_bf16 v[220:223], v[116:119], v[88:91], v[220:223]
  ds_read_b64_tr_b16 v[116:117], v5 offset:43136
  ds_read_b64_tr_b16 v[118:119], v5 offset:46208
  buffer_load_dwordx4 v[76:79], v2, s[16:19], s41 offen offset:2048 sc1
  v_mfma_f32_16x16x32_bf16 v[172:175], v[120:123], v[84:87], v[172:175]
  v_mfma_f32_16x16x32_bf16 v[224:227], v[120:123], v[88:91], v[224:227]
  ds_read_b64_tr_b16 v[120:121], v6 offset:43168
  ds_read_b64_tr_b16 v[122:123], v6 offset:46240
  v_mfma_f32_16x16x32_bf16 v[176:179], v[124:127], v[84:87], v[176:179]
  s_setprio 2
  v_mfma_f32_16x16x32_bf16 v[228:231], v[124:127], v[88:91], v[228:231]
  ds_read_b64_tr_b16 v[124:125], v7 offset:43008
  ds_read_b64_tr_b16 v[126:127], v7 offset:46592
  buffer_load_dwordx4 v[80:83], v2, s[16:19], s41 offen offset:3072 sc1
  s_add_u32 s41, s41, 4096
  v_mfma_f32_16x16x32_bf16 v[180:183], v[128:131], v[84:87], v[180:183]
  v_mfma_f32_16x16x32_bf16 v[232:235], v[128:131], v[88:91], v[232:235]
  ds_read_b64_tr_b16 v[128:129], v7 offset:43040
  ds_read_b64_tr_b16 v[130:131], v7 offset:46624
  v_mfma_f32_16x16x32_bf16 v[184:187], v[132:135], v[84:87], v[184:187]
  v_mfma_f32_16x16x32_bf16 v[236:239], v[132:135], v[88:91], v[236:239]
  ds_read_b64_tr_b16 v[132:133], v7 offset:43072
  ds_read_b64_tr_b16 v[134:135], v7 offset:46656
  v_add_u32 v31, L1_cp2-L1_pc, v31
  v_min_u32 v31, L1_end-L1_pc, v31
  global_load_dword v0, v31, s[100:101]
  s_waitcnt lgkmcnt(15)
  v_mfma_f32_16x16x32_bf16 v[188:191], v[136:139], v[84:87], v[188:191]
  v_mfma_f32_16x16x32_bf16 v[240:243], v[136:139], v[88:91], v[240:243]
  ds_read_b64_tr_b16 v[136:137], v7 offset:43104
  ds_read_b64_tr_b16 v[138:139], v7 offset:46688
  v_mfma_f32_16x16x32_bf16 v[192:195], v[140:143], v[84:87], v[192:195]
  v_mfma_f32_16x16x32_bf16 v[244:247], v[140:143], v[88:91], v[244:247]
  ds_read_b64_tr_b16 v[140:141], v7 offset:43136
  ds_read_b64_tr_b16 v[142:143], v7 offset:46720
  v_mfma_f32_16x16x32_bf16 v[196:199], v[144:147], v[84:87], v[196:199]
  v_mfma_f32_16x16x32_bf16 v[248:251], v[144:147], v[88:91], v[248:251]
  ds_read_b64_tr_b16 v[144:145], v7 offset:43168
  ds_read_b64_tr_b16 v[146:147], v7 offset:46752
  v_mfma_f32_16x16x32_bf16 v[200:203], v[148:151], v[84:87], v[200:203]
  v_mfma_f32_16x16x32_bf16 v[252:255], v[148:151], v[88:91], v[252:255]
  s_setprio 1
  ds_read_b64_tr_b16 v[148:149], v7 offset:43200
  ds_read_b64_tr_b16 v[150:151], v7 offset:46784
  s_waitcnt lgkmcnt(8)
  v_mfma_f32_16x16x32_bf16 v[152:155], v[100:103], v[92:95], v[152:155]
  v_mfma_f32_16x16x32_bf16 v[204:207], v[100:103], v[96:99], v[204:207]
  ds_read_b64_tr_b16 v[100:101], v8 offset:0
  ds_read_b64_tr_b16 v[102:103], v8 offset:3072
  v_mfma_f32_16x16x32_bf16 v[156:159], v[104:107], v[92:95], v[156:159]
  v_mfma_f32_16x16x32_bf16 v[208:211], v[104:107], v[96:99], v[208:211]
  ds_read_b64_tr_b16 v[104:105], v9 offset:32
  ds_read_b64_tr_b16 v[106:107], v9 offset:3104
  s_add_u32 m0, s68, 14336
  s_add_u32 s42, s42, s45
  buffer_load_dwordx4 v3, s[20:23], s42 offen lds
  v_mfma_f32_16x16x32_bf16 v[160:163], v[108:111], v[92:95], v[160:163]
  v_mfma_f32_16x16x32_bf16 v[212:215], v[108:111], v[96:99], v[212:215]
  ds_read_b64_tr_b16 v[108:109], v8 offset:64
  ds_read_b64_tr_b16 v[110:111], v8 offset:3136
  s_add_u32 m0, s44, 14336
  s_add_u32 s43, s43, s51
  buffer_load_dwordx4 v4, s[24:27], s43 offen lds
  v_mfma_f32_16x16x32_bf16 v[164:167], v[112:115], v[92:95], v[164:167]
  v_mfma_f32_16x16x32_bf16 v[216:219], v[112:115], v[96:99], v[216:219]
  ds_read_b64_tr_b16 v[112:113], v9 offset:96
  ds_read_b64_tr_b16 v[114:115], v9 offset:3168
  v_mfma_f32_16x16x32_bf16 v[168:171], v[116:119], v[92:95], v[168:171]
  v_mfma_f32_16x16x32_bf16 v[220:223], v[116:119], v[96:99], v[220:223]
  ds_read_b64_tr_b16 v[116:117], v8 offset:128
  ds_read_b64_tr_b16 v[118:119], v8 offset:3200
  buffer_load_dwordx4 v[84:87], v2, s[16:19], s41 offen offset:0 sc1
  v_mfma_f32_16x16x32_bf16 v[172:175], v[120:123], v[92:95], v[172:175]
  v_mfma_f32_16x16x32_bf16 v[224:227], v[120:123], v[96:99], v[224:227]
  ds_read_b64_tr_b16 v[120:121], v9 offset:160
  ds_read_b64_tr_b16 v[122:123], v9 offset:3232
  v_mfma_f32_16x16x32_bf16 v[176:179], v[124:127], v[92:95], v[176:179]
  s_setprio 0
  v_mfma_f32_16x16x32_bf16 v[228:231], v[124:127], v[96:99], v[228:231]
  ds_read_b64_tr_b16 v[124:125], v10 offset:0
  ds_read_b64_tr_b16 v[126:127], v10 offset:3584
  buffer_load_dwordx4 v[88:91], v2, s[16:19], s41 offen offset:1024 sc1
  v_mfma_f32_16x16x32_bf16 v[180:183], v[128:131], v[92:95], v[180:183]
  v_mfma_f32_16x16x32_bf16 v[232:235], v[128:131], v[96:99], v[232:235]
  ds_read_b64_tr_b16 v[128:129], v10 offset:32
  ds_read_b64_tr_b16 v[130:131], v10 offset:3616
  v_mfma_f32_16x16x32_bf16 v[184:187], v[132:135], v[92:95], v[184:187]
  v_mfma_f32_16x16x32_bf16 v[236:239], v[132:135], v[96:99], v[236:239]
  ds_read_b64_tr_b16 v[132:133], v10 offset:64
  ds_read_b64_tr_b16 v[134:135], v10 offset:3648
  buffer_load_dword v0, v28, s[80:83], s84 offen
  s_add_u32 s84, s84, s85
  s_waitcnt lgkmcnt(15)
  v_mfma_f32_16x16x32_bf16 v[188:191], v[136:139], v[92:95], v[188:191]
  v_mfma_f32_16x16x32_bf16 v[240:243], v[136:139], v[96:99], v[240:243]
  ds_read_b64_tr_b16 v[136:137], v10 offset:96
  ds_read_b64_tr_b16 v[138:139], v10 offset:3680
  v_mfma_f32_16x16x32_bf16 v[192:195], v[140:143], v[92:95], v[192:195]
  v_mfma_f32_16x16x32_bf16 v[244:247], v[140:143], v[96:99], v[244:247]
  ds_read_b64_tr_b16 v[140:141], v10 offset:128
  ds_read_b64_tr_b16 v[142:143], v10 offset:3712
  v_mfma_f32_16x16x32_bf16 v[196:199], v[144:147], v[92:95], v[196:199]
  v_mfma_f32_16x16x32_bf16 v[248:251], v[144:147], v[96:99], v[248:251]
  ds_read_b64_tr_b16 v[144:145], v10 offset:160
  ds_read_b64_tr_b16 v[146:147], v10 offset:3744
  v_mfma_f32_16x16x32_bf16 v[200:203], v[148:151], v[92:95], v[200:203]
  v_mfma_f32_16x16x32_bf16 v[252:255], v[148:151], v[96:99], v[252:255]
  ds_read_b64_tr_b16 v[148:149], v10 offset:192
  ds_read_b64_tr_b16 v[150:151], v10 offset:3776
  s_waitcnt vmcnt(16)
  s_setprio 3
  s_barrier
  s_waitcnt lgkmcnt(8)
  v_mfma_f32_16x16x32_bf16 v[152:155], v[100:103], v[36:39], v[152:155]
  v_mfma_f32_16x16x32_bf16 v[204:207], v[100:103], v[40:43], v[204:207]
  ds_read_b64_tr_b16 v[100:101], v8 offset:14336
  ds_read_b64_tr_b16 v[102:103], v8 offset:17408
  v_mfma_f32_16x16x32_bf16 v[156:159], v[104:107], v[36:39], v[156:159]
  v_mfma_f32_16x16x32_bf16 v[208:211], v[104:107], v[40:43], v[208:211]
  ds_read_b64_tr_b16 v[104:105], v9 offset:14368
  ds_read_b64_tr_b16 v[106:107], v9 offset:17440
  s_add_u32 m0, s68, 28672
  s_add_u32 s42, s42, s45
  buffer_load_dwordx4 v3, s[20:23], s42 offen lds
  v_mfma_f32_16x16x32_bf16 v[160:163], v[108:111], v[36:39], v[160:163]
  v_mfma_f32_16x16x32_bf16 v[212:215], v[108:111], v[40:43], v[212:215]
  ds_read_b64_tr_b16 v[108:109], v8 offset:14400
  ds_read_b64_tr_b16 v[110:111], v8 offset:17472
  s_add_u32 m0, s44, 28672
  s_add_u32 s43, s43, s51
  buffer_load_dwordx4 v4, s[24:27], s43 offen lds
  v_mfma_f32_16x16x32_bf16 v[164:167], v[112:115], v[36:39], v[164:167]
  v_mfma_f32_16x16x32_bf16 v[216:219], v[112:115], v[40:43], v[216:219]
  ds_read_b64_tr_b16 v[112:113], v9 offset:14432
  ds_read_b64_tr_b16 v[114:115], v9 offset:17504
  v_mfma_f32_16x16x32_bf16 v[168:171], v[116:119], v[36:39], v[168:171]
  v_mfma_f32_16x16x32_bf16 v[220:223], v[116:119], v[40:43], v[220:223]
  ds_read_b64_tr_b16 v[116:117], v8 offset:14464
  ds_read_b64_tr_b16 v[118:119], v8 offset:17536
  buffer_load_dwordx4 v[92:95], v2, s[16:19], s41 offen offset:2048 sc1
  v_mfma_f32_16x16x32_bf16 v[172:175], v[120:123], v[36:39], v[172:175]
  v_mfma_f32_16x16x32_bf16 v[224:227], v[120:123], v[40:43], v[224:227]
  ds_read_b64_tr_b16 v[120:121], v9 offset:14496
  ds_read_b64_tr_b16 v[122:123], v9 offset:17568
  v_mfma_f32_16x16x32_bf16 v[176:179], v[124:127], v[36:39], v[176:179]
  s_setprio 2
  v_mfma_f32_16x16x32_bf16 v[228:231], v[124:127], v[40:43], v[228:231]
  ds_read_b64_tr_b16 v[124:125], v10 offset:14336
  ds_read_b64_tr_b16 v[126:127], v10 offset:17920
  buffer_load_dwordx4 v[96:99], v2, s[16:19], s41 offen offset:3072 sc1
  s_add_u32 s41, s41, 4096
  v_mfma_f32_16x16x32_bf16 v[180:183], v[128:131], v[36:39], v[180:183]
  v_mfma_f32_16x16x32_bf16 v[232:235], v[128:131], v[40:43], v[232:235]
  ds_read_b64_tr_b16 v[128:129], v10 offset:14368
  ds_read_b64_tr_b16 v[130:131], v10 offset:17952
  v_mfma_f32_16x16x32_bf16 v[184:187], v[132:135], v[36:39], v[184:187]
  v_mfma_f32_16x16x32_bf16 v[236:239], v[132:135], v[40:43], v[236:239]
  ds_read_b64_tr_b16 v[132:133], v10 offset:14400
  ds_read_b64_tr_b16 v[134:135], v10 offset:17984
  s_waitcnt lgkmcnt(15)
  v_mfma_f32_16x16x32_bf16 v[188:191], v[136:139], v[36:39], v[188:191]
  v_mfma_f32_16x16x32_bf16 v[240:243], v[136:139], v[40:43], v[240:243]
  ds_read_b64_tr_b16 v[136:137], v10 offset:14432
  ds_read_b64_tr_b16 v[138:139], v10 offset:18016
  v_mfma_f32_16x16x32_bf16 v[192:195], v[140:143], v[36:39], v[192:195]
  v_mfma_f32_16x16x32_bf16 v[244:247], v[140:143], v[40:43], v[244:247]
  ds_read_b64_tr_b16 v[140:141], v10 offset:14464
  ds_read_b64_tr_b16 v[142:143], v10 offset:18048
  v_mfma_f32_16x16x32_bf16 v[196:199], v[144:147], v[36:39], v[196:199]
  v_mfma_f32_16x16x32_bf16 v[248:251], v[144:147], v[40:43], v[248:251]
  ds_read_b64_tr_b16 v[144:145], v10 offset:14496
  ds_read_b64_tr_b16 v[146:147], v10 offset:18080
  v_mfma_f32_16x16x32_bf16 v[200:203], v[148:151], v[36:39], v[200:203]
  v_mfma_f32_16x16x32_bf16 v[252:255], v[148:151], v[40:43], v[252:255]
  s_setprio 1
  ds_read_b64_tr_b16 v[148:149], v10 offset:14528
  ds_read_b64_tr_b16 v[150:151], v10 offset:18112
  s_waitcnt lgkmcnt(8)
  v_mfma_f32_16x16x32_bf16 v[152:155], v[100:103], v[44:47], v[152:155]
  v_mfma_f32_16x16x32_bf16 v[204:207], v[100:103], v[48:51], v[204:207]
  ds_read_b64_tr_b16 v[100:101], v8 offset:28672
  ds_read_b64_tr_b16 v[102:103], v8 offset:31744
  v_mfma_f32_16x16x32_bf16 v[156:159], v[104:107], v[44:47], v[156:159]
  v_mfma_f32_16x16x32_bf16 v[208:211], v[104:107], v[48:51], v[208:211]
  ds_read_b64_tr_b16 v[104:105], v9 offset:28704
  ds_read_b64_tr_b16 v[106:107], v9 offset:31776
  s_add_u32 m0, s68, 43008
  s_add_u32 s42, s42, s45
  buffer_load_dwordx4 v3, s[20:23], s42 offen lds
  v_mfma_f32_16x16x32_bf16 v[160:163], v[108:111], v[44:47], v[160:163]
  v_mfma_f32_16x16x32_bf16 v[212:215], v[108:111], v[48:51], v[212:215]
  ds_read_b64_tr_b16 v[108:109], v8 offset:28736
  ds_read_b64_tr_b16 v[110:111], v8 offset:31808
  s_add_u32 m0, s44, 43008
  s_add_u32 s43, s43, s51
  buffer_load_dwordx4 v4, s[24:27], s43 offen lds
  v_mfma_f32_16x16x32_bf16 v[164:167], v[112:115], v[44:47], v[164:167]
  v_mfma_f32_16x16x32_bf16 v[216:219], v[112:115], v[48:51], v[216:219]
  ds_read_b64_tr_b16 v[112:113], v9 offset:28768
  ds_read_b64_tr_b16 v[114:115], v9 offset:31840
  v_mfma_f32_16x16x32_bf16 v[168:171], v[116:119], v[44:47], v[168:171]
  v_mfma_f32_16x16x32_bf16 v[220:223], v[116:119], v[48:51], v[220:223]
  ds_read_b64_tr_b16 v[116:117], v8 offset:28800
  ds_read_b64_tr_b16 v[118:119], v8 offset:31872
  buffer_load_dwordx4 v[36:39], v2, s[16:19], s41 offen offset:0 sc1
  v_mfma_f32_16x16x32_bf16 v[172:175], v[120:123], v[44:47], v[172:175]
  v_mfma_f32_16x16x32_bf16 v[224:227], v[120:123], v[48:51], v[224:227]
  ds_read_b64_tr_b16 v[120:121], v9 offset:28832
  ds_read_b64_tr_b16 v[122:123], v9 offset:31904
  v_mfma_f32_16x16x32_bf16 v[176:179], v[124:127], v[44:47], v[176:179]
  s_setprio 0
  v_mfma_f32_16x16x32_bf16 v[228:231], v[124:127], v[48:51], v[228:231]
  ds_read_b64_tr_b16 v[124:125], v10 offset:28672
  ds_read_b64_tr_b16 v[126:127], v10 offset:32256
  buffer_load_dwordx4 v[40:43], v2, s[16:19], s41 offen offset:1024 sc1
  v_mfma_f32_16x16x32_bf16 v[180:183], v[128:131], v[44:47], v[180:183]
  v_mfma_f32_16x16x32_bf16 v[232:235], v[128:131], v[48:51], v[232:235]
  ds_read_b64_tr_b16 v[128:129], v10 offset:28704
  ds_read_b64_tr_b16 v[130:131], v10 offset:32288
  v_mfma_f32_16x16x32_bf16 v[184:187], v[132:135], v[44:47], v[184:187]
  v_mfma_f32_16x16x32_bf16 v[236:239], v[132:135], v[48:51], v[236:239]
  ds_read_b64_tr_b16 v[132:133], v10 offset:28736
  ds_read_b64_tr_b16 v[134:135], v10 offset:32320
  s_waitcnt lgkmcnt(15)
  v_mfma_f32_16x16x32_bf16 v[188:191], v[136:139], v[44:47], v[188:191]
  v_mfma_f32_16x16x32_bf16 v[240:243], v[136:139], v[48:51], v[240:243]
  ds_read_b64_tr_b16 v[136:137], v10 offset:28768
  ds_read_b64_tr_b16 v[138:139], v10 offset:32352
  v_mfma_f32_16x16x32_bf16 v[192:195], v[140:143], v[44:47], v[192:195]
  v_mfma_f32_16x16x32_bf16 v[244:247], v[140:143], v[48:51], v[244:247]
  ds_read_b64_tr_b16 v[140:141], v10 offset:28800
  ds_read_b64_tr_b16 v[142:143], v10 offset:32384
  v_mfma_f32_16x16x32_bf16 v[196:199], v[144:147], v[44:47], v[196:199]
  v_mfma_f32_16x16x32_bf16 v[248:251], v[144:147], v[48:51], v[248:251]
  ds_read_b64_tr_b16 v[144:145], v10 offset:28832
  ds_read_b64_tr_b16 v[146:147], v10 offset:32416
  v_mfma_f32_16x16x32_bf16 v[200:203], v[148:151], v[44:47], v[200:203]
  v_mfma_f32_16x16x32_bf16 v[252:255], v[148:151], v[48:51], v[252:255]
  ds_read_b64_tr_b16 v[148:149], v10 offset:28864
  ds_read_b64_tr_b16 v[150:151], v10 offset:32448
  s_waitcnt vmcnt(16)
  s_setprio 3
  s_barrier
  s_waitcnt lgkmcnt(8)
  v_mfma_f32_16x16x32_bf16 v[152:155], v[100:103], v[52:55], v[152:155]
  v_mfma_f32_16x16x32_bf16 v[204:207], v[100:103], v[56:59], v[204:207]
  ds_read_b64_tr_b16 v[100:101], v8 offset:43008
  ds_read_b64_tr_b16 v[102:103], v8 offset:46080
  v_mfma_f32_16x16x32_bf16 v[156:159], v[104:107], v[52:55], v[156:159]
  v_mfma_f32_16x16x32_bf16 v[208:211], v[104:107], v[56:59], v[208:211]
  ds_read_b64_tr_b16 v[104:105], v9 offset:43040
  ds_read_b64_tr_b16 v[106:107], v9 offset:46112
  s_add_u32 m0, s68, 57344
  s_add_u32 s42, s42, s45
  buffer_load_dwordx4 v3, s[20:23], s42 offen lds
  v_mfma_f32_16x16x32_bf16 v[160:163], v[108:111], v[52:55], v[160:163]
  v_mfma_f32_16x16x32_bf16 v[212:215], v[108:111], v[56:59], v[212:215]
  ds_read_b64_tr_b16 v[108:109], v8 offset:43072
  ds_read_b64_tr_b16 v[110:111], v8 offset:46144
  s_add_u32 m0, s44, 57344
  s_add_u32 s43, s43, s51
  buffer_load_dwordx4 v4, s[24:27], s43 offen lds
  v_mfma_f32_16x16x32_bf16 v[164:167], v[112:115], v[52:55], v[164:167]
  v_mfma_f32_16x16x32_bf16 v[216:219], v[112:115], v[56:59], v[216:219]
  ds_read_b64_tr_b16 v[112:113], v9 offset:43104
  ds_read_b64_tr_b16 v[114:115], v9 offset:46176
  v_mfma_f32_16x16x32_bf16 v[168:171], v[116:119], v[52:55], v[168:171]
  v_mfma_f32_16x16x32_bf16 v[220:223], v[116:119], v[56:59], v[220:223]
  ds_read_b64_tr_b16 v[116:117], v8 offset:43136
  ds_read_b64_tr_b16 v[118:119], v8 offset:46208
  buffer_load_dwordx4 v[44:47], v2, s[16:19], s41 offen offset:2048 sc1
  v_mfma_f32_16x16x32_bf16 v[172:175], v[120:123], v[52:55], v[172:175]
  v_mfma_f32_16x16x32_bf16 v[224:227], v[120:123], v[56:59], v[224:227]
  ds_read_b64_tr_b16 v[120:121], v9 offset:43168
  ds_read_b64_tr_b16 v[122:123], v9 offset:46240
  v_mfma_f32_16x16x32_bf16 v[176:179], v[124:127], v[52:55], v[176:179]
  s_setprio 2
  v_mfma_f32_16x16x32_bf16 v[228:231], v[124:127], v[56:59], v[228:231]
  ds_read_b64_tr_b16 v[124:125], v10 offset:43008
  ds_read_b64_tr_b16 v[126:127], v10 offset:46592
  buffer_load_dwordx4 v[48:51], v2, s[16:19], s41 offen offset:3072 sc1
  s_add_u32 s41, s41, 4096
  v_mfma_f32_16x16x32_bf16 v[180:183], v[128:131], v[52:55], v[180:183]
  v_mfma_f32_16x16x32_bf16 v[232:235], v[128:131], v[56:59], v[232:235]
  ds_read_b64_tr_b16 v[128:129], v10 offset:43040
  ds_read_b64_tr_b16 v[130:131], v10 offset:46624
  v_mfma_f32_16x16x32_bf16 v[184:187], v[132:135], v[52:55], v[184:187]
  v_mfma_f32_16x16x32_bf16 v[236:239], v[132:135], v[56:59], v[236:239]
  ds_read_b64_tr_b16 v[132:133], v10 offset:43072
  ds_read_b64_tr_b16 v[134:135], v10 offset:46656
  s_waitcnt lgkmcnt(15)
  v_mfma_f32_16x16x32_bf16 v[188:191], v[136:139], v[52:55], v[188:191]
  v_mfma_f32_16x16x32_bf16 v[240:243], v[136:139], v[56:59], v[240:243]
  ds_read_b64_tr_b16 v[136:137], v10 offset:43104
  ds_read_b64_tr_b16 v[138:139], v10 offset:46688
  v_mfma_f32_16x16x32_bf16 v[192:195], v[140:143], v[52:55], v[192:195]
  v_mfma_f32_16x16x32_bf16 v[244:247], v[140:143], v[56:59], v[244:247]
  ds_read_b64_tr_b16 v[140:141], v10 offset:43136
  ds_read_b64_tr_b16 v[142:143], v10 offset:46720
  v_mfma_f32_16x16x32_bf16 v[196:199], v[144:147], v[52:55], v[196:199]
  v_mfma_f32_16x16x32_bf16 v[248:251], v[144:147], v[56:59], v[248:251]
  ds_read_b64_tr_b16 v[144:145], v10 offset:43168
  ds_read_b64_tr_b16 v[146:147], v10 offset:46752
  v_mfma_f32_16x16x32_bf16 v[200:203], v[148:151], v[52:55], v[200:203]
  v_mfma_f32_16x16x32_bf16 v[252:255], v[148:151], v[56:59], v[252:255]
  s_setprio 1
  ds_read_b64_tr_b16 v[148:149], v10 offset:43200
  ds_read_b64_tr_b16 v[150:151], v10 offset:46784
  s_waitcnt lgkmcnt(8)
  v_mfma_f32_16x16x32_bf16 v[152:155], v[100:103], v[60:63], v[152:155]
  v_mfma_f32_16x16x32_bf16 v[204:207], v[100:103], v[64:67], v[204:207]
  ds_read_b64_tr_b16 v[100:101], v5 offset:0
  ds_read_b64_tr_b16 v[102:103], v5 offset:3072
  v_mfma_f32_16x16x32_bf16 v[156:159], v[104:107], v[60:63], v[156:159]
  v_mfma_f32_16x16x32_bf16 v[208:211], v[104:107], v[64:67], v[208:211]
  ds_read_b64_tr_b16 v[104:105], v6 offset:32
  ds_read_b64_tr_b16 v[106:107], v6 offset:3104
  s_add_u32 m0, s68, 71680
  s_add_u32 s42, s42, s45
  buffer_load_dwordx4 v3, s[20:23], s42 offen lds
  v_mfma_f32_16x16x32_bf16 v[160:163], v[108:111], v[60:63], v[160:163]
  v_mfma_f32_16x16x32_bf16 v[212:215], v[108:111], v[64:67], v[212:215]
  ds_read_b64_tr_b16 v[108:109], v5 offset:64
  ds_read_b64_tr_b16 v[110:111], v5 offset:3136
  s_add_u32 m0, s44, 71680
  s_add_u32 s43, s43, s51
  buffer_load_dwordx4 v4, s[24:27], s43 offen lds
  v_mfma_f32_16x16x32_bf16 v[164:167], v[112:115], v[60:63], v[164:167]
  v_mfma_f32_16x16x32_bf16 v[216:219], v[112:115], v[64:67], v[216:219]
  ds_read_b64_tr_b16 v[112:113], v6 offset:96
  ds_read_b64_tr_b16 v[114:115], v6 offset:3168
  v_mfma_f32_16x16x32_bf16 v[168:171], v[116:119], v[60:63], v[168:171]
  v_mfma_f32_16x16x32_bf16 v[220:223], v[116:119], v[64:67], v[220:223]
  ds_read_b64_tr_b16 v[116:117], v5 offset:128
  ds_read_b64_tr_b16 v[118:119], v5 offset:3200
  buffer_load_dwordx4 v[52:55], v2, s[16:19], s41 offen offset:0 sc1
  v_mfma_f32_16x16x32_bf16 v[172:175], v[120:123], v[60:63], v[172:175]
  v_mfma_f32_16x16x32_bf16 v[224:227], v[120:123], v[64:67], v[224:227]
  ds_read_b64_tr_b16 v[120:121], v6 offset:160
  ds_read_b64_tr_b16 v[122:123], v6 offset:3232
  v_mfma_f32_16x16x32_bf16 v[176:179], v[124:127], v[60:63], v[176:179]
  s_setprio 0
  v_mfma_f32_16x16x32_bf16 v[228:231], v[124:127], v[64:67], v[228:231]
  ds_read_b64_tr_b16 v[124:125], v7 offset:0
  ds_read_b64_tr_b16 v[126:127], v7 offset:3584
  buffer_load_dwordx4 v[56:59], v2, s[16:19], s41 offen offset:1024 sc1
  v_mfma_f32_16x16x32_bf16 v[180:183], v[128:131], v[60:63], v[180:183]
  v_mfma_f32_16x16x32_bf16 v[232:235], v[128:131], v[64:67], v[232:235]
  ds_read_b64_tr_b16 v[128:129], v7 offset:32
  ds_read_b64_tr_b16 v[130:131], v7 offset:3616
  v_mfma_f32_16x16x32_bf16 v[184:187], v[132:135], v[60:63], v[184:187]
  v_mfma_f32_16x16x32_bf16 v[236:239], v[132:135], v[64:67], v[236:239]
  ds_read_b64_tr_b16 v[132:133], v7 offset:64
  ds_read_b64_tr_b16 v[134:135], v7 offset:3648
  buffer_load_dword v0, v28, s[80:83], s84 offen
  s_add_u32 s84, s84, s85
  s_waitcnt lgkmcnt(15)
  v_mfma_f32_16x16x32_bf16 v[188:191], v[136:139], v[60:63], v[188:191]
  v_mfma_f32_16x16x32_bf16 v[240:243], v[136:139], v[64:67], v[240:243]
  ds_read_b64_tr_b16 v[136:137], v7 offset:96
  ds_read_b64_tr_b16 v[138:139], v7 offset:3680
  v_mfma_f32_16x16x32_bf16 v[192:195], v[140:143], v[60:63], v[192:195]
  v_mfma_f32_16x16x32_bf16 v[244:247], v[140:143], v[64:67], v[244:247]
  ds_read_b64_tr_b16 v[140:141], v7 offset:128
  ds_read_b64_tr_b16 v[142:143], v7 offset:3712
  v_mfma_f32_16x16x32_bf16 v[196:199], v[144:147], v[60:63], v[196:199]
  v_mfma_f32_16x16x32_bf16 v[248:251], v[144:147], v[64:67], v[248:251]
  ds_read_b64_tr_b16 v[144:145], v7 offset:160
  ds_read_b64_tr_b16 v[146:147], v7 offset:3744
  v_mfma_f32_16x16x32_bf16 v[200:203], v[148:151], v[60:63], v[200:203]
  v_mfma_f32_16x16x32_bf16 v[252:255], v[148:151], v[64:67], v[252:255]
  ds_read_b64_tr_b16 v[148:149], v7 offset:192
  ds_read_b64_tr_b16 v[150:151], v7 offset:3776
L1_cp2:
  s_waitcnt vmcnt(15)
  s_setprio 3
  s_barrier
  s_waitcnt lgkmcnt(8)
  v_mfma_f32_16x16x32_bf16 v[152:155], v[100:103], v[68:71], v[152:155]
  ds_read_b64_tr_b16 v[28:29], v11 offset:0
  v_mfma_f32_16x16x32_bf16 v[204:207], v[100:103], v[72:75], v[204:207]
  ds_read_b64_tr_b16 v[100:101], v5 offset:14336
  ds_read_b64_tr_b16 v[102:103], v5 offset:17408
  v_mfma_f32_16x16x32_bf16 v[156:159], v[104:107], v[68:71], v[156:159]
  v_mfma_f32_16x16x32_bf16 v[208:211], v[104:107], v[72:75], v[208:211]
  ds_read_b64_tr_b16 v[104:105], v6 offset:14368
  ds_read_b64_tr_b16 v[106:107], v6 offset:17440
  s_add_u32 m0, s68, 86016
  s_add_u32 s42, s42, s45
  buffer_load_dwordx4 v3, s[20:23], s42 offen lds
  v_mfma_f32_16x16x32_bf16 v[160:163], v[108:111], v[68:71], v[160:163]
  v_mfma_f32_16x16x32_bf16 v[212:215], v[108:111], v[72:75], v[212:215]
  ds_read_b64_tr_b16 v[108:109], v5 offset:14400
  ds_read_b64_tr_b16 v[110:111], v5 offset:17472
  s_add_u32 m0, s44, 86016
  s_add_u32 s43, s43, s51
  buffer_load_dwordx4 v4, s[24:27], s43 offen lds
  v_mfma_f32_16x16x32_bf16 v[164:167], v[112:115], v[68:71], v[164:167]
  v_mfma_f32_16x16x32_bf16 v[216:219], v[112:115], v[72:75], v[216:219]
  ds_read_b64_tr_b16 v[112:113], v6 offset:14432
  ds_read_b64_tr_b16 v[114:115], v6 offset:17504
  v_mfma_f32_16x16x32_bf16 v[168:171], v[116:119], v[68:71], v[168:171]
  v_mfma_f32_16x16x32_bf16 v[220:223], v[116:119], v[72:75], v[220:223]
  ds_read_b64_tr_b16 v[116:117], v5 offset:14464
  ds_read_b64_tr_b16 v[118:119], v5 offset:17536
  buffer_load_dwordx4 v[60:63], v2, s[16:19], s41 offen offset:2048 sc1
  v_mfma_f32_16x16x32_bf16 v[172:175], v[120:123], v[68:71], v[172:175]
  v_mfma_f32_16x16x32_bf16 v[224:227], v[120:123], v[72:75], v[224:227]
  ds_read_b64_tr_b16 v[120:121], v6 offset:14496
  ds_read_b64_tr_b16 v[122:123], v6 offset:17568
  v_mfma_f32_16x16x32_bf16 v[176:179], v[124:127], v[68:71], v[176:179]
  s_setprio 2
  v_mfma_f32_16x16x32_bf16 v[228:231], v[124:127], v[72:75], v[228:231]
  ds_read_b64_tr_b16 v[30:31], v11 offset:1024
  ds_read_b64_tr_b16 v[124:125], v7 offset:14336
  ds_read_b64_tr_b16 v[126:127], v7 offset:17920
  buffer_load_dwordx4 v[64:67], v2, s[16:19], s41 offen offset:3072 sc1
  s_add_u32 s41, s41, 4096
  v_mfma_f32_16x16x32_bf16 v[180:183], v[128:131], v[68:71], v[180:183]
  v_mfma_f32_16x16x32_bf16 v[232:235], v[128:131], v[72:75], v[232:235]
  ds_read_b64_tr_b16 v[128:129], v7 offset:14368
  ds_read_b64_tr_b16 v[130:131], v7 offset:17952
  v_mfma_f32_16x16x32_bf16 v[184:187], v[132:135], v[68:71], v[184:187]
  v_mfma_f32_16x16x32_bf16 v[236:239], v[132:135], v[72:75], v[236:239]
  ds_read_b64_tr_b16 v[132:133], v7 offset:14400
  ds_read_b64_tr_b16 v[134:135], v7 offset:17984
  s_waitcnt lgkmcnt(15)
  v_mfma_f32_16x16x32_bf16 v[188:191], v[136:139], v[68:71], v[188:191]
  v_mfma_f32_16x16x32_bf16 v[240:243], v[136:139], v[72:75], v[240:243]
  ds_read_b64_tr_b16 v[136:137], v7 offset:14432
  ds_read_b64_tr_b16 v[138:139], v7 offset:18016
  v_mfma_f32_16x16x32_bf16 v[192:195], v[140:143], v[68:71], v[192:195]
  v_mfma_f32_16x16x32_bf16 v[244:247], v[140:143], v[72:75], v[244:247]
  ds_read_b64_tr_b16 v[140:141], v7 offset:14464
  ds_read_b64_tr_b16 v[142:143], v7 offset:18048
  v_mfma_f32_16x16x32_bf16 v[196:199], v[144:147], v[68:71], v[196:199]
  v_mfma_f32_16x16x32_bf16 v[248:251], v[144:147], v[72:75], v[248:251]
  ds_read_b64_tr_b16 v[144:145], v7 offset:14496
  ds_read_b64_tr_b16 v[146:147], v7 offset:18080
  v_mfma_f32_16x16x32_bf16 v[200:203], v[148:151], v[68:71], v[200:203]
  v_mfma_f32_16x16x32_bf16 v[252:255], v[148:151], v[72:75], v[252:255]
  s_setprio 1
  ds_read_b64_tr_b16 v[148:149], v7 offset:14528
  ds_read_b64_tr_b16 v[150:151], v7 offset:18112
  s_waitcnt lgkmcnt(8)
  v_mfma_f32_16x16x32_bf16 v[152:155], v[100:103], v[76:79], v[152:155]
  ds_read_b64_tr_b16 v[32:33], v11 offset:32
  v_mfma_f32_16x16x32_bf16 v[204:207], v[100:103], v[80:83], v[204:207]
  ds_read_b64_tr_b16 v[100:101], v5 offset:28672
  ds_read_b64_tr_b16 v[102:103], v5 offset:31744
  v_mfma_f32_16x16x32_bf16 v[156:159], v[104:107], v[76:79], v[156:159]
  v_mfma_f32_16x16x32_bf16 v[208:211], v[104:107], v[80:83], v[208:211]
  ds_read_b64_tr_b16 v[104:105], v6 offset:28704
  ds_read_b64_tr_b16 v[106:107], v6 offset:31776
  s_add_u32 m0, s68, 100352
  s_add_u32 s42, s42, s45
  buffer_load_dwordx4 v3, s[20:23], s42 offen lds
  v_mfma_f32_16x16x32_bf16 v[160:163], v[108:111], v[76:79], v[160:163]
  v_mfma_f32_16x16x32_bf16 v[212:215], v[108:111], v[80:83], v[212:215]
  ds_read_b64_tr_b16 v[108:109], v5 offset:28736
  ds_read_b64_tr_b16 v[110:111], v5 offset:31808
  s_add_u32 m0, s44, 100352
  s_add_u32 s43, s43, s51
  buffer_load_dwordx4 v4, s[24:27], s43 offen lds
  v_mfma_f32_16x16x32_bf16 v[164:167], v[112:115], v[76:79], v[164:167]
  v_mfma_f32_16x16x32_bf16 v[216:219], v[112:115], v[80:83], v[216:219]
  ds_read_b64_tr_b16 v[112:113], v6 offset:28768
  ds_read_b64_tr_b16 v[114:115], v6 offset:31840
  v_mfma_f32_16x16x32_bf16 v[168:171], v[116:119], v[76:79], v[168:171]
  v_mfma_f32_16x16x32_bf16 v[220:223], v[116:119], v[80:83], v[220:223]
  ds_read_b64_tr_b16 v[116:117], v5 offset:28800
  ds_read_b64_tr_b16 v[118:119], v5 offset:31872
  buffer_load_dwordx4 v[68:71], v2, s[16:19], s41 offen offset:0 sc1
  v_mfma_f32_16x16x32_bf16 v[172:175], v[120:123], v[76:79], v[172:175]
  v_mfma_f32_16x16x32_bf16 v[224:227], v[120:123], v[80:83], v[224:227]
  ds_read_b64_tr_b16 v[120:121], v6 offset:28832
  ds_read_b64_tr_b16 v[122:123], v6 offset:31904
  v_mfma_f32_16x16x32_bf16 v[176:179], v[124:127], v[76:79], v[176:179]
  s_setprio 0
  v_mfma_f32_16x16x32_bf16 v[228:231], v[124:127], v[80:83], v[228:231]
  ds_read_b64_tr_b16 v[34:35], v11 offset:1056
  ds_read_b64_tr_b16 v[124:125], v7 offset:28672
  ds_read_b64_tr_b16 v[126:127], v7 offset:32256
  buffer_load_dwordx4 v[72:75], v2, s[16:19], s41 offen offset:1024 sc1
  v_mfma_f32_16x16x32_bf16 v[180:183], v[128:131], v[76:79], v[180:183]
  v_mfma_f32_16x16x32_bf16 v[232:235], v[128:131], v[80:83], v[232:235]
  ds_read_b64_tr_b16 v[128:129], v7 offset:28704
  ds_read_b64_tr_b16 v[130:131], v7 offset:32288
  v_mfma_f32_16x16x32_bf16 v[184:187], v[132:135], v[76:79], v[184:187]
  v_mfma_f32_16x16x32_bf16 v[236:239], v[132:135], v[80:83], v[236:239]
  ds_read_b64_tr_b16 v[132:133], v7 offset:28736
  ds_read_b64_tr_b16 v[134:135], v7 offset:32320
  s_waitcnt lgkmcnt(15)
  v_mfma_f32_16x16x32_bf16 v[188:191], v[136:139], v[76:79], v[188:191]
  v_mfma_f32_16x16x32_bf16 v[240:243], v[136:139], v[80:83], v[240:243]
  ds_read_b64_tr_b16 v[136:137], v7 offset:28768
  ds_read_b64_tr_b16 v[138:139], v7 offset:32352
  v_mfma_f32_16x16x32_bf16 v[192:195], v[140:143], v[76:79], v[192:195]
  v_mfma_f32_16x16x32_bf16 v[244:247], v[140:143], v[80:83], v[244:247]
  ds_read_b64_tr_b16 v[140:141], v7 offset:28800
  ds_read_b64_tr_b16 v[142:143], v7 offset:32384
  v_mfma_f32_16x16x32_bf16 v[196:199], v[144:147], v[76:79], v[196:199]
  v_mfma_f32_16x16x32_bf16 v[248:251], v[144:147], v[80:83], v[248:251]
  ds_read_b64_tr_b16 v[144:145], v7 offset:28832
  ds_read_b64_tr_b16 v[146:147], v7 offset:32416
  v_mfma_f32_16x16x32_bf16 v[200:203], v[148:151], v[76:79], v[200:203]
  v_mfma_f32_16x16x32_bf16 v[252:255], v[148:151], v[80:83], v[252:255]
  ds_read_b64_tr_b16 v[148:149], v7 offset:28864
  ds_read_b64_tr_b16 v[150:151], v7 offset:32448
  s_waitcnt vmcnt(15)
  s_setprio 3
  s_barrier
  s_waitcnt lgkmcnt(8)
  v_mfma_f32_16x16x32_bf16 v[152:155], v[100:103], v[84:87], v[152:155]
  s_mul_i32 s48, s2, 28672
  v_mfma_f32_16x16x32_bf16 v[204:207], v[100:103], v[88:91], v[204:207]
  ds_read_b64_tr_b16 v[100:101], v5 offset:43008
  ds_read_b64_tr_b16 v[102:103], v5 offset:46080
  v_mfma_f32_16x16x32_bf16 v[156:159], v[104:107], v[84:87], v[156:159]
  s_lshl_b32 s49, s36, 12
  v_mfma_f32_16x16x32_bf16 v[208:211], v[104:107], v[88:91], v[208:211]
  ds_read_b64_tr_b16 v[104:105], v6 offset:43040
  ds_read_b64_tr_b16 v[106:107], v6 offset:46112
  s_add_u32 m0, s68, 0
  s_add_u32 s42, s42, s45
  buffer_load_dwordx4 v3, s[20:23], s42 offen lds
  v_mfma_f32_16x16x32_bf16 v[160:163], v[108:111], v[84:87], v[160:163]
  s_add_u32 s48, s48, s49
  v_mfma_f32_16x16x32_bf16 v[212:215], v[108:111], v[88:91], v[212:215]
  ds_read_b64_tr_b16 v[108:109], v5 offset:43072
  ds_read_b64_tr_b16 v[110:111], v5 offset:46144
  s_add_u32 m0, s44, 0
  s_add_u32 s43, s43, s51
  buffer_load_dwordx4 v4, s[24:27], s43 offen lds
  v_mfma_f32_16x16x32_bf16 v[164:167], v[112:115], v[84:87], v[164:167]
  s_lshl_b32 s49, s2, 13
  v_mfma_f32_16x16x32_bf16 v[216:219], v[112:115], v[88:91], v[216:219]
  ds_read_b64_tr_b16 v[112:113], v6 offset:43104
  ds_read_b64_tr_b16 v[114:115], v6 offset:46176
  v_mfma_f32_16x16x32_bf16 v[168:171], v[116:119], v[84:87], v[168:171]
  s_cmp_eq_u32 s36, 7
  s_cselect_b32 s52, s60, s14
  s_cselect_b32 s53, s61, s15
  s_mov_b32 s54, 7340032
  s_cselect_b32 s54, 2097152, s54
  s_cselect_b32 s58, s49, s48
  s_cselect_b32 s49, 64, 32
  v_mfma_f32_16x16x32_bf16 v[220:223], v[116:119], v[88:91], v[220:223]
  ds_read_b64_tr_b16 v[116:117], v5 offset:43136
  ds_read_b64_tr_b16 v[118:119], v5 offset:46208
  buffer_load_dwordx4 v[76:79], v2, s[16:19], s41 offen offset:2048 sc1
  v_mfma_f32_16x16x32_bf16 v[172:175], v[120:123], v[84:87], v[172:175]
  v_mfma_f32_16x16x32_bf16 v[224:227], v[120:123], v[88:91], v[224:227]
  ds_read_b64_tr_b16 v[120:121], v6 offset:43168
  ds_read_b64_tr_b16 v[122:123], v6 offset:46240
  v_mfma_f32_16x16x32_bf16 v[176:179], v[124:127], v[84:87], v[176:179]
  s_setprio 2
  v_mfma_f32_16x16x32_bf16 v[228:231], v[124:127], v[88:91], v[228:231]
  ds_read_b64_tr_b16 v[124:125], v7 offset:43008
  ds_read_b64_tr_b16 v[126:127], v7 offset:46592
  buffer_load_dwordx4 v[80:83], v2, s[16:19], s41 offen offset:3072 sc1
  s_add_u32 s41, s41, 4096
  v_mfma_f32_16x16x32_bf16 v[180:183], v[128:131], v[84:87], v[180:183]
  v_mfma_f32_16x16x32_bf16 v[232:235], v[128:131], v[88:91], v[232:235]
  ds_read_b64_tr_b16 v[128:129], v7 offset:43040
  ds_read_b64_tr_b16 v[130:131], v7 offset:46624
  v_mfma_f32_16x16x32_bf16 v[184:187], v[132:135], v[84:87], v[184:187]
  v_mfma_f32_16x16x32_bf16 v[236:239], v[132:135], v[88:91], v[236:239]
  ds_read_b64_tr_b16 v[132:133], v7 offset:43072
  ds_read_b64_tr_b16 v[134:135], v7 offset:46656
  s_waitcnt lgkmcnt(15)
  v_mfma_f32_16x16x32_bf16 v[188:191], v[136:139], v[84:87], v[188:191]
  v_mfma_f32_16x16x32_bf16 v[240:243], v[136:139], v[88:91], v[240:243]
  ds_read_b64_tr_b16 v[136:137], v7 offset:43104
  ds_read_b64_tr_b16 v[138:139], v7 offset:46688
  v_mfma_f32_16x16x32_bf16 v[192:195], v[140:143], v[84:87], v[192:195]
  v_mfma_f32_16x16x32_bf16 v[244:247], v[140:143], v[88:91], v[244:247]
  ds_read_b64_tr_b16 v[140:141], v7 offset:43136
  ds_read_b64_tr_b16 v[142:143], v7 offset:46720
  v_mfma_f32_16x16x32_bf16 v[196:199], v[144:147], v[84:87], v[196:199]
  v_mfma_f32_16x16x32_bf16 v[248:251], v[144:147], v[88:91], v[248:251]
  s_lshl_b32 s90, s49, 7
  ds_read_b64_tr_b16 v[144:145], v7 offset:43168
  ds_read_b64_tr_b16 v[146:147], v7 offset:46752
  v_mfma_f32_16x16x32_bf16 v[200:203], v[148:151], v[84:87], v[200:203]
  v_mfma_f32_16x16x32_bf16 v[252:255], v[148:151], v[88:91], v[252:255]
  s_setprio 1
  ds_read_b64_tr_b16 v[148:149], v7 offset:43200
  ds_read_b64_tr_b16 v[150:151], v7 offset:46784
  s_waitcnt lgkmcnt(8)
  v_mfma_f32_16x16x32_bf16 v[152:155], v[100:103], v[92:95], v[152:155]
  s_mov_b32 s55, 0x20000
  v_mfma_f32_16x16x32_bf16 v[204:207], v[100:103], v[96:99], v[204:207]
  ds_read_b64_tr_b16 v[100:101], v8 offset:0
  ds_read_b64_tr_b16 v[102:103], v8 offset:3072
  v_mfma_f32_16x16x32_bf16 v[156:159], v[104:107], v[92:95], v[156:159]
  v_lshlrev_b32 v11, 7, v1
  v_mfma_f32_16x16x32_bf16 v[208:211], v[104:107], v[96:99], v[208:211]
  ds_read_b64_tr_b16 v[104:105], v9 offset:32
  ds_read_b64_tr_b16 v[106:107], v9 offset:3104
  s_add_u32 m0, s68, 14336
  s_add_u32 s42, s42, s45
  buffer_load_dwordx4 v3, s[20:23], s42 offen lds
  v_mfma_f32_16x16x32_bf16 v[160:163], v[108:111], v[92:95], v[160:163]
  v_mfma_f32_16x16x32_bf16 v[212:215], v[108:111], v[96:99], v[212:215]
  ds_read_b64_tr_b16 v[108:109], v8 offset:64
  ds_read_b64_tr_b16 v[110:111], v8 offset:3136
  s_add_u32 m0, s44, 14336
  s_add_u32 s43, s43, s51
  buffer_load_dwordx4 v4, s[24:27], s43 offen lds
  v_mfma_f32_16x16x32_bf16 v[164:167], v[112:115], v[92:95], v[164:167]
  v_mov_b32 v12, 2130706432
  v_mfma_f32_16x16x32_bf16 v[216:219], v[112:115], v[96:99], v[216:219]
  ds_read_b64_tr_b16 v[112:113], v9 offset:96
  ds_read_b64_tr_b16 v[114:115], v9 offset:3168
  v_mfma_f32_16x16x32_bf16 v[168:171], v[116:119], v[92:95], v[168:171]
  v_mfma_f32_16x16x32_bf16 v[220:223], v[116:119], v[96:99], v[220:223]
  ds_read_b64_tr_b16 v[116:117], v8 offset:128
  ds_read_b64_tr_b16 v[118:119], v8 offset:3200
  buffer_load_dwordx4 v[84:87], v2, s[16:19], s41 offen offset:0 sc1
  v_mfma_f32_16x16x32_bf16 v[172:175], v[120:123], v[92:95], v[172:175]
  v_cmp_gt_u32 vcc, s49, v1
  v_mfma_f32_16x16x32_bf16 v[224:227], v[120:123], v[96:99], v[224:227]
  ds_read_b64_tr_b16 v[120:121], v9 offset:160
  ds_read_b64_tr_b16 v[122:123], v9 offset:3232
  v_mfma_f32_16x16x32_bf16 v[176:179], v[124:127], v[92:95], v[176:179]
  s_setprio 0
  v_mfma_f32_16x16x32_bf16 v[228:231], v[124:127], v[96:99], v[228:231]
  ds_read_b64_tr_b16 v[124:125], v10 offset:0
  ds_read_b64_tr_b16 v[126:127], v10 offset:3584
  buffer_load_dwordx4 v[88:91], v2, s[16:19], s41 offen offset:1024 sc1
  v_mfma_f32_16x16x32_bf16 v[180:183], v[128:131], v[92:95], v[180:183]
  v_mfma_f32_16x16x32_bf16 v[232:235], v[128:131], v[96:99], v[232:235]
  ds_read_b64_tr_b16 v[128:129], v10 offset:32
  ds_read_b64_tr_b16 v[130:131], v10 offset:3616
  v_mfma_f32_16x16x32_bf16 v[184:187], v[132:135], v[92:95], v[184:187]
  v_mfma_f32_16x16x32_bf16 v[236:239], v[132:135], v[96:99], v[236:239]
  ds_read_b64_tr_b16 v[132:133], v10 offset:64
  ds_read_b64_tr_b16 v[134:135], v10 offset:3648
  s_waitcnt lgkmcnt(15)
  v_mfma_f32_16x16x32_bf16 v[188:191], v[136:139], v[92:95], v[188:191]
  v_mfma_f32_16x16x32_bf16 v[240:243], v[136:139], v[96:99], v[240:243]
  v_cndmask_b32 v11, v12, v11, vcc
  ds_read_b64_tr_b16 v[136:137], v10 offset:96
  ds_read_b64_tr_b16 v[138:139], v10 offset:3680
  v_mfma_f32_16x16x32_bf16 v[192:195], v[140:143], v[92:95], v[192:195]
  v_mfma_f32_16x16x32_bf16 v[244:247], v[140:143], v[96:99], v[244:247]
  ds_read_b64_tr_b16 v[140:141], v10 offset:128
  ds_read_b64_tr_b16 v[142:143], v10 offset:3712
  v_mfma_f32_16x16x32_bf16 v[196:199], v[144:147], v[92:95], v[196:199]
  v_mfma_f32_16x16x32_bf16 v[248:251], v[144:147], v[96:99], v[248:251]
  ds_read_b64_tr_b16 v[144:145], v10 offset:160
  ds_read_b64_tr_b16 v[146:147], v10 offset:3744
  v_mfma_f32_16x16x32_bf16 v[200:203], v[148:151], v[92:95], v[200:203]
  v_mfma_f32_16x16x32_bf16 v[252:255], v[148:151], v[96:99], v[252:255]
  ds_read_b64_tr_b16 v[148:149], v10 offset:192
  ds_read_b64_tr_b16 v[150:151], v10 offset:3776
  s_waitcnt vmcnt(14)
  s_setprio 3
  s_barrier
  s_waitcnt lgkmcnt(8)
  v_mfma_f32_16x16x32_bf16 v[152:155], v[100:103], v[36:39], v[152:155]
  s_mov_b32 s56, 1069066811
  v_mfma_f32_16x16x32_bf16 v[204:207], v[100:103], v[40:43], v[204:207]
  ds_read_b64_tr_b16 v[100:101], v8 offset:14336
  ds_read_b64_tr_b16 v[102:103], v8 offset:17408
  v_mfma_f32_16x16x32_bf16 v[156:159], v[104:107], v[36:39], v[156:159]
  v_mfma_f32_16x16x32_bf16 v[208:211], v[104:107], v[40:43], v[208:211]
  ds_read_b64_tr_b16 v[104:105], v9 offset:14368
  ds_read_b64_tr_b16 v[106:107], v9 offset:17440
  s_add_u32 m0, s68, 28672
  s_add_u32 s42, s42, s45
  buffer_load_dwordx4 v3, s[20:23], s42 offen lds
  v_mfma_f32_16x16x32_bf16 v[160:163], v[108:111], v[36:39], v[160:163]
  v_mfma_f32_16x16x32_bf16 v[212:215], v[108:111], v[40:43], v[212:215]
  s_mov_b32 s57, 0xffff0000
  ds_read_b64_tr_b16 v[108:109], v8 offset:14400
  ds_read_b64_tr_b16 v[110:111], v8 offset:17472
  s_add_u32 m0, s44, 28672
  s_add_u32 s43, s43, s51
  buffer_load_dwordx4 v4, s[24:27], s43 offen lds
  v_mfma_f32_16x16x32_bf16 v[164:167], v[112:115], v[36:39], v[164:167]
  v_mfma_f32_16x16x32_bf16 v[216:219], v[112:115], v[40:43], v[216:219]
  ds_read_b64_tr_b16 v[112:113], v9 offset:14432
  ds_read_b64_tr_b16 v[114:115], v9 offset:17504
  v_mfma_f32_16x16x32_bf16 v[168:171], v[116:119], v[36:39], v[168:171]
  v_mfma_f32_16x16x32_bf16 v[220:223], v[116:119], v[40:43], v[220:223]
  ds_read_b64_tr_b16 v[116:117], v8 offset:14464
  ds_read_b64_tr_b16 v[118:119], v8 offset:17536
  buffer_load_dwordx4 v[92:95], v2, s[16:19], s41 offen offset:2048 sc1
  v_mfma_f32_16x16x32_bf16 v[172:175], v[120:123], v[36:39], v[172:175]
  s_mul_i32 s59, s39, 294912
  v_mfma_f32_16x16x32_bf16 v[224:227], v[120:123], v[40:43], v[224:227]
  ds_read_b64_tr_b16 v[120:121], v9 offset:14496
  ds_read_b64_tr_b16 v[122:123], v9 offset:17568
  v_mfma_f32_16x16x32_bf16 v[176:179], v[124:127], v[36:39], v[176:179]
  s_setprio 2
  v_mfma_f32_16x16x32_bf16 v[228:231], v[124:127], v[40:43], v[228:231]
  ds_read_b64_tr_b16 v[124:125], v10 offset:14336
  ds_read_b64_tr_b16 v[126:127], v10 offset:17920
  buffer_load_dwordx4 v[96:99], v2, s[16:19], s41 offen offset:3072 sc1
  s_add_u32 s41, s41, 4096
  v_mfma_f32_16x16x32_bf16 v[180:183], v[128:131], v[36:39], v[180:183]
  v_mfma_f32_16x16x32_bf16 v[232:235], v[128:131], v[40:43], v[232:235]
  s_add_u32 s59, s59, 4194304
  ds_read_b64_tr_b16 v[128:129], v10 offset:14368
  ds_read_b64_tr_b16 v[130:131], v10 offset:17952
  v_mfma_f32_16x16x32_bf16 v[184:187], v[132:135], v[36:39], v[184:187]
  v_mfma_f32_16x16x32_bf16 v[236:239], v[132:135], v[40:43], v[236:239]
  ds_read_b64_tr_b16 v[132:133], v10 offset:14400
  ds_read_b64_tr_b16 v[134:135], v10 offset:17984
  buffer_load_dword v0, v11, s[52:55], s58 offen
  s_add_u32 s58, s58, s90
  s_waitcnt lgkmcnt(15)
  v_mfma_f32_16x16x32_bf16 v[188:191], v[136:139], v[36:39], v[188:191]
  v_mfma_f32_16x16x32_bf16 v[240:243], v[136:139], v[40:43], v[240:243]
  ds_read_b64_tr_b16 v[136:137], v10 offset:14432
  ds_read_b64_tr_b16 v[138:139], v10 offset:18016
  v_mfma_f32_16x16x32_bf16 v[192:195], v[140:143], v[36:39], v[192:195]
  v_mfma_f32_16x16x32_bf16 v[244:247], v[140:143], v[40:43], v[244:247]
  ds_read_b64_tr_b16 v[140:141], v10 offset:14464
  ds_read_b64_tr_b16 v[142:143], v10 offset:18048
  v_mfma_f32_16x16x32_bf16 v[196:199], v[144:147], v[36:39], v[196:199]
  v_mfma_f32_16x16x32_bf16 v[248:251], v[144:147], v[40:43], v[248:251]
  ds_read_b64_tr_b16 v[144:145], v10 offset:14496
  ds_read_b64_tr_b16 v[146:147], v10 offset:18080
  v_mfma_f32_16x16x32_bf16 v[200:203], v[148:151], v[36:39], v[200:203]
  v_mfma_f32_16x16x32_bf16 v[252:255], v[148:151], v[40:43], v[252:255]
  s_setprio 1
  ds_read_b64_tr_b16 v[148:149], v10 offset:14528
  ds_read_b64_tr_b16 v[150:151], v10 offset:18112
  s_waitcnt lgkmcnt(8)
  v_mfma_f32_16x16x32_bf16 v[152:155], v[100:103], v[44:47], v[152:155]
  v_mfma_f32_16x16x32_bf16 v[204:207], v[100:103], v[48:51], v[204:207]
  ds_read_b64_tr_b16 v[100:101], v8 offset:28672
  ds_read_b64_tr_b16 v[102:103], v8 offset:31744
  v_mfma_f32_16x16x32_bf16 v[156:159], v[104:107], v[44:47], v[156:159]
  v_mfma_f32_16x16x32_bf16 v[208:211], v[104:107], v[48:51], v[208:211]
  ds_read_b64_tr_b16 v[104:105], v9 offset:28704
  ds_read_b64_tr_b16 v[106:107], v9 offset:31776
  s_add_u32 m0, s68, 43008
  s_add_u32 s42, s42, s45
  buffer_load_dwordx4 v3, s[20:23], s42 offen lds
  v_mfma_f32_16x16x32_bf16 v[160:163], v[108:111], v[44:47], v[160:163]
  v_mfma_f32_16x16x32_bf16 v[212:215], v[108:111], v[48:51], v[212:215]
  ds_read_b64_tr_b16 v[108:109], v8 offset:28736
  ds_read_b64_tr_b16 v[110:111], v8 offset:31808
  s_add_u32 m0, s44, 43008
  s_add_u32 s43, s43, s51
  buffer_load_dwordx4 v4, s[24:27], s43 offen lds
  v_mfma_f32_16x16x32_bf16 v[164:167], v[112:115], v[44:47], v[164:167]
  v_mfma_f32_16x16x32_bf16 v[216:219], v[112:115], v[48:51], v[216:219]
  ds_read_b64_tr_b16 v[112:113], v9 offset:28768
  ds_read_b64_tr_b16 v[114:115], v9 offset:31840
  v_mfma_f32_16x16x32_bf16 v[168:171], v[116:119], v[44:47], v[168:171]
  v_mfma_f32_16x16x32_bf16 v[220:223], v[116:119], v[48:51], v[220:223]
  ds_read_b64_tr_b16 v[116:117], v8 offset:28800
  ds_read_b64_tr_b16 v[118:119], v8 offset:31872
  v_mfma_f32_16x16x32_bf16 v[172:175], v[120:123], v[44:47], v[172:175]
  v_mfma_f32_16x16x32_bf16 v[224:227], v[120:123], v[48:51], v[224:227]
  ds_read_b64_tr_b16 v[120:121], v9 offset:28832
  ds_read_b64_tr_b16 v[122:123], v9 offset:31904
  v_mfma_f32_16x16x32_bf16 v[176:179], v[124:127], v[44:47], v[176:179]
  s_setprio 0
  v_mfma_f32_16x16x32_bf16 v[228:231], v[124:127], v[48:51], v[228:231]
  ds_read_b64_tr_b16 v[124:125], v10 offset:28672
  ds_read_b64_tr_b16 v[126:127], v10 offset:32256
  v_mfma_f32_16x16x32_bf16 v[180:183], v[128:131], v[44:47], v[180:183]
  v_mfma_f32_16x16x32_bf16 v[232:235], v[128:131], v[48:51], v[232:235]
  ds_read_b64_tr_b16 v[128:129], v10 offset:28704
  ds_read_b64_tr_b16 v[130:131], v10 offset:32288
  v_mfma_f32_16x16x32_bf16 v[184:187], v[132:135], v[44:47], v[184:187]
  v_mfma_f32_16x16x32_bf16 v[236:239], v[132:135], v[48:51], v[236:239]
  ds_read_b64_tr_b16 v[132:133], v10 offset:28736
  ds_read_b64_tr_b16 v[134:135], v10 offset:32320
  s_waitcnt lgkmcnt(15)
  v_mfma_f32_16x16x32_bf16 v[188:191], v[136:139], v[44:47], v[188:191]
  v_mfma_f32_16x16x32_bf16 v[240:243], v[136:139], v[48:51], v[240:243]
  ds_read_b64_tr_b16 v[136:137], v10 offset:28768
  ds_read_b64_tr_b16 v[138:139], v10 offset:32352
  v_mfma_f32_16x16x32_bf16 v[192:195], v[140:143], v[44:47], v[192:195]
  v_mfma_f32_16x16x32_bf16 v[244:247], v[140:143], v[48:51], v[244:247]
  ds_read_b64_tr_b16 v[140:141], v10 offset:28800
  ds_read_b64_tr_b16 v[142:143], v10 offset:32384
  v_mfma_f32_16x16x32_bf16 v[196:199], v[144:147], v[44:47], v[196:199]
  v_mfma_f32_16x16x32_bf16 v[248:251], v[144:147], v[48:51], v[248:251]
  ds_read_b64_tr_b16 v[144:145], v10 offset:28832
  ds_read_b64_tr_b16 v[146:147], v10 offset:32416
  v_mfma_f32_16x16x32_bf16 v[200:203], v[148:151], v[44:47], v[200:203]
  v_mfma_f32_16x16x32_bf16 v[252:255], v[148:151], v[48:51], v[252:255]
  ds_read_b64_tr_b16 v[148:149], v10 offset:28864
  ds_read_b64_tr_b16 v[150:151], v10 offset:32448
  s_waitcnt vmcnt(13)
  s_setprio 3
  s_barrier
  s_waitcnt lgkmcnt(8)
  v_mfma_f32_16x16x32_bf16 v[152:155], v[100:103], v[52:55], v[152:155]
  v_mfma_f32_16x16x32_bf16 v[204:207], v[100:103], v[56:59], v[204:207]
  ds_read_b64_tr_b16 v[100:101], v8 offset:43008
  ds_read_b64_tr_b16 v[102:103], v8 offset:46080
  v_mfma_f32_16x16x32_bf16 v[156:159], v[104:107], v[52:55], v[156:159]
  v_mfma_f32_16x16x32_bf16 v[208:211], v[104:107], v[56:59], v[208:211]
  ds_read_b64_tr_b16 v[104:105], v9 offset:43040
  ds_read_b64_tr_b16 v[106:107], v9 offset:46112
  v_mfma_f32_16x16x32_bf16 v[160:163], v[108:111], v[52:55], v[160:163]
  v_mfma_f32_16x16x32_bf16 v[212:215], v[108:111], v[56:59], v[212:215]
  ds_read_b64_tr_b16 v[108:109], v8 offset:43072
  ds_read_b64_tr_b16 v[110:111], v8 offset:46144
  v_mfma_f32_16x16x32_bf16 v[164:167], v[112:115], v[52:55], v[164:167]
  v_mfma_f32_16x16x32_bf16 v[216:219], v[112:115], v[56:59], v[216:219]
  ds_read_b64_tr_b16 v[112:113], v9 offset:43104
  ds_read_b64_tr_b16 v[114:115], v9 offset:46176
  v_mfma_f32_16x16x32_bf16 v[168:171], v[116:119], v[52:55], v[168:171]
  v_mfma_f32_16x16x32_bf16 v[220:223], v[116:119], v[56:59], v[220:223]
  ds_read_b64_tr_b16 v[116:117], v8 offset:43136
  ds_read_b64_tr_b16 v[118:119], v8 offset:46208
  v_mfma_f32_16x16x32_bf16 v[172:175], v[120:123], v[52:55], v[172:175]
  v_mfma_f32_16x16x32_bf16 v[224:227], v[120:123], v[56:59], v[224:227]
  ds_read_b64_tr_b16 v[120:121], v9 offset:43168
  ds_read_b64_tr_b16 v[122:123], v9 offset:46240
  v_mfma_f32_16x16x32_bf16 v[176:179], v[124:127], v[52:55], v[176:179]
  s_setprio 2
  v_mfma_f32_16x16x32_bf16 v[228:231], v[124:127], v[56:59], v[228:231]
  s_lshr_b32 s70, s36, 2
  s_and_b32 s71, s36, 3
  ds_read_b64_tr_b16 v[124:125], v10 offset:43008
  ds_read_b64_tr_b16 v[126:127], v10 offset:46592
  v_mfma_f32_16x16x32_bf16 v[180:183], v[128:131], v[52:55], v[180:183]
  s_and_b32 s74, s46, 1
  v_mfma_f32_16x16x32_bf16 v[232:235], v[128:131], v[56:59], v[232:235]
  s_lshr_b32 s48, s46, 1
  ds_read_b64_tr_b16 v[128:129], v10 offset:43040
  ds_read_b64_tr_b16 v[130:131], v10 offset:46624
  v_mfma_f32_16x16x32_bf16 v[184:187], v[132:135], v[52:55], v[184:187]
  s_lshl_b32 s72, s48, 2
  v_mfma_f32_16x16x32_bf16 v[236:239], v[132:135], v[56:59], v[236:239]
  s_and_b32 s49, s47, 3
  ds_read_b64_tr_b16 v[132:133], v10 offset:43072
  ds_read_b64_tr_b16 v[134:135], v10 offset:46656
  s_waitcnt lgkmcnt(15)
  v_mfma_f32_16x16x32_bf16 v[188:191], v[136:139], v[52:55], v[188:191]
  s_add_u32 s72, s72, s49
  v_mfma_f32_16x16x32_bf16 v[240:243], v[136:139], v[56:59], v[240:243]
  s_lshr_b32 s73, s47, 2
  ds_read_b64_tr_b16 v[136:137], v10 offset:43104
  ds_read_b64_tr_b16 v[138:139], v10 offset:46688
  v_mfma_f32_16x16x32_bf16 v[192:195], v[140:143], v[52:55], v[192:195]
  s_lshl_b32 s75, s74, 1
  s_add_u32 s75, s75, s70
  v_mfma_f32_16x16x32_bf16 v[244:247], v[140:143], v[56:59], v[244:247]
  ds_read_b64_tr_b16 v[140:141], v10 offset:43136
  ds_read_b64_tr_b16 v[142:143], v10 offset:46720
  v_mfma_f32_16x16x32_bf16 v[196:199], v[144:147], v[52:55], v[196:199]
  v_mfma_f32_16x16x32_bf16 v[248:251], v[144:147], v[56:59], v[248:251]
  v_lshrrev_b32 v11, 4, v1
  ds_read_b64_tr_b16 v[144:145], v10 offset:43168
  ds_read_b64_tr_b16 v[146:147], v10 offset:46752
  v_mfma_f32_16x16x32_bf16 v[200:203], v[148:151], v[52:55], v[200:203]
  v_mfma_f32_16x16x32_bf16 v[252:255], v[148:151], v[56:59], v[252:255]
  s_lshl_b32 s48, s71, 3
  s_setprio 1
  ds_read_b64_tr_b16 v[148:149], v10 offset:43200
  ds_read_b64_tr_b16 v[150:151], v10 offset:46784
  s_waitcnt lgkmcnt(8)
  v_mfma_f32_16x16x32_bf16 v[152:155], v[100:103], v[60:63], v[152:155]
  v_add_u32 v12, s48, v11
  v_mfma_f32_16x16x32_bf16 v[204:207], v[100:103], v[64:67], v[204:207]
  ds_read_b64_tr_b16 v[100:101], v5 offset:0
  ds_read_b64_tr_b16 v[102:103], v5 offset:3072
  v_mfma_f32_16x16x32_bf16 v[156:159], v[104:107], v[60:63], v[156:159]
  v_lshlrev_b32 v3, 11, v12
  v_mfma_f32_16x16x32_bf16 v[208:211], v[104:107], v[64:67], v[208:211]
  v_lshlrev_b32 v11, 1, v11
  ds_read_b64_tr_b16 v[104:105], v6 offset:32
  ds_read_b64_tr_b16 v[106:107], v6 offset:3104
  v_mfma_f32_16x16x32_bf16 v[160:163], v[108:111], v[60:63], v[160:163]
  v_mfma_f32_16x16x32_bf16 v[212:215], v[108:111], v[64:67], v[212:215]
  v_and_b32 v12, 15, v1
  ds_read_b64_tr_b16 v[108:109], v5 offset:64
  ds_read_b64_tr_b16 v[110:111], v5 offset:3136
  v_mfma_f32_16x16x32_bf16 v[164:167], v[112:115], v[60:63], v[164:167]
  v_mfma_f32_16x16x32_bf16 v[216:219], v[112:115], v[64:67], v[216:219]
  v_xor_b32 v11, v11, v12
  ds_read_b64_tr_b16 v[112:113], v6 offset:96
  ds_read_b64_tr_b16 v[114:115], v6 offset:3168
  v_mfma_f32_16x16x32_bf16 v[168:171], v[116:119], v[60:63], v[168:171]
  v_mfma_f32_16x16x32_bf16 v[220:223], v[116:119], v[64:67], v[220:223]
  v_lshl_add_u32 v3, v11, 4, v3
  ds_read_b64_tr_b16 v[116:117], v5 offset:128
  ds_read_b64_tr_b16 v[118:119], v5 offset:3200
  v_mfma_f32_16x16x32_bf16 v[172:175], v[120:123], v[60:63], v[172:175]
  s_lshl_b32 s48, s73, 8
  v_mfma_f32_16x16x32_bf16 v[224:227], v[120:123], v[64:67], v[224:227]
  v_add_u32 v3, s48, v3
  ds_read_b64_tr_b16 v[120:121], v6 offset:160
  ds_read_b64_tr_b16 v[122:123], v6 offset:3232
  v_mfma_f32_16x16x32_bf16 v[176:179], v[124:127], v[60:63], v[176:179]
  s_setprio 0
  v_mfma_f32_16x16x32_bf16 v[228:231], v[124:127], v[64:67], v[228:231]
  v_xor_b32 v4, 128, v3
  ds_read_b64_tr_b16 v[124:125], v7 offset:0
  ds_read_b64_tr_b16 v[126:127], v7 offset:3584
  v_mfma_f32_16x16x32_bf16 v[180:183], v[128:131], v[60:63], v[180:183]
  v_mfma_f32_16x16x32_bf16 v[232:235], v[128:131], v[64:67], v[232:235]
  v_add_u32 v4, 8192, v4
  ds_read_b64_tr_b16 v[128:129], v7 offset:32
  ds_read_b64_tr_b16 v[130:131], v7 offset:3616
  v_mfma_f32_16x16x32_bf16 v[184:187], v[132:135], v[60:63], v[184:187]
  v_mfma_f32_16x16x32_bf16 v[236:239], v[132:135], v[64:67], v[236:239]
  s_mov_b32 s80, s14
  ds_read_b64_tr_b16 v[132:133], v7 offset:64
  ds_read_b64_tr_b16 v[134:135], v7 offset:3648
  s_waitcnt lgkmcnt(15)
  v_mfma_f32_16x16x32_bf16 v[188:191], v[136:139], v[60:63], v[188:191]
  s_mov_b32 s81, s15
  s_mov_b32 s82, 7340032
  v_mfma_f32_16x16x32_bf16 v[240:243], v[136:139], v[64:67], v[240:243]
  s_mov_b32 s83, 0x20000
  ds_read_b64_tr_b16 v[136:137], v7 offset:96
  ds_read_b64_tr_b16 v[138:139], v7 offset:3680
  v_mfma_f32_16x16x32_bf16 v[192:195], v[140:143], v[60:63], v[192:195]
  s_mul_i32 s85, s75, 1572864
  v_mfma_f32_16x16x32_bf16 v[244:247], v[140:143], v[64:67], v[244:247]
  s_sub_u32 s85, s85, 65536
  ds_read_b64_tr_b16 v[140:141], v7 offset:128
  ds_read_b64_tr_b16 v[142:143], v7 offset:3712
  v_mfma_f32_16x16x32_bf16 v[196:199], v[144:147], v[60:63], v[196:199]
  s_mul_i32 s87, s70, 49152
  v_mfma_f32_16x16x32_bf16 v[248:251], v[144:147], v[64:67], v[248:251]
  s_add_u32 s87, s87, 65536
  ds_read_b64_tr_b16 v[144:145], v7 offset:160
  ds_read_b64_tr_b16 v[146:147], v7 offset:3744
  v_mfma_f32_16x16x32_bf16 v[200:203], v[148:151], v[60:63], v[200:203]
  s_lshl_b32 s86, s71, 11
  v_mfma_f32_16x16x32_bf16 v[252:255], v[148:151], v[64:67], v[252:255]
  s_add_u32 s86, s86, s87
  ds_read_b64_tr_b16 v[148:149], v7 offset:192
  ds_read_b64_tr_b16 v[150:151], v7 offset:3776
  s_waitcnt vmcnt(5)
  s_setprio 3
  s_barrier
  s_waitcnt lgkmcnt(6)
  v_mfma_f32_16x16x32_bf16 v[176:179], v[124:127], v[68:71], v[176:179]
  v_mfma_f32_16x16x32_bf16 v[228:231], v[124:127], v[72:75], v[228:231]
  ds_read_b64_tr_b16 v[124:125], v7 offset:14336
  ds_read_b64_tr_b16 v[126:127], v7 offset:17920
  v_mfma_f32_16x16x32_bf16 v[180:183], v[128:131], v[68:71], v[180:183]
  v_mfma_f32_16x16x32_bf16 v[232:235], v[128:131], v[72:75], v[232:235]
  ds_read_b64_tr_b16 v[128:129], v7 offset:14368
  ds_read_b64_tr_b16 v[130:131], v7 offset:17952
  v_mfma_f32_16x16x32_bf16 v[184:187], v[132:135], v[68:71], v[184:187]
  v_mfma_f32_16x16x32_bf16 v[236:239], v[132:135], v[72:75], v[236:239]
  ds_read_b64_tr_b16 v[132:133], v7 offset:14400
  ds_read_b64_tr_b16 v[134:135], v7 offset:17984
  v_mfma_f32_16x16x32_bf16 v[188:191], v[136:139], v[68:71], v[188:191]
  v_mfma_f32_16x16x32_bf16 v[240:243], v[136:139], v[72:75], v[240:243]
  ds_read_b64_tr_b16 v[136:137], v7 offset:14432
  ds_read_b64_tr_b16 v[138:139], v7 offset:18016
  s_waitcnt lgkmcnt(8)
  v_mfma_f32_16x16x32_bf16 v[192:195], v[140:143], v[68:71], v[192:195]
  v_mfma_f32_16x16x32_bf16 v[244:247], v[140:143], v[72:75], v[244:247]
  ds_read_b64_tr_b16 v[140:141], v7 offset:14464
  ds_read_b64_tr_b16 v[142:143], v7 offset:18048
  v_mfma_f32_16x16x32_bf16 v[196:199], v[144:147], v[68:71], v[196:199]
  v_mfma_f32_16x16x32_bf16 v[248:251], v[144:147], v[72:75], v[248:251]
  ds_read_b64_tr_b16 v[144:145], v7 offset:14496
  ds_read_b64_tr_b16 v[146:147], v7 offset:18080
  v_mfma_f32_16x16x32_bf16 v[200:203], v[148:151], v[68:71], v[200:203]
  s_setprio 2
  v_mfma_f32_16x16x32_bf16 v[252:255], v[148:151], v[72:75], v[252:255]
  ds_read_b64_tr_b16 v[148:149], v7 offset:14528
  ds_read_b64_tr_b16 v[150:151], v7 offset:18112
  s_waitcnt lgkmcnt(6)
  v_mfma_f32_16x16x32_bf16 v[176:179], v[124:127], v[76:79], v[176:179]
  v_mfma_f32_16x16x32_bf16 v[228:231], v[124:127], v[80:83], v[228:231]
  ds_read_b64_tr_b16 v[124:125], v7 offset:28672
  ds_read_b64_tr_b16 v[126:127], v7 offset:32256
  v_mfma_f32_16x16x32_bf16 v[180:183], v[128:131], v[76:79], v[180:183]
  v_mfma_f32_16x16x32_bf16 v[232:235], v[128:131], v[80:83], v[232:235]
  ds_read_b64_tr_b16 v[128:129], v7 offset:28704
  ds_read_b64_tr_b16 v[130:131], v7 offset:32288
  s_add_u32 m0, s86, 0
  s_add_u32 s85, s85, 65536
  buffer_load_dwordx4 v3, s[80:83], s85 offen lds
  v_mfma_f32_16x16x32_bf16 v[184:187], v[132:135], v[76:79], v[184:187]
  v_mfma_f32_16x16x32_bf16 v[236:239], v[132:135], v[80:83], v[236:239]
  ds_read_b64_tr_b16 v[132:133], v7 offset:28736
  ds_read_b64_tr_b16 v[134:135], v7 offset:32320
  s_add_u32 m0, s86, 1024
  s_nop 0
  buffer_load_dwordx4 v4, s[80:83], s85 offen lds
  v_mfma_f32_16x16x32_bf16 v[188:191], v[136:139], v[76:79], v[188:191]
  v_mfma_f32_16x16x32_bf16 v[240:243], v[136:139], v[80:83], v[240:243]
  ds_read_b64_tr_b16 v[136:137], v7 offset:28768
  ds_read_b64_tr_b16 v[138:139], v7 offset:32352
  s_add_u32 m0, s86, 8192
  s_add_u32 s85, s85, 65536
  buffer_load_dwordx4 v3, s[80:83], s85 offen lds
  s_waitcnt lgkmcnt(8)
  v_mfma_f32_16x16x32_bf16 v[192:195], v[140:143], v[76:79], v[192:195]
  v_mfma_f32_16x16x32_bf16 v[244:247], v[140:143], v[80:83], v[244:247]
  ds_read_b64_tr_b16 v[140:141], v7 offset:28800
  ds_read_b64_tr_b16 v[142:143], v7 offset:32384
  s_add_u32 m0, s86, 9216
  s_nop 0
  buffer_load_dwordx4 v4, s[80:83], s85 offen lds
  v_mfma_f32_16x16x32_bf16 v[196:199], v[144:147], v[76:79], v[196:199]
  v_mfma_f32_16x16x32_bf16 v[248:251], v[144:147], v[80:83], v[248:251]
  ds_read_b64_tr_b16 v[144:145], v7 offset:28832
  ds_read_b64_tr_b16 v[146:147], v7 offset:32416
  v_mfma_f32_16x16x32_bf16 v[200:203], v[148:151], v[76:79], v[200:203]
  s_setprio 0
  v_mfma_f32_16x16x32_bf16 v[252:255], v[148:151], v[80:83], v[252:255]
  ds_read_b64_tr_b16 v[148:149], v7 offset:28864
  ds_read_b64_tr_b16 v[150:151], v7 offset:32448
  s_waitcnt vmcnt(4)
  s_setprio 3
  s_barrier
  s_waitcnt lgkmcnt(6)
  v_mfma_f32_16x16x32_bf16 v[176:179], v[124:127], v[84:87], v[176:179]
  v_mfma_f32_16x16x32_bf16 v[228:231], v[124:127], v[88:91], v[228:231]
  ds_read_b64_tr_b16 v[124:125], v7 offset:43008
  ds_read_b64_tr_b16 v[126:127], v7 offset:46592
  v_mfma_f32_16x16x32_bf16 v[180:183], v[128:131], v[84:87], v[180:183]
  v_mfma_f32_16x16x32_bf16 v[232:235], v[128:131], v[88:91], v[232:235]
  ds_read_b64_tr_b16 v[128:129], v7 offset:43040
  ds_read_b64_tr_b16 v[130:131], v7 offset:46624
  s_add_u32 m0, s86, 16384
  s_add_u32 s85, s85, 65536
  buffer_load_dwordx4 v3, s[80:83], s85 offen lds
  v_mfma_f32_16x16x32_bf16 v[184:187], v[132:135], v[84:87], v[184:187]
  v_mfma_f32_16x16x32_bf16 v[236:239], v[132:135], v[88:91], v[236:239]
  ds_read_b64_tr_b16 v[132:133], v7 offset:43072
  ds_read_b64_tr_b16 v[134:135], v7 offset:46656
  s_add_u32 m0, s86, 17408
  s_nop 0
  buffer_load_dwordx4 v4, s[80:83], s85 offen lds
  v_mfma_f32_16x16x32_bf16 v[188:191], v[136:139], v[84:87], v[188:191]
  v_mfma_f32_16x16x32_bf16 v[240:243], v[136:139], v[88:91], v[240:243]
  ds_read_b64_tr_b16 v[136:137], v7 offset:43104
  ds_read_b64_tr_b16 v[138:139], v7 offset:46688
  s_waitcnt lgkmcnt(8)
  v_mfma_f32_16x16x32_bf16 v[192:195], v[140:143], v[84:87], v[192:195]
  v_mfma_f32_16x16x32_bf16 v[244:247], v[140:143], v[88:91], v[244:247]
  ds_read_b64_tr_b16 v[140:141], v7 offset:43136
  ds_read_b64_tr_b16 v[142:143], v7 offset:46720
  s_add_u32 m0, s86, 24576
  s_add_u32 s85, s85, 65536
  buffer_load_dwordx4 v3, s[80:83], s85 offen lds
  v_mfma_f32_16x16x32_bf16 v[196:199], v[144:147], v[84:87], v[196:199]
  v_mfma_f32_16x16x32_bf16 v[248:251], v[144:147], v[88:91], v[248:251]
  ds_read_b64_tr_b16 v[144:145], v7 offset:43168
  ds_read_b64_tr_b16 v[146:147], v7 offset:46752
  v_mfma_f32_16x16x32_bf16 v[200:203], v[148:151], v[84:87], v[200:203]
  s_setprio 2
  v_mfma_f32_16x16x32_bf16 v[252:255], v[148:151], v[88:91], v[252:255]
  ds_read_b64_tr_b16 v[148:149], v7 offset:43200
  ds_read_b64_tr_b16 v[150:151], v7 offset:46784
  s_waitcnt lgkmcnt(6)
  v_mfma_f32_16x16x32_bf16 v[176:179], v[124:127], v[92:95], v[176:179]
  v_mfma_f32_16x16x32_bf16 v[228:231], v[124:127], v[96:99], v[228:231]
  v_mfma_f32_16x16x32_bf16 v[180:183], v[128:131], v[92:95], v[180:183]
  v_mfma_f32_16x16x32_bf16 v[232:235], v[128:131], v[96:99], v[232:235]
  s_add_u32 m0, s86, 25600
  s_nop 0
  buffer_load_dwordx4 v4, s[80:83], s85 offen lds
  v_mfma_f32_16x16x32_bf16 v[184:187], v[132:135], v[92:95], v[184:187]
  v_mfma_f32_16x16x32_bf16 v[236:239], v[132:135], v[96:99], v[236:239]
  s_add_u32 m0, s86, 32768
  s_add_u32 s85, s85, 65536
  buffer_load_dwordx4 v3, s[80:83], s85 offen lds
  v_mfma_f32_16x16x32_bf16 v[188:191], v[136:139], v[92:95], v[188:191]
  v_mfma_f32_16x16x32_bf16 v[240:243], v[136:139], v[96:99], v[240:243]
  s_waitcnt lgkmcnt(0)
  v_mfma_f32_16x16x32_bf16 v[192:195], v[140:143], v[92:95], v[192:195]
  v_mfma_f32_16x16x32_bf16 v[244:247], v[140:143], v[96:99], v[244:247]
  s_add_u32 m0, s86, 33792
  s_nop 0
  buffer_load_dwordx4 v4, s[80:83], s85 offen lds
  v_mfma_f32_16x16x32_bf16 v[196:199], v[144:147], v[92:95], v[196:199]
  v_mfma_f32_16x16x32_bf16 v[248:251], v[144:147], v[96:99], v[248:251]
  v_mfma_f32_16x16x32_bf16 v[200:203], v[148:151], v[92:95], v[200:203]
  s_setprio 0
  v_mfma_f32_16x16x32_bf16 v[252:255], v[148:151], v[96:99], v[252:255]
  v_mfma_f32_16x16x32_bf16 v[152:155], v[100:103], v[68:71], v[152:155]
  v_lshlrev_b32 v36, 16, v14
  v_and_b32 v37, s57, v14
  v_lshlrev_b32 v38, 16, v15
  v_and_b32 v39, s57, v15
  v_mfma_f32_16x16x32_bf16 v[204:207], v[100:103], v[72:75], v[204:207]
  v_cvt_pk_bf16_f32 v176, 0, v176
  v_cvt_pk_bf16_f32 v177, 0, v177
  v_cvt_pk_bf16_f32 v178, 0, v178
  v_cvt_pk_bf16_f32 v179, 0, v179
  ds_read_b64_tr_b16 v[100:101], v5 offset:14336
  ds_read_b64_tr_b16 v[102:103], v5 offset:17408
  v_mfma_f32_16x16x32_bf16 v[156:159], v[104:107], v[68:71], v[156:159]
  v_cvt_pk_bf16_f32 v228, 0, v228
  v_cvt_pk_bf16_f32 v229, 0, v229
  v_cvt_pk_bf16_f32 v230, 0, v230
  v_cvt_pk_bf16_f32 v231, 0, v231
  v_mfma_f32_16x16x32_bf16 v[208:211], v[104:107], v[72:75], v[208:211]
  v_add_f32 v176, v176, v36
  v_add_f32 v177, v177, v37
  v_add_f32 v178, v178, v38
  v_add_f32 v179, v179, v39
  ds_read_b64_tr_b16 v[104:105], v6 offset:14368
  ds_read_b64_tr_b16 v[106:107], v6 offset:17440
  v_mfma_f32_16x16x32_bf16 v[160:163], v[108:111], v[68:71], v[160:163]
  v_add_f32 v228, v228, v36
  v_add_f32 v229, v229, v37
  v_add_f32 v230, v230, v38
  v_mfma_f32_16x16x32_bf16 v[212:215], v[108:111], v[72:75], v[212:215]
  v_add_f32 v231, v231, v39
  v_cvt_pk_bf16_f32 v176, 0, v176
  v_cvt_pk_bf16_f32 v177, 0, v177
  v_cvt_pk_bf16_f32 v178, 0, v178
  ds_read_b64_tr_b16 v[108:109], v5 offset:14400
  ds_read_b64_tr_b16 v[110:111], v5 offset:17472
  v_mfma_f32_16x16x32_bf16 v[164:167], v[112:115], v[68:71], v[164:167]
  v_cvt_pk_bf16_f32 v179, 0, v179
  v_cvt_pk_bf16_f32 v228, 0, v228
  v_cvt_pk_bf16_f32 v229, 0, v229
  v_cvt_pk_bf16_f32 v230, 0, v230
  v_mfma_f32_16x16x32_bf16 v[216:219], v[112:115], v[72:75], v[216:219]
  v_cvt_pk_bf16_f32 v231, 0, v231
  v_mul_f32 v176, v176, |v176|
  v_mul_f32 v177, v177, |v177|
  v_mul_f32 v178, v178, |v178|
  ds_read_b64_tr_b16 v[112:113], v6 offset:14432
  ds_read_b64_tr_b16 v[114:115], v6 offset:17504
  v_mfma_f32_16x16x32_bf16 v[168:171], v[116:119], v[68:71], v[168:171]
  v_mul_f32 v179, v179, |v179|
  v_mul_f32 v228, v228, |v228|
  v_mul_f32 v229, v229, |v229|
  v_mul_f32 v230, v230, |v230|
  v_mfma_f32_16x16x32_bf16 v[220:223], v[116:119], v[72:75], v[220:223]
  v_mul_f32 v231, v231, |v231|
  v_cvt_pk_bf16_f32 v124, v176, v177
  v_cvt_pk_bf16_f32 v125, v178, v179
  ds_read_b64_tr_b16 v[116:117], v5 offset:14464
  ds_read_b64_tr_b16 v[118:119], v5 offset:17536
  v_mfma_f32_16x16x32_bf16 v[172:175], v[120:123], v[68:71], v[172:175]
  v_cvt_pk_bf16_f32 v136, v228, v229
  v_cvt_pk_bf16_f32 v137, v230, v231
  v_pk_max_i16 v124, v124, 0
  v_pk_max_i16 v125, v125, 0
  v_mfma_f32_16x16x32_bf16 v[224:227], v[120:123], v[72:75], v[224:227]
  v_pk_max_i16 v136, v136, 0
  v_pk_max_i16 v137, v137, 0
  v_lshlrev_b32 v36, 16, v16
  v_and_b32 v37, s57, v16
  ds_read_b64_tr_b16 v[120:121], v6 offset:14496
  ds_read_b64_tr_b16 v[122:123], v6 offset:17568
  s_waitcnt lgkmcnt(6)
  v_mfma_f32_16x16x32_bf16 v[152:155], v[100:103], v[76:79], v[152:155]
  v_lshlrev_b32 v38, 16, v17
  v_and_b32 v39, s57, v17
  v_cvt_pk_bf16_f32 v180, 0, v180
  v_cvt_pk_bf16_f32 v181, 0, v181
  v_mfma_f32_16x16x32_bf16 v[204:207], v[100:103], v[80:83], v[204:207]
  v_cvt_pk_bf16_f32 v182, 0, v182
  v_cvt_pk_bf16_f32 v183, 0, v183
  v_cvt_pk_bf16_f32 v232, 0, v232
  ds_read_b64_tr_b16 v[100:101], v5 offset:28672
  ds_read_b64_tr_b16 v[102:103], v5 offset:31744
  v_mfma_f32_16x16x32_bf16 v[156:159], v[104:107], v[76:79], v[156:159]
  v_cvt_pk_bf16_f32 v233, 0, v233
  v_cvt_pk_bf16_f32 v234, 0, v234
  v_cvt_pk_bf16_f32 v235, 0, v235
  v_add_f32 v180, v180, v36
  v_mfma_f32_16x16x32_bf16 v[208:211], v[104:107], v[80:83], v[208:211]
  v_add_f32 v181, v181, v37
  v_add_f32 v182, v182, v38
  v_add_f32 v183, v183, v39
  v_add_f32 v232, v232, v36
  ds_read_b64_tr_b16 v[104:105], v6 offset:28704
  ds_read_b64_tr_b16 v[106:107], v6 offset:31776
  v_mfma_f32_16x16x32_bf16 v[160:163], v[108:111], v[76:79], v[160:163]
  v_add_f32 v233, v233, v37
  v_add_f32 v234, v234, v38
  v_add_f32 v235, v235, v39
  v_cvt_pk_bf16_f32 v180, 0, v180
  v_mfma_f32_16x16x32_bf16 v[212:215], v[108:111], v[80:83], v[212:215]
  v_cvt_pk_bf16_f32 v181, 0, v181
  v_cvt_pk_bf16_f32 v182, 0, v182
  v_cvt_pk_bf16_f32 v183, 0, v183
  v_cvt_pk_bf16_f32 v232, 0, v232
  ds_read_b64_tr_b16 v[108:109], v5 offset:28736
  ds_read_b64_tr_b16 v[110:111], v5 offset:31808
  s_waitcnt lgkmcnt(6)
  v_mfma_f32_16x16x32_bf16 v[164:167], v[112:115], v[76:79], v[164:167]
  v_cvt_pk_bf16_f32 v233, 0, v233
  v_cvt_pk_bf16_f32 v234, 0, v234
  v_cvt_pk_bf16_f32 v235, 0, v235
  v_mfma_f32_16x16x32_bf16 v[216:219], v[112:115], v[80:83], v[216:219]
  v_mul_f32 v180, v180, |v180|
  v_mul_f32 v181, v181, |v181|
  v_mul_f32 v182, v182, |v182|
  v_mul_f32 v183, v183, |v183|
  ds_read_b64_tr_b16 v[112:113], v6 offset:28768
  ds_read_b64_tr_b16 v[114:115], v6 offset:31840
  v_mfma_f32_16x16x32_bf16 v[168:171], v[116:119], v[76:79], v[168:171]
  v_mul_f32 v232, v232, |v232|
  v_mul_f32 v233, v233, |v233|
  v_mul_f32 v234, v234, |v234|
  v_mul_f32 v235, v235, |v235|
  v_mfma_f32_16x16x32_bf16 v[220:223], v[116:119], v[80:83], v[220:223]
  v_cvt_pk_bf16_f32 v126, v180, v181
  v_cvt_pk_bf16_f32 v127, v182, v183
  v_cvt_pk_bf16_f32 v138, v232, v233
  v_cvt_pk_bf16_f32 v139, v234, v235
  ds_read_b64_tr_b16 v[116:117], v5 offset:28800
  ds_read_b64_tr_b16 v[118:119], v5 offset:31872
  v_mfma_f32_16x16x32_bf16 v[172:175], v[120:123], v[76:79], v[172:175]
  v_pk_max_i16 v126, v126, 0
  v_pk_max_i16 v127, v127, 0
  v_pk_max_i16 v138, v138, 0
  v_mfma_f32_16x16x32_bf16 v[224:227], v[120:123], v[80:83], v[224:227]
  v_pk_max_i16 v139, v139, 0
  s_mul_i32 s92, s37, 6144
  s_add_u32 s92, s92, s59
  s_add_u32 s92, s92, 65536
  buffer_store_dwordx4 v[124:127], v2, s[28:31], s92 offen offset:0 sc1
  buffer_store_dwordx4 v[136:139], v2, s[28:31], s92 offen offset:1024 sc1
  ds_read_b64_tr_b16 v[120:121], v6 offset:28832
  ds_read_b64_tr_b16 v[122:123], v6 offset:31904
  s_waitcnt lgkmcnt(6)
  v_mfma_f32_16x16x32_bf16 v[152:155], v[100:103], v[84:87], v[152:155]
  v_lshlrev_b32 v36, 16, v18
  v_and_b32 v37, s57, v18
  v_lshlrev_b32 v38, 16, v19
  v_and_b32 v39, s57, v19
  v_mfma_f32_16x16x32_bf16 v[204:207], v[100:103], v[88:91], v[204:207]
  v_cvt_pk_bf16_f32 v184, 0, v184
  v_cvt_pk_bf16_f32 v185, 0, v185
  v_cvt_pk_bf16_f32 v186, 0, v186
  ds_read_b64_tr_b16 v[100:101], v5 offset:43008
  ds_read_b64_tr_b16 v[102:103], v5 offset:46080
  v_mfma_f32_16x16x32_bf16 v[156:159], v[104:107], v[84:87], v[156:159]
  v_cvt_pk_bf16_f32 v187, 0, v187
  v_cvt_pk_bf16_f32 v236, 0, v236
  v_cvt_pk_bf16_f32 v237, 0, v237
  v_cvt_pk_bf16_f32 v238, 0, v238
  v_mfma_f32_16x16x32_bf16 v[208:211], v[104:107], v[88:91], v[208:211]
  v_cvt_pk_bf16_f32 v239, 0, v239
  v_add_f32 v184, v184, v36
  v_add_f32 v185, v185, v37
  v_add_f32 v186, v186, v38
  ds_read_b64_tr_b16 v[104:105], v6 offset:43040
  ds_read_b64_tr_b16 v[106:107], v6 offset:46112
  v_mfma_f32_16x16x32_bf16 v[160:163], v[108:111], v[84:87], v[160:163]
  v_add_f32 v187, v187, v39
  v_add_f32 v236, v236, v36
  v_add_f32 v237, v237, v37
  v_add_f32 v238, v238, v38
  v_mfma_f32_16x16x32_bf16 v[212:215], v[108:111], v[88:91], v[212:215]
  v_add_f32 v239, v239, v39
  v_cvt_pk_bf16_f32 v184, 0, v184
  v_cvt_pk_bf16_f32 v185, 0, v185
  ds_read_b64_tr_b16 v[108:109], v5 offset:43072
  ds_read_b64_tr_b16 v[110:111], v5 offset:46144
  s_waitcnt lgkmcnt(6)
  v_mfma_f32_16x16x32_bf16 v[164:167], v[112:115], v[84:87], v[164:167]
  v_cvt_pk_bf16_f32 v186, 0, v186
  v_cvt_pk_bf16_f32 v187, 0, v187
  v_cvt_pk_bf16_f32 v236, 0, v236
  v_cvt_pk_bf16_f32 v237, 0, v237
  v_mfma_f32_16x16x32_bf16 v[216:219], v[112:115], v[88:91], v[216:219]
  v_cvt_pk_bf16_f32 v238, 0, v238
  v_cvt_pk_bf16_f32 v239, 0, v239
  v_mul_f32 v184, v184, |v184|
  v_mul_f32 v185, v185, |v185|
  ds_read_b64_tr_b16 v[112:113], v6 offset:43104
  ds_read_b64_tr_b16 v[114:115], v6 offset:46176
  v_mfma_f32_16x16x32_bf16 v[168:171], v[116:119], v[84:87], v[168:171]
  v_mul_f32 v186, v186, |v186|
  v_mul_f32 v187, v187, |v187|
  v_mul_f32 v236, v236, |v236|
  v_mul_f32 v237, v237, |v237|
  v_mfma_f32_16x16x32_bf16 v[220:223], v[116:119], v[88:91], v[220:223]
  v_mul_f32 v238, v238, |v238|
  v_mul_f32 v239, v239, |v239|
  v_cvt_pk_bf16_f32 v128, v184, v185
  v_cvt_pk_bf16_f32 v129, v186, v187
  ds_read_b64_tr_b16 v[116:117], v5 offset:43136
  ds_read_b64_tr_b16 v[118:119], v5 offset:46208
  v_mfma_f32_16x16x32_bf16 v[172:175], v[120:123], v[84:87], v[172:175]
  v_cvt_pk_bf16_f32 v140, v236, v237
  v_cvt_pk_bf16_f32 v141, v238, v239
  v_pk_max_i16 v128, v128, 0
  v_mfma_f32_16x16x32_bf16 v[224:227], v[120:123], v[88:91], v[224:227]
  v_pk_max_i16 v129, v129, 0
  v_pk_max_i16 v140, v140, 0
  v_pk_max_i16 v141, v141, 0
  v_lshlrev_b32 v36, 16, v20
  ds_read_b64_tr_b16 v[120:121], v6 offset:43168
  ds_read_b64_tr_b16 v[122:123], v6 offset:46240
  s_waitcnt lgkmcnt(6)
  v_mfma_f32_16x16x32_bf16 v[152:155], v[100:103], v[92:95], v[152:155]
  v_and_b32 v37, s57, v20
  v_lshlrev_b32 v38, 16, v21
  v_and_b32 v39, s57, v21
  v_cvt_pk_bf16_f32 v188, 0, v188
  v_mfma_f32_16x16x32_bf16 v[204:207], v[100:103], v[96:99], v[204:207]
  v_cvt_pk_bf16_f32 v189, 0, v189
  v_cvt_pk_bf16_f32 v190, 0, v190
  v_cvt_pk_bf16_f32 v191, 0, v191
  v_cvt_pk_bf16_f32 v240, 0, v240
  v_mfma_f32_16x16x32_bf16 v[156:159], v[104:107], v[92:95], v[156:159]
  v_cvt_pk_bf16_f32 v241, 0, v241
  v_cvt_pk_bf16_f32 v242, 0, v242
  v_cvt_pk_bf16_f32 v243, 0, v243
  v_mfma_f32_16x16x32_bf16 v[208:211], v[104:107], v[96:99], v[208:211]
  v_add_f32 v188, v188, v36
  v_add_f32 v189, v189, v37
  v_add_f32 v190, v190, v38
  v_add_f32 v191, v191, v39
  v_mfma_f32_16x16x32_bf16 v[160:163], v[108:111], v[92:95], v[160:163]
  v_add_f32 v240, v240, v36
  v_add_f32 v241, v241, v37
  v_add_f32 v242, v242, v38
  v_add_f32 v243, v243, v39
  v_mfma_f32_16x16x32_bf16 v[212:215], v[108:111], v[96:99], v[212:215]
  v_cvt_pk_bf16_f32 v188, 0, v188
  v_cvt_pk_bf16_f32 v189, 0, v189
  v_cvt_pk_bf16_f32 v190, 0, v190
  v_cvt_pk_bf16_f32 v191, 0, v191
  s_waitcnt lgkmcnt(0)
  v_mfma_f32_16x16x32_bf16 v[164:167], v[112:115], v[92:95], v[164:167]
  v_cvt_pk_bf16_f32 v240, 0, v240
  v_cvt_pk_bf16_f32 v241, 0, v241
  v_cvt_pk_bf16_f32 v242, 0, v242
  v_cvt_pk_bf16_f32 v243, 0, v243
  v_mfma_f32_16x16x32_bf16 v[216:219], v[112:115], v[96:99], v[216:219]
  v_mul_f32 v188, v188, |v188|
  v_mul_f32 v189, v189, |v189|
  v_mul_f32 v190, v190, |v190|
  v_mfma_f32_16x16x32_bf16 v[168:171], v[116:119], v[92:95], v[168:171]
  v_mul_f32 v191, v191, |v191|
  v_mul_f32 v240, v240, |v240|
  v_mul_f32 v241, v241, |v241|
  v_mul_f32 v242, v242, |v242|
  v_mfma_f32_16x16x32_bf16 v[220:223], v[116:119], v[96:99], v[220:223]
  v_mul_f32 v243, v243, |v243|
  v_cvt_pk_bf16_f32 v130, v188, v189
  v_cvt_pk_bf16_f32 v131, v190, v191
  v_cvt_pk_bf16_f32 v142, v240, v241
  v_mfma_f32_16x16x32_bf16 v[172:175], v[120:123], v[92:95], v[172:175]
  v_cvt_pk_bf16_f32 v143, v242, v243
  v_pk_max_i16 v130, v130, 0
  v_pk_max_i16 v131, v131, 0
  v_pk_max_i16 v142, v142, 0
  v_mfma_f32_16x16x32_bf16 v[224:227], v[120:123], v[96:99], v[224:227]
  v_pk_max_i16 v143, v143, 0
  buffer_store_dwordx4 v[128:131], v2, s[28:31], s92 offen offset:2048 sc1
  buffer_store_dwordx4 v[140:143], v2, s[28:31], s92 offen offset:3072 sc1
  v_lshlrev_b32 v36, 16, v22
  v_and_b32 v37, s57, v22
  v_lshlrev_b32 v38, 16, v23
  v_and_b32 v39, s57, v23
  v_cvt_pk_bf16_f32 v192, 0, v192
  v_cvt_pk_bf16_f32 v193, 0, v193
  v_cvt_pk_bf16_f32 v194, 0, v194
  v_cvt_pk_bf16_f32 v195, 0, v195
  v_cvt_pk_bf16_f32 v244, 0, v244
  v_cvt_pk_bf16_f32 v245, 0, v245
  v_cvt_pk_bf16_f32 v246, 0, v246
  v_cvt_pk_bf16_f32 v247, 0, v247
  v_pk_add_f32 v[192:193], v[192:193], v[36:37]
  v_pk_add_f32 v[194:195], v[194:195], v[38:39]
  v_pk_add_f32 v[244:245], v[244:245], v[36:37]
  v_pk_add_f32 v[246:247], v[246:247], v[38:39]
  v_cvt_pk_bf16_f32 v132, v192, v193
  v_cvt_pk_bf16_f32 v133, v194, v195
  v_cvt_pk_bf16_f32 v144, v244, v245
  v_cvt_pk_bf16_f32 v145, v246, v247
  v_pk_max_i16 v132, v132, 0
  v_pk_max_i16 v133, v133, 0
  v_pk_max_i16 v144, v144, 0
  v_pk_max_i16 v145, v145, 0
  v_lshlrev_b32 v192, 16, v132
  v_and_b32 v193, s57, v132
  v_lshlrev_b32 v194, 16, v133
  v_and_b32 v195, s57, v133
  v_lshlrev_b32 v244, 16, v144
  v_and_b32 v245, s57, v144
  v_lshlrev_b32 v246, 16, v145
  v_and_b32 v247, s57, v145
  v_pk_mul_f32 v[192:193], v[192:193], v[192:193]
  v_pk_mul_f32 v[194:195], v[194:195], v[194:195]
  v_pk_mul_f32 v[244:245], v[244:245], v[244:245]
  v_pk_mul_f32 v[246:247], v[246:247], v[246:247]
  v_cvt_pk_bf16_f32 v132, v192, v193
  v_cvt_pk_bf16_f32 v133, v194, v195
  v_cvt_pk_bf16_f32 v144, v244, v245
  v_cvt_pk_bf16_f32 v145, v246, v247
  v_lshlrev_b32 v36, 16, v24
  v_and_b32 v37, s57, v24
  v_lshlrev_b32 v38, 16, v25
  v_and_b32 v39, s57, v25
  v_cvt_pk_bf16_f32 v196, 0, v196
  v_cvt_pk_bf16_f32 v197, 0, v197
  v_cvt_pk_bf16_f32 v198, 0, v198
  v_cvt_pk_bf16_f32 v199, 0, v199
  v_cvt_pk_bf16_f32 v248, 0, v248
  v_cvt_pk_bf16_f32 v249, 0, v249
  v_cvt_pk_bf16_f32 v250, 0, v250
  v_cvt_pk_bf16_f32 v251, 0, v251
  v_pk_add_f32 v[196:197], v[196:197], v[36:37]
  v_pk_add_f32 v[198:199], v[198:199], v[38:39]
  v_pk_add_f32 v[248:249], v[248:249], v[36:37]
  v_pk_add_f32 v[250:251], v[250:251], v[38:39]
  v_cvt_pk_bf16_f32 v134, v196, v197
  v_cvt_pk_bf16_f32 v135, v198, v199
  v_cvt_pk_bf16_f32 v146, v248, v249
  v_cvt_pk_bf16_f32 v147, v250, v251
  v_pk_max_i16 v134, v134, 0
  v_pk_max_i16 v135, v135, 0
  v_pk_max_i16 v146, v146, 0
  v_pk_max_i16 v147, v147, 0
  v_lshlrev_b32 v196, 16, v134
  v_and_b32 v197, s57, v134
  v_lshlrev_b32 v198, 16, v135
  v_and_b32 v199, s57, v135
  v_lshlrev_b32 v248, 16, v146
  v_and_b32 v249, s57, v146
  v_lshlrev_b32 v250, 16, v147
  v_and_b32 v251, s57, v147
  v_pk_mul_f32 v[196:197], v[196:197], v[196:197]
  v_pk_mul_f32 v[198:199], v[198:199], v[198:199]
  v_pk_mul_f32 v[248:249], v[248:249], v[248:249]
  v_pk_mul_f32 v[250:251], v[250:251], v[250:251]
  v_cvt_pk_bf16_f32 v134, v196, v197
  v_cvt_pk_bf16_f32 v135, v198, v199
  v_cvt_pk_bf16_f32 v146, v248, v249
  v_cvt_pk_bf16_f32 v147, v250, v251
  s_add_u32 s92, s92, 4096
  buffer_store_dwordx4 v[132:135], v2, s[28:31], s92 offen offset:0 sc1
  buffer_store_dwordx4 v[144:147], v2, s[28:31], s92 offen offset:1024 sc1
  v_lshlrev_b32 v36, 16, v26
  v_and_b32 v37, s57, v26
  v_lshlrev_b32 v38, 16, v27
  v_and_b32 v39, s57, v27
  v_cvt_pk_bf16_f32 v200, 0, v200
  v_cvt_pk_bf16_f32 v201, 0, v201
  v_cvt_pk_bf16_f32 v202, 0, v202
  v_cvt_pk_bf16_f32 v203, 0, v203
  v_cvt_pk_bf16_f32 v252, 0, v252
  v_cvt_pk_bf16_f32 v253, 0, v253
  v_cvt_pk_bf16_f32 v254, 0, v254
  v_cvt_pk_bf16_f32 v255, 0, v255
  v_pk_add_f32 v[200:201], v[200:201], v[36:37]
  v_pk_add_f32 v[202:203], v[202:203], v[38:39]
  v_pk_add_f32 v[252:253], v[252:253], v[36:37]
  v_pk_add_f32 v[254:255], v[254:255], v[38:39]
  v_cvt_pk_bf16_f32 v148, v200, v201
  v_cvt_pk_bf16_f32 v149, v202, v203
  v_cvt_pk_bf16_f32 v150, v252, v253
  v_cvt_pk_bf16_f32 v151, v254, v255
  v_pk_max_i16 v148, v148, 0
  v_pk_max_i16 v149, v149, 0
  v_pk_max_i16 v150, v150, 0
  v_pk_max_i16 v151, v151, 0
  v_lshlrev_b32 v200, 16, v148
  v_and_b32 v201, s57, v148
  v_lshlrev_b32 v202, 16, v149
  v_and_b32 v203, s57, v149
  v_lshlrev_b32 v252, 16, v150
  v_and_b32 v253, s57, v150
  v_lshlrev_b32 v254, 16, v151
  v_and_b32 v255, s57, v151
  v_pk_mul_f32 v[200:201], v[200:201], v[200:201]
  v_pk_mul_f32 v[202:203], v[202:203], v[202:203]
  v_pk_mul_f32 v[252:253], v[252:253], v[252:253]
  v_pk_mul_f32 v[254:255], v[254:255], v[254:255]
  v_cvt_pk_bf16_f32 v148, v200, v201
  v_cvt_pk_bf16_f32 v149, v202, v203
  v_cvt_pk_bf16_f32 v150, v252, v253
  v_cvt_pk_bf16_f32 v151, v254, v255
  s_lshl_b32 s92, s37, 10
  s_bitcmp1_b32 s37, 3
  s_cbranch_scc0 L1_hr
  s_xor_b32 s92, s92, 1024
  v_swap_b32 v148, v150
  v_swap_b32 v149, v151
L1_hr:
  s_add_u32 s92, s92, s59
  s_add_u32 s92, s92, 262144
  buffer_store_dwordx4 v[148:151], v2, s[28:31], s92 offen sc1
  v_lshrrev_b32 v108, 4, v1
  v_and_b32 v109, 15, v1
  s_lshl_b32 s48, s36, 5
  v_add_u32 v7, s48, v109
  v_lshlrev_b32 v7, 8, v7
  v_and_b32 v110, 7, v109
  v_lshl_add_u32 v7, v110, 5, v7
  v_lshrrev_b32 v110, 2, v109
  v_xor_b32 v110, v110, v108
  v_lshl_add_u32 v7, v110, 3, v7
  v_lshrrev_b32 v110, 2, v1
  v_lshlrev_b32 v8, 8, v110
  v_and_b32 v110, 7, v110
  v_lshl_add_u32 v8, v110, 5, v8
  v_and_b32 v110, 3, v1
  v_xor_b32 v110, v110, v108
  v_lshl_add_u32 v8, v110, 3, v8
  v_mov_b32 v5, 1
  v_mov_b32 v6, 2130706432
  v_cmp_eq_u32 vcc, 0, v1
  s_nop 1
  v_cndmask_b32 v6, v6, 0, vcc
  v_cvt_pk_bf16_f32 v160, v160, v161
  v_cvt_pk_bf16_f32 v161, v162, v163
  v_cvt_pk_bf16_f32 v162, v164, v165
  v_cvt_pk_bf16_f32 v163, v166, v167
  v_cvt_pk_bf16_f32 v212, v212, v213
  v_cvt_pk_bf16_f32 v213, v214, v215
  v_cvt_pk_bf16_f32 v214, v216, v217
  v_cvt_pk_bf16_f32 v215, v218, v219
  v_cvt_pk_bf16_f32 v36, v152, v153
  v_cvt_pk_bf16_f32 v37, v154, v155
  v_cvt_pk_bf16_f32 v38, v156, v157
  v_cvt_pk_bf16_f32 v39, v158, v159
  v_cvt_pk_bf16_f32 v40, v204, v205
  v_cvt_pk_bf16_f32 v41, v206, v207
  v_cvt_pk_bf16_f32 v42, v208, v209
  v_cvt_pk_bf16_f32 v43, v210, v211
  v_cvt_pk_bf16_f32 v168, v168, v169
  v_cvt_pk_bf16_f32 v169, v170, v171
  v_cvt_pk_bf16_f32 v170, v172, v173
  v_cvt_pk_bf16_f32 v171, v174, v175
  v_cvt_pk_bf16_f32 v220, v220, v221
  v_cvt_pk_bf16_f32 v221, v222, v223
  v_cvt_pk_bf16_f32 v222, v224, v225
  v_cvt_pk_bf16_f32 v223, v226, v227
  v_mfma_f32_16x16x32_bf16 v[52:55], v[28:31], v[160:163], 0
  v_mfma_f32_16x16x32_bf16 v[56:59], v[32:35], v[160:163], 0
  v_mfma_f32_16x16x32_bf16 v[60:63], v[28:31], v[212:215], 0
  v_mfma_f32_16x16x32_bf16 v[64:67], v[32:35], v[212:215], 0
  s_nop 4
  v_cvt_pk_bf16_f32 v52, 0, v52
  v_cvt_pk_bf16_f32 v53, 0, v53
  v_cvt_pk_bf16_f32 v54, 0, v54
  v_cvt_pk_bf16_f32 v55, 0, v55
  v_cvt_pk_bf16_f32 v56, 0, v56
  v_cvt_pk_bf16_f32 v57, 0, v57
  v_cvt_pk_bf16_f32 v58, 0, v58
  v_cvt_pk_bf16_f32 v59, 0, v59
  v_cvt_pk_bf16_f32 v60, 0, v60
  v_cvt_pk_bf16_f32 v61, 0, v61
  v_cvt_pk_bf16_f32 v62, 0, v62
  v_cvt_pk_bf16_f32 v63, 0, v63
  v_cvt_pk_bf16_f32 v64, 0, v64
  v_cvt_pk_bf16_f32 v65, 0, v65
  v_cvt_pk_bf16_f32 v66, 0, v66
  v_cvt_pk_bf16_f32 v67, 0, v67
  v_max3_f32 v100, v52, v53, v54
  v_min3_f32 v101, v52, v53, v54
  v_max3_f32 v100, v100, v55, v56
  v_min3_f32 v101, v101, v55, v56
  v_max3_f32 v100, v100, v57, v58
  v_min3_f32 v101, v101, v57, v58
  v_max_f32 v100, v100, v59
  v_max_f32 v101, -v101, -v59
  v_max3_f32 v102, v60, v61, v62
  v_min3_f32 v103, v60, v61, v62
  v_max3_f32 v102, v102, v63, v64
  v_min3_f32 v103, v103, v63, v64
  v_max3_f32 v102, v102, v65, v66
  v_min3_f32 v103, v103, v65, v66
  v_max_f32 v102, v102, v67
  v_max_f32 v103, -v103, -v67
  v_permlane32_swap_b32 v100, v101
  s_nop 0
  v_permlane32_swap_b32 v102, v103
  v_max_f32 v100, v100, v101
  v_max_f32 v102, v102, v103
  s_nop 1
  v_permlane16_swap_b32 v100, v102
  v_max_f32 v100, v100, v102
  v_mov_b32 v102, v100
  s_nop 1
  v_permlane16_swap_b32 v100, v102
  v_mov_b32 v101, v100
  v_mov_b32 v103, v102
  s_nop 0
  v_permlane32_swap_b32 v100, v101
  v_permlane32_swap_b32 v102, v103
  v_mul_f32 v100, s56, v100
  v_mul_f32 v104, s56, v101
  v_mul_f32 v102, s56, v102
  v_mul_f32 v106, s56, v103
  v_pk_fma_f32 v[68:69], v[52:53], s[56:57], v[100:101] op_sel_hi:[1,0,0] neg_lo:[0,0,1] neg_hi:[0,0,1]
  v_pk_fma_f32 v[70:71], v[54:55], s[56:57], v[100:101] op_sel_hi:[1,0,0] neg_lo:[0,0,1] neg_hi:[0,0,1]
  v_pk_fma_f32 v[72:73], v[56:57], s[56:57], v[100:101] op_sel_hi:[1,0,0] neg_lo:[0,0,1] neg_hi:[0,0,1]
  v_pk_fma_f32 v[74:75], v[58:59], s[56:57], v[100:101] op_sel_hi:[1,0,0] neg_lo:[0,0,1] neg_hi:[0,0,1]
  v_exp_f32 v68, v68
  v_exp_f32 v69, v69
  v_exp_f32 v70, v70
  v_exp_f32 v71, v71
  v_exp_f32 v72, v72
  v_exp_f32 v73, v73
  v_exp_f32 v74, v74
  v_exp_f32 v75, v75
  v_pk_fma_f32 v[76:77], v[52:53], s[56:57], v[104:105] op_sel_hi:[1,0,0] neg_lo:[1,0,1] neg_hi:[1,0,1]
  s_lshl_b32 s48, s39, 7
  s_lshl_b32 s49, s37, 2
  s_add_u32 s48, s48, s49
  s_add_u32 s94, s48, 29376512
  s_add_u32 s48, s48, 29368320
  s_waitcnt vmcnt(0)
  buffer_store_dword v5, v6, s[28:31], s48 offen sc1
  v_pk_fma_f32 v[78:79], v[54:55], s[56:57], v[104:105] op_sel_hi:[1,0,0] neg_lo:[1,0,1] neg_hi:[1,0,1]
  v_pk_fma_f32 v[80:81], v[56:57], s[56:57], v[104:105] op_sel_hi:[1,0,0] neg_lo:[1,0,1] neg_hi:[1,0,1]
  v_pk_fma_f32 v[82:83], v[58:59], s[56:57], v[104:105] op_sel_hi:[1,0,0] neg_lo:[1,0,1] neg_hi:[1,0,1]
  v_exp_f32 v76, v76
  v_exp_f32 v77, v77
  v_exp_f32 v78, v78
  v_exp_f32 v79, v79
  v_exp_f32 v80, v80
  v_exp_f32 v81, v81
  v_exp_f32 v82, v82
  v_exp_f32 v83, v83
  v_pk_fma_f32 v[84:85], v[60:61], s[56:57], v[102:103] op_sel_hi:[1,0,0] neg_lo:[0,0,1] neg_hi:[0,0,1]
  v_pk_fma_f32 v[86:87], v[62:63], s[56:57], v[102:103] op_sel_hi:[1,0,0] neg_lo:[0,0,1] neg_hi:[0,0,1]
  v_pk_fma_f32 v[88:89], v[64:65], s[56:57], v[102:103] op_sel_hi:[1,0,0] neg_lo:[0,0,1] neg_hi:[0,0,1]
  v_pk_fma_f32 v[90:91], v[66:67], s[56:57], v[102:103] op_sel_hi:[1,0,0] neg_lo:[0,0,1] neg_hi:[0,0,1]
  v_exp_f32 v84, v84
  v_exp_f32 v85, v85
  v_exp_f32 v86, v86
  v_exp_f32 v87, v87
  v_exp_f32 v88, v88
  v_exp_f32 v89, v89
  v_exp_f32 v90, v90
  v_exp_f32 v91, v91
  v_pk_fma_f32 v[92:93], v[60:61], s[56:57], v[106:107] op_sel_hi:[1,0,0] neg_lo:[1,0,1] neg_hi:[1,0,1]
  v_pk_fma_f32 v[94:95], v[62:63], s[56:57], v[106:107] op_sel_hi:[1,0,0] neg_lo:[1,0,1] neg_hi:[1,0,1]
  v_pk_fma_f32 v[96:97], v[64:65], s[56:57], v[106:107] op_sel_hi:[1,0,0] neg_lo:[1,0,1] neg_hi:[1,0,1]
  v_pk_fma_f32 v[98:99], v[66:67], s[56:57], v[106:107] op_sel_hi:[1,0,0] neg_lo:[1,0,1] neg_hi:[1,0,1]
  v_exp_f32 v92, v92
  v_exp_f32 v93, v93
  v_exp_f32 v94, v94
  v_exp_f32 v95, v95
  v_exp_f32 v96, v96
  v_exp_f32 v97, v97
  v_exp_f32 v98, v98
  v_exp_f32 v99, v99
  v_pk_add_f32 v[108:109], v[68:69], v[70:71]
  v_pk_add_f32 v[110:111], v[72:73], v[74:75]
  v_pk_add_f32 v[108:109], v[108:109], v[110:111]
  v_add_f32 v104, v108, v109
  v_pk_add_f32 v[108:109], v[76:77], v[78:79]
  v_pk_add_f32 v[110:111], v[80:81], v[82:83]
  s_add_u32 m0, s86, 40960
  s_add_u32 s85, s85, 65536
  buffer_load_dwordx4 v3, s[80:83], s85 offen lds
  v_pk_add_f32 v[108:109], v[108:109], v[110:111]
  v_add_f32 v105, v108, v109
  v_pk_add_f32 v[108:109], v[84:85], v[86:87]
  v_pk_add_f32 v[110:111], v[88:89], v[90:91]
  v_pk_add_f32 v[108:109], v[108:109], v[110:111]
  v_add_f32 v106, v108, v109
  v_pk_add_f32 v[108:109], v[92:93], v[94:95]
  v_pk_add_f32 v[110:111], v[96:97], v[98:99]
  v_pk_add_f32 v[108:109], v[108:109], v[110:111]
  v_add_f32 v107, v108, v109
  v_permlane32_swap_b32 v104, v105
  s_nop 0
  v_permlane32_swap_b32 v106, v107
  v_add_f32 v104, v104, v105
  v_add_f32 v106, v106, v107
  s_nop 1
  v_permlane16_swap_b32 v104, v106
  v_add_f32 v104, v104, v106
  v_mov_b32 v106, v104
  s_nop 1
  v_permlane16_swap_b32 v104, v106
  v_mov_b32 v105, v104
  v_mov_b32 v107, v106
  s_nop 0
  v_permlane32_swap_b32 v104, v105
  v_permlane32_swap_b32 v106, v107
  v_rcp_f32 v104, v104
  v_rcp_f32 v100, v105
  v_rcp_f32 v106, v106
  v_rcp_f32 v102, v107
  v_pk_mul_f32 v[68:69], v[68:69], v[104:105] op_sel_hi:[1,0]
  v_pk_mul_f32 v[70:71], v[70:71], v[104:105] op_sel_hi:[1,0]
  v_pk_mul_f32 v[72:73], v[72:73], v[104:105] op_sel_hi:[1,0]
  v_pk_mul_f32 v[74:75], v[74:75], v[104:105] op_sel_hi:[1,0]
  v_cvt_pk_bf16_f32 v52, v68, v69
  v_cvt_pk_bf16_f32 v53, v70, v71
  v_cvt_pk_bf16_f32 v54, v72, v73
  v_cvt_pk_bf16_f32 v55, v74, v75
  v_pk_mul_f32 v[76:77], v[76:77], v[100:101] op_sel_hi:[1,0]
  v_pk_mul_f32 v[78:79], v[78:79], v[100:101] op_sel_hi:[1,0]
  v_pk_mul_f32 v[80:81], v[80:81], v[100:101] op_sel_hi:[1,0]
  v_pk_mul_f32 v[82:83], v[82:83], v[100:101] op_sel_hi:[1,0]
  v_cvt_pk_bf16_f32 v56, v76, v77
  v_cvt_pk_bf16_f32 v57, v78, v79
  v_cvt_pk_bf16_f32 v58, v80, v81
  v_cvt_pk_bf16_f32 v59, v82, v83
  v_pk_mul_f32 v[84:85], v[84:85], v[106:107] op_sel_hi:[1,0]
  v_pk_mul_f32 v[86:87], v[86:87], v[106:107] op_sel_hi:[1,0]
  v_pk_mul_f32 v[88:89], v[88:89], v[106:107] op_sel_hi:[1,0]
  v_pk_mul_f32 v[90:91], v[90:91], v[106:107] op_sel_hi:[1,0]
  v_cvt_pk_bf16_f32 v60, v84, v85
  v_cvt_pk_bf16_f32 v61, v86, v87
  v_cvt_pk_bf16_f32 v62, v88, v89
  v_cvt_pk_bf16_f32 v63, v90, v91
  v_pk_mul_f32 v[92:93], v[92:93], v[102:103] op_sel_hi:[1,0]
  v_pk_mul_f32 v[94:95], v[94:95], v[102:103] op_sel_hi:[1,0]
  v_pk_mul_f32 v[96:97], v[96:97], v[102:103] op_sel_hi:[1,0]
  v_pk_mul_f32 v[98:99], v[98:99], v[102:103] op_sel_hi:[1,0]
  v_cvt_pk_bf16_f32 v64, v92, v93
  v_cvt_pk_bf16_f32 v65, v94, v95
  v_cvt_pk_bf16_f32 v66, v96, v97
  s_add_u32 m0, s86, 41984
  s_nop 0
  buffer_load_dwordx4 v4, s[80:83], s85 offen lds
  v_cvt_pk_bf16_f32 v67, v98, v99
  s_barrier
  v_xor_b32 v108, 0, v7
  ds_write_b64 v108, v[52:53] offset:0
  ds_write_b64 v108, v[60:61] offset:4096
  v_xor_b32 v109, 32, v7
  ds_write_b64 v109, v[54:55] offset:0
  ds_write_b64 v109, v[62:63] offset:4096
  v_xor_b32 v108, 64, v7
  ds_write_b64 v108, v[56:57] offset:0
  ds_write_b64 v108, v[64:65] offset:4096
  v_xor_b32 v109, 96, v7
  ds_write_b64 v109, v[58:59] offset:0
  ds_write_b64 v109, v[66:67] offset:4096
  v_xor_b32 v108, 128, v7
  ds_write_b64 v108, v[168:169] offset:0
  ds_write_b64 v108, v[220:221] offset:4096
  v_xor_b32 v109, 160, v7
  ds_write_b64 v109, v[170:171] offset:0
  ds_write_b64 v109, v[222:223] offset:4096
  s_and_b32 s48, s36, 3
  s_lshl_b32 s48, s48, 5
  v_xor_b32 v110, s48, v8
  s_lshr_b32 s48, s36, 2
  s_add_u32 s48, s48, 4
  s_lshl_b32 s48, s48, 5
  v_xor_b32 v111, s48, v8
  v_mov_b32 v100, 0x3f803f80
  v_mov_b32 v101, 0x3f803f80
  v_mov_b32 v102, 0x3f803f80
  v_mov_b32 v103, 0x3f803f80
  s_lshl_b32 s48, s70, 10
  v_xor_b32 v26, s48, v2
  v_xor_b32 v27, 0x400, v26
  s_lshl_b32 s88, s72, 2
  s_add_u32 s88, s88, s71
  s_mul_i32 s48, s88, 294912
  s_add_u32 s48, s48, 4194304
  s_add_u32 s76, s8, s48
  s_addc_u32 s77, s9, 0
  s_mov_b32 s78, 294912
  s_mov_b32 s79, 0x20000
  s_mul_i32 s84, s75, 49152
  s_add_u32 s84, s84, 65536
  v_lshrrev_b32 v68, 2, v1
  v_and_b32 v69, 3, v1
  v_lshlrev_b32 v69, 3, v69
  v_add_u32 v69, s87, v69
  v_lshl_add_u32 v70, v68, 8, v69
  v_and_b32 v71, 7, v68
  v_lshlrev_b32 v71, 5, v71
  s_lshl_b32 s48, s74, 7
  v_xor_b32 v71, s48, v71
  v_add_u32 v14, v71, v70
  v_xor_b32 v15, 32, v14
  v_xor_b32 v16, 64, v14
  v_xor_b32 v17, 96, v14
  v_xor_b32 v18, 128, v14
  v_xor_b32 v19, 160, v14
  v_xor_b32 v20, 192, v14
  v_xor_b32 v21, 224, v14
  v_lshl_add_u32 v70, v68, 7, v69
  v_bfe_u32 v71, v1, 3, 2
  v_lshlrev_b32 v71, 5, v71
  v_add_u32 v22, v71, v70
  v_xor_b32 v23, 32, v22
  v_xor_b32 v24, 64, v22
  v_xor_b32 v25, 96, v22
  v_lshrrev_b32 v68, 3, v1
  s_lshl_b32 s48, s71, 3
  v_add_u32 v68, s48, v68
  v_lshlrev_b32 v9, 11, v68
  v_bfe_u32 v68, v1, 4, 2
  v_lshlrev_b32 v68, 1, v68
  v_and_b32 v69, 7, v1
  v_xor_b32 v68, v68, v69
  v_lshl_add_u32 v9, v68, 4, v9
  s_lshl_b32 s89, s73, 8
  s_lshl_b32 s48, s74, 7
  s_add_u32 s89, s89, s48
  v_add_u32 v9, s89, v9
  v_and_b32 v12, 15, v1
  v_lshlrev_b32 v12, 2, v12
  s_lshl_b32 s95, s88, 7
  s_add_u32 s95, s95, 29368320
  s_lshl_b32 s48, s75, 5
  v_and_b32 v108, 28, v12
  v_add_u32 v108, s48, v108
  s_lshl_b32 s48, s70, 6
  v_add_u32 v12, s48, v12
  s_waitcnt lgkmcnt(0)
  s_barrier
  buffer_load_dword v10, v108, s[28:31], s95 offen sc1
  ds_read_b64_tr_b16 v[68:69], v110 offset:0
  ds_read_b64_tr_b16 v[70:71], v110 offset:4096
  ds_read_b64_tr_b16 v[192:193], v111 offset:0
  ds_read_b64_tr_b16 v[194:195], v111 offset:4096
  ds_read_b64_tr_b16 v[72:73], v110 offset:8192
  ds_read_b64_tr_b16 v[74:75], v110 offset:12288
  ds_read_b64_tr_b16 v[196:197], v111 offset:8192
  ds_read_b64_tr_b16 v[198:199], v111 offset:12288
  ds_read_b64_tr_b16 v[76:77], v110 offset:16384
  ds_read_b64_tr_b16 v[78:79], v110 offset:20480
  ds_read_b64_tr_b16 v[200:201], v111 offset:16384
  ds_read_b64_tr_b16 v[202:203], v111 offset:20480
  ds_read_b64_tr_b16 v[80:81], v110 offset:24576
  ds_read_b64_tr_b16 v[82:83], v110 offset:28672
  ds_read_b64_tr_b16 v[204:205], v111 offset:24576
  ds_read_b64_tr_b16 v[206:207], v111 offset:28672
  s_waitcnt lgkmcnt(12)
  v_mfma_f32_16x16x32_bf16 v[52:55], v[68:71], v[192:195], 0
  v_mfma_f32_16x16x32_bf16 v[56:59], v[68:71], v[100:103], 0
  ds_read_b64_tr_b16 v[84:85], v110 offset:32768
  ds_read_b64_tr_b16 v[86:87], v110 offset:36864
  ds_read_b64_tr_b16 v[208:209], v111 offset:32768
  ds_read_b64_tr_b16 v[210:211], v111 offset:36864
  s_waitcnt lgkmcnt(12)
  v_mfma_f32_16x16x32_bf16 v[52:55], v[72:75], v[196:199], v[52:55]
  v_mfma_f32_16x16x32_bf16 v[56:59], v[72:75], v[100:103], v[56:59]
  ds_read_b64_tr_b16 v[88:89], v110 offset:40960
  ds_read_b64_tr_b16 v[90:91], v110 offset:45056
  ds_read_b64_tr_b16 v[212:213], v111 offset:40960
  ds_read_b64_tr_b16 v[214:215], v111 offset:45056
  s_waitcnt lgkmcnt(12)
  v_mfma_f32_16x16x32_bf16 v[52:55], v[76:79], v[200:203], v[52:55]
  v_mfma_f32_16x16x32_bf16 v[56:59], v[76:79], v[100:103], v[56:59]
  ds_read_b64_tr_b16 v[92:93], v110 offset:49152
  ds_read_b64_tr_b16 v[94:95], v110 offset:53248
  ds_read_b64_tr_b16 v[216:217], v111 offset:49152
  ds_read_b64_tr_b16 v[218:219], v111 offset:53248
  s_waitcnt lgkmcnt(12)
  v_mfma_f32_16x16x32_bf16 v[52:55], v[80:83], v[204:207], v[52:55]
  v_mfma_f32_16x16x32_bf16 v[56:59], v[80:83], v[100:103], v[56:59]
  ds_read_b64_tr_b16 v[96:97], v110 offset:57344
  ds_read_b64_tr_b16 v[98:99], v110 offset:61440
  ds_read_b64_tr_b16 v[220:221], v111 offset:57344
  ds_read_b64_tr_b16 v[222:223], v111 offset:61440
  s_waitcnt lgkmcnt(12)
  v_mfma_f32_16x16x32_bf16 v[52:55], v[84:87], v[208:211], v[52:55]
  v_mfma_f32_16x16x32_bf16 v[56:59], v[84:87], v[100:103], v[56:59]
  s_lshl_b32 s48, s37, 3
  s_add_u32 s48, s48, s38
  s_mul_i32 s48, s48, 12288
  s_add_u32 s48, s48, 25165824
  s_and_b32 s49, s40, 0xfff
  s_add_u32 s49, s49, s48
  s_add_u32 s49, s49, 8192
  s_add_u32 s48, s48, s40
  s_waitcnt lgkmcnt(8)
  v_mfma_f32_16x16x32_bf16 v[52:55], v[88:91], v[212:215], v[52:55]
  v_mfma_f32_16x16x32_bf16 v[56:59], v[88:91], v[100:103], v[56:59]
  s_waitcnt lgkmcnt(4)
  v_mfma_f32_16x16x32_bf16 v[52:55], v[92:95], v[216:219], v[52:55]
  v_mfma_f32_16x16x32_bf16 v[56:59], v[92:95], v[100:103], v[56:59]
  s_waitcnt lgkmcnt(0)
  v_mfma_f32_16x16x32_bf16 v[52:55], v[96:99], v[220:223], v[52:55]
  v_mfma_f32_16x16x32_bf16 v[56:59], v[96:99], v[100:103], v[56:59]
  s_nop 6
  buffer_store_dwordx4 v[52:55], v2, s[28:31], s48 offen sc1
  s_lshl_b32 s48, s70, 7
  s_add_u32 s49, s49, s48
  s_mov_b32 exec_lo, 0x10001
  s_mov_b32 exec_hi, 0x10001
  buffer_store_dwordx4 v[56:59], v1, s[28:31], s49 offen sc1
  s_mov_b64 exec, -1
  s_lshl_b32 s58, s37, 8
  s_lshl_b32 s48, s36, 5
  s_add_u32 s58, s58, s48
  s_add_u32 s58, s58, 29360128
  s_waitcnt vmcnt(2)
  v_cmp_ne_u32 vcc, 1, v10
  s_mov_b32 s3, 0
  s_nop 0
  s_cmp_eq_u64 vcc, 0
  s_cbranch_scc1 Lok1
Lsp2:
  s_sleep 16
  buffer_load_dword v10, v108, s[28:31], s95 offen sc1
  s_waitcnt vmcnt(0)
  v_cmp_ne_u32 vcc, 1, v10
  s_add_u32 s3, s3, 1
  s_nop 0
  s_cmp_eq_u64 vcc, 0
  s_cbranch_scc1 Lok1
  s_cmp_lt_u32 s3, 0x40000
  s_cbranch_scc1 Lsp2
Lok1:
  buffer_load_dwordx4 v[112:115], v26, s[76:79], s84 offen offset:0 sc1
  buffer_load_dwordx4 v[116:119], v27, s[76:79], s84 offen offset:0 sc1
  buffer_load_dwordx4 v[120:123], v26, s[76:79], s84 offen offset:2048 sc1
  buffer_load_dwordx4 v[124:127], v27, s[76:79], s84 offen offset:2048 sc1
  s_add_u32 s84, s84, 4096
  s_add_u32 s95, s95, 8192
  v_and_b32 v7, 7, v1
  v_lshlrev_b32 v7, 2, v7
  v_mfma_f32_16x16x32_bf16 v[52:55], v[28:31], v[36:39], 0
  v_mfma_f32_16x16x32_bf16 v[56:59], v[32:35], v[36:39], 0
  v_mfma_f32_16x16x32_bf16 v[60:63], v[28:31], v[40:43], 0
  v_mfma_f32_16x16x32_bf16 v[64:67], v[32:35], v[40:43], 0
  s_nop 4
  v_cvt_pk_bf16_f32 v52, 0, v52
  v_cvt_pk_bf16_f32 v53, 0, v53
  v_cvt_pk_bf16_f32 v54, 0, v54
  v_cvt_pk_bf16_f32 v55, 0, v55
  v_cvt_pk_bf16_f32 v56, 0, v56
  v_cvt_pk_bf16_f32 v57, 0, v57
  v_cvt_pk_bf16_f32 v58, 0, v58
  v_cvt_pk_bf16_f32 v59, 0, v59
  v_cvt_pk_bf16_f32 v60, 0, v60
  v_cvt_pk_bf16_f32 v61, 0, v61
  v_cvt_pk_bf16_f32 v62, 0, v62
  v_cvt_pk_bf16_f32 v63, 0, v63
  v_cvt_pk_bf16_f32 v64, 0, v64
  v_cvt_pk_bf16_f32 v65, 0, v65
  v_cvt_pk_bf16_f32 v66, 0, v66
  v_cvt_pk_bf16_f32 v67, 0, v67
  v_max3_f32 v100, v52, v53, v54
  v_min3_f32 v101, v52, v53, v54
  v_max3_f32 v100, v100, v55, v56
  v_min3_f32 v101, v101, v55, v56
  v_max3_f32 v100, v100, v57, v58
  v_min3_f32 v101, v101, v57, v58
  v_max_f32 v100, v100, v59
  v_max_f32 v101, -v101, -v59
  v_max3_f32 v102, v60, v61, v62
  v_min3_f32 v103, v60, v61, v62
  v_max3_f32 v102, v102, v63, v64
  v_min3_f32 v103, v103, v63, v64
  v_max3_f32 v102, v102, v65, v66
  v_min3_f32 v103, v103, v65, v66
  v_max_f32 v102, v102, v67
  v_max_f32 v103, -v103, -v67
  v_permlane32_swap_b32 v100, v101
  s_nop 0
  v_permlane32_swap_b32 v102, v103
  v_max_f32 v100, v100, v101
  v_max_f32 v102, v102, v103
  s_nop 1
  v_permlane16_swap_b32 v100, v102
  v_max_f32 v100, v100, v102
  v_mov_b32 v102, v100
  s_nop 1
  v_permlane16_swap_b32 v100, v102
  v_mov_b32 v101, v100
  v_mov_b32 v103, v102
  s_nop 0
  v_permlane32_swap_b32 v100, v101
  v_permlane32_swap_b32 v102, v103
  v_mul_f32 v100, s56, v100
  v_mul_f32 v104, s56, v101
  v_mul_f32 v102, s56, v102
  v_mul_f32 v106, s56, v103
  v_fma_f32 v68, v52, s56, -v100
  v_fma_f32 v69, v53, s56, -v100
  v_fma_f32 v70, v54, s56, -v100
  v_fma_f32 v71, v55, s56, -v100
  v_fma_f32 v72, v56, s56, -v100
  v_fma_f32 v73, v57, s56, -v100
  v_fma_f32 v74, v58, s56, -v100
  v_fma_f32 v75, v59, s56, -v100
  v_exp_f32 v68, v68
  s_lshl_b32 s48, s38, 2
  s_add_u32 s48, s48, s58
  s_waitcnt vmcnt(4)
  buffer_store_dword v5, v6, s[28:31], s48 offen sc1
  s_barrier
  ds_read_b64_tr_b16 v[160:161], v14 offset:0
  ds_read_b64_tr_b16 v[162:163], v14 offset:4096
  ds_read_b64_tr_b16 v[164:165], v15 offset:0
  ds_read_b64_tr_b16 v[166:167], v15 offset:4096
  ds_read_b64_tr_b16 v[168:169], v16 offset:0
  ds_read_b64_tr_b16 v[170:171], v16 offset:4096
  ds_read_b64_tr_b16 v[172:173], v17 offset:0
  ds_read_b64_tr_b16 v[174:175], v17 offset:4096
  ds_read_b64_tr_b16 v[176:177], v18 offset:0
  ds_read_b64_tr_b16 v[178:179], v18 offset:4096
  ds_read_b64_tr_b16 v[180:181], v19 offset:0
  ds_read_b64_tr_b16 v[182:183], v19 offset:4096
  ds_read_b64_tr_b16 v[184:185], v20 offset:0
  ds_read_b64_tr_b16 v[186:187], v20 offset:4096
  ds_read_b64_tr_b16 v[188:189], v21 offset:0
  ds_read_b64_tr_b16 v[190:191], v21 offset:4096
  s_waitcnt vmcnt(3)
  s_setprio 3
  s_barrier
  s_waitcnt lgkmcnt(8)
  v_mfma_f32_16x16x32_bf16 v[192:195], v[160:163], v[112:115], 0
  v_exp_f32 v69, v69
  v_mfma_f32_16x16x32_bf16 v[224:227], v[160:163], v[116:119], 0
  v_exp_f32 v70, v70
  ds_read_b64_tr_b16 v[160:161], v14 offset:8192
  ds_read_b64_tr_b16 v[162:163], v14 offset:12288
  buffer_load_dwordx4 v[128:131], v26, s[76:79], s84 offen offset:0 sc1
  v_mfma_f32_16x16x32_bf16 v[196:199], v[164:167], v[112:115], 0
  v_exp_f32 v71, v71
  v_mfma_f32_16x16x32_bf16 v[228:231], v[164:167], v[116:119], 0
  v_exp_f32 v72, v72
  s_setprio 2
  ds_read_b64_tr_b16 v[164:165], v15 offset:8192
  ds_read_b64_tr_b16 v[166:167], v15 offset:12288
  v_mfma_f32_16x16x32_bf16 v[200:203], v[168:171], v[112:115], 0
  v_exp_f32 v73, v73
  v_mfma_f32_16x16x32_bf16 v[232:235], v[168:171], v[116:119], 0
  v_exp_f32 v74, v74
  ds_read_b64_tr_b16 v[168:169], v16 offset:8192
  ds_read_b64_tr_b16 v[170:171], v16 offset:12288
  buffer_load_dwordx4 v[132:135], v27, s[76:79], s84 offen offset:0 sc1
  v_mfma_f32_16x16x32_bf16 v[204:207], v[172:175], v[112:115], 0
  v_exp_f32 v75, v75
  v_mfma_f32_16x16x32_bf16 v[236:239], v[172:175], v[116:119], 0
  v_fma_f32 v76, -v52, s56, -v104
  v_fma_f32 v77, -v53, s56, -v104
  s_setprio 1
  ds_read_b64_tr_b16 v[172:173], v17 offset:8192
  ds_read_b64_tr_b16 v[174:175], v17 offset:12288
  s_waitcnt lgkmcnt(8)
  v_mfma_f32_16x16x32_bf16 v[208:211], v[176:179], v[112:115], 0
  v_fma_f32 v78, -v54, s56, -v104
  v_fma_f32 v79, -v55, s56, -v104
  v_mfma_f32_16x16x32_bf16 v[240:243], v[176:179], v[116:119], 0
  v_fma_f32 v80, -v56, s56, -v104
  ds_read_b64_tr_b16 v[176:177], v18 offset:8192
  ds_read_b64_tr_b16 v[178:179], v18 offset:12288
  buffer_load_dwordx4 v[136:139], v26, s[76:79], s84 offen offset:2048 sc1
  v_mfma_f32_16x16x32_bf16 v[212:215], v[180:183], v[112:115], 0
  v_fma_f32 v81, -v57, s56, -v104
  v_fma_f32 v82, -v58, s56, -v104
  v_mfma_f32_16x16x32_bf16 v[244:247], v[180:183], v[116:119], 0
  v_fma_f32 v83, -v59, s56, -v104
  v_exp_f32 v76, v76
  s_setprio 0
  ds_read_b64_tr_b16 v[180:181], v19 offset:8192
  ds_read_b64_tr_b16 v[182:183], v19 offset:12288
  v_mfma_f32_16x16x32_bf16 v[216:219], v[184:187], v[112:115], 0
  v_exp_f32 v77, v77
  v_mfma_f32_16x16x32_bf16 v[248:251], v[184:187], v[116:119], 0
  v_exp_f32 v78, v78
  ds_read_b64_tr_b16 v[184:185], v20 offset:8192
  ds_read_b64_tr_b16 v[186:187], v20 offset:12288
  buffer_load_dwordx4 v[140:143], v27, s[76:79], s84 offen offset:2048 sc1
  s_add_u32 s84, s84, 4096
  v_mfma_f32_16x16x32_bf16 v[220:223], v[188:191], v[112:115], 0
  v_exp_f32 v79, v79
  v_mfma_f32_16x16x32_bf16 v[252:255], v[188:191], v[116:119], 0
  v_exp_f32 v80, v80
  ds_read_b64_tr_b16 v[188:189], v21 offset:8192
  ds_read_b64_tr_b16 v[190:191], v21 offset:12288
  s_waitcnt vmcnt(5)
  s_setprio 3
  s_barrier
  s_waitcnt lgkmcnt(8)
  v_mfma_f32_16x16x32_bf16 v[192:195], v[160:163], v[120:123], v[192:195]
  v_exp_f32 v81, v81
  v_mfma_f32_16x16x32_bf16 v[224:227], v[160:163], v[124:127], v[224:227]
  v_exp_f32 v82, v82
  ds_read_b64_tr_b16 v[160:161], v14 offset:16384
  ds_read_b64_tr_b16 v[162:163], v14 offset:20480
  s_add_u32 m0, s86, 0
  s_add_u32 s85, s85, 65536
  buffer_load_dwordx4 v3, s[80:83], s85 offen lds
  v_mfma_f32_16x16x32_bf16 v[196:199], v[164:167], v[120:123], v[196:199]
  v_exp_f32 v83, v83
  v_mfma_f32_16x16x32_bf16 v[228:231], v[164:167], v[124:127], v[228:231]
  s_setprio 2
  ds_read_b64_tr_b16 v[164:165], v15 offset:16384
  ds_read_b64_tr_b16 v[166:167], v15 offset:20480
  s_add_u32 m0, s86, 1024
  s_nop 0
  buffer_load_dwordx4 v4, s[80:83], s85 offen lds
  v_mfma_f32_16x16x32_bf16 v[200:203], v[168:171], v[120:123], v[200:203]
  v_fma_f32 v84, v60, s56, -v102
  v_fma_f32 v85, v61, s56, -v102
  v_mfma_f32_16x16x32_bf16 v[232:235], v[168:171], v[124:127], v[232:235]
  v_fma_f32 v86, v62, s56, -v102
  v_fma_f32 v87, v63, s56, -v102
  ds_read_b64_tr_b16 v[168:169], v16 offset:16384
  ds_read_b64_tr_b16 v[170:171], v16 offset:20480
  buffer_load_dwordx4 v[144:147], v26, s[76:79], s84 offen offset:0 sc1
  v_mfma_f32_16x16x32_bf16 v[204:207], v[172:175], v[120:123], v[204:207]
  v_fma_f32 v88, v64, s56, -v102
  v_fma_f32 v89, v65, s56, -v102
  v_mfma_f32_16x16x32_bf16 v[236:239], v[172:175], v[124:127], v[236:239]
  v_fma_f32 v90, v66, s56, -v102
  v_fma_f32 v91, v67, s56, -v102
  s_setprio 1
  ds_read_b64_tr_b16 v[172:173], v17 offset:16384
  ds_read_b64_tr_b16 v[174:175], v17 offset:20480
  s_waitcnt lgkmcnt(8)
  v_mfma_f32_16x16x32_bf16 v[208:211], v[176:179], v[120:123], v[208:211]
  v_exp_f32 v84, v84
  v_mfma_f32_16x16x32_bf16 v[240:243], v[176:179], v[124:127], v[240:243]
  v_exp_f32 v85, v85
  ds_read_b64_tr_b16 v[176:177], v18 offset:16384
  ds_read_b64_tr_b16 v[178:179], v18 offset:20480
  buffer_load_dwordx4 v[148:151], v27, s[76:79], s84 offen offset:0 sc1
  v_mfma_f32_16x16x32_bf16 v[212:215], v[180:183], v[120:123], v[212:215]
  v_exp_f32 v86, v86
  v_mfma_f32_16x16x32_bf16 v[244:247], v[180:183], v[124:127], v[244:247]
  v_exp_f32 v87, v87
  s_setprio 0
  ds_read_b64_tr_b16 v[180:181], v19 offset:16384
  ds_read_b64_tr_b16 v[182:183], v19 offset:20480
  buffer_load_dwordx4 v[152:155], v26, s[76:79], s84 offen offset:2048 sc1
  v_mfma_f32_16x16x32_bf16 v[216:219], v[184:187], v[120:123], v[216:219]
  v_exp_f32 v88, v88
  v_mfma_f32_16x16x32_bf16 v[248:251], v[184:187], v[124:127], v[248:251]
  v_exp_f32 v89, v89
  ds_read_b64_tr_b16 v[184:185], v20 offset:16384
  ds_read_b64_tr_b16 v[186:187], v20 offset:20480
  buffer_load_dwordx4 v[156:159], v27, s[76:79], s84 offen offset:2048 sc1
  s_add_u32 s84, s84, 4096
  v_mfma_f32_16x16x32_bf16 v[220:223], v[188:191], v[120:123], v[220:223]
  v_exp_f32 v90, v90
  v_mfma_f32_16x16x32_bf16 v[252:255], v[188:191], v[124:127], v[252:255]
  v_exp_f32 v91, v91
  ds_read_b64_tr_b16 v[188:189], v21 offset:16384
  ds_read_b64_tr_b16 v[190:191], v21 offset:20480
  s_waitcnt vmcnt(8)
  s_setprio 3
  s_barrier
  s_waitcnt lgkmcnt(8)
  v_mfma_f32_16x16x32_bf16 v[192:195], v[160:163], v[128:131], v[192:195]
  v_fma_f32 v92, -v60, s56, -v106
  v_mfma_f32_16x16x32_bf16 v[224:227], v[160:163], v[132:135], v[224:227]
  v_fma_f32 v93, -v61, s56, -v106
  v_fma_f32 v94, -v62, s56, -v106
  ds_read_b64_tr_b16 v[160:161], v14 offset:24576
  ds_read_b64_tr_b16 v[162:163], v14 offset:28672
  s_add_u32 m0, s86, 8192
  s_add_u32 s85, s85, 65536
  buffer_load_dwordx4 v3, s[80:83], s85 offen lds
  v_mfma_f32_16x16x32_bf16 v[196:199], v[164:167], v[128:131], v[196:199]
  v_fma_f32 v95, -v63, s56, -v106
  v_fma_f32 v96, -v64, s56, -v106
  v_mfma_f32_16x16x32_bf16 v[228:231], v[164:167], v[132:135], v[228:231]
  v_fma_f32 v97, -v65, s56, -v106
  v_fma_f32 v98, -v66, s56, -v106
  s_setprio 2
  ds_read_b64_tr_b16 v[164:165], v15 offset:24576
  ds_read_b64_tr_b16 v[166:167], v15 offset:28672
  s_add_u32 m0, s86, 9216
  s_nop 0
  buffer_load_dwordx4 v4, s[80:83], s85 offen lds
  v_mfma_f32_16x16x32_bf16 v[200:203], v[168:171], v[128:131], v[200:203]
  v_fma_f32 v99, -v67, s56, -v106
  v_exp_f32 v92, v92
  v_mfma_f32_16x16x32_bf16 v[232:235], v[168:171], v[132:135], v[232:235]
  v_exp_f32 v93, v93
  ds_read_b64_tr_b16 v[168:169], v16 offset:24576
  ds_read_b64_tr_b16 v[170:171], v16 offset:28672
  buffer_load_dwordx4 v[112:115], v26, s[76:79], s84 offen offset:0 sc1
  v_mfma_f32_16x16x32_bf16 v[204:207], v[172:175], v[128:131], v[204:207]
  v_mfma_f32_16x16x32_bf16 v[236:239], v[172:175], v[132:135], v[236:239]
  v_exp_f32 v94, v94
  s_setprio 1
  ds_read_b64_tr_b16 v[172:173], v17 offset:24576
  ds_read_b64_tr_b16 v[174:175], v17 offset:28672
  s_waitcnt lgkmcnt(8)
  v_mfma_f32_16x16x32_bf16 v[208:211], v[176:179], v[128:131], v[208:211]
  v_exp_f32 v95, v95
  v_mfma_f32_16x16x32_bf16 v[240:243], v[176:179], v[132:135], v[240:243]
  v_exp_f32 v96, v96
  ds_read_b64_tr_b16 v[176:177], v18 offset:24576
  ds_read_b64_tr_b16 v[178:179], v18 offset:28672
  buffer_load_dwordx4 v[116:119], v27, s[76:79], s84 offen offset:0 sc1
  v_mfma_f32_16x16x32_bf16 v[212:215], v[180:183], v[128:131], v[212:215]
  v_exp_f32 v97, v97
  v_mfma_f32_16x16x32_bf16 v[244:247], v[180:183], v[132:135], v[244:247]
  v_exp_f32 v98, v98
  s_setprio 0
  ds_read_b64_tr_b16 v[180:181], v19 offset:24576
  ds_read_b64_tr_b16 v[182:183], v19 offset:28672
  buffer_load_dwordx4 v[120:123], v26, s[76:79], s84 offen offset:2048 sc1
  v_mfma_f32_16x16x32_bf16 v[216:219], v[184:187], v[128:131], v[216:219]
  v_exp_f32 v99, v99
  v_mfma_f32_16x16x32_bf16 v[248:251], v[184:187], v[132:135], v[248:251]
  v_add_f32 v108, v68, v70
  v_add_f32 v109, v69, v71
  ds_read_b64_tr_b16 v[184:185], v20 offset:24576
  ds_read_b64_tr_b16 v[186:187], v20 offset:28672
  buffer_load_dwordx4 v[124:127], v27, s[76:79], s84 offen offset:2048 sc1
  s_add_u32 s84, s84, 4096
  v_mfma_f32_16x16x32_bf16 v[220:223], v[188:191], v[128:131], v[220:223]
  v_add_f32 v110, v72, v74
  v_add_f32 v111, v73, v75
  v_mfma_f32_16x16x32_bf16 v[252:255], v[188:191], v[132:135], v[252:255]
  v_add_f32 v108, v108, v110
  ds_read_b64_tr_b16 v[188:189], v21 offset:24576
  ds_read_b64_tr_b16 v[190:191], v21 offset:28672
  s_waitcnt vmcnt(12)
  s_setprio 3
  s_barrier
  s_waitcnt lgkmcnt(8)
  v_mfma_f32_16x16x32_bf16 v[192:195], v[160:163], v[136:139], v[192:195]
  v_add_f32 v109, v109, v111
  v_add_f32 v104, v108, v109
  v_mfma_f32_16x16x32_bf16 v[224:227], v[160:163], v[140:143], v[224:227]
  v_add_f32 v108, v76, v78
  v_add_f32 v109, v77, v79
  ds_read_b64_tr_b16 v[160:161], v14 offset:32768
  ds_read_b64_tr_b16 v[162:163], v14 offset:36864
  s_add_u32 m0, s86, 16384
  s_add_u32 s85, s85, 65536
  buffer_load_dwordx4 v3, s[80:83], s85 offen lds
  v_mfma_f32_16x16x32_bf16 v[196:199], v[164:167], v[136:139], v[196:199]
  v_add_f32 v110, v80, v82
  v_add_f32 v111, v81, v83
  v_mfma_f32_16x16x32_bf16 v[228:231], v[164:167], v[140:143], v[228:231]
  v_add_f32 v108, v108, v110
  v_add_f32 v109, v109, v111
  s_setprio 2
  ds_read_b64_tr_b16 v[164:165], v15 offset:32768
  ds_read_b64_tr_b16 v[166:167], v15 offset:36864
  v_mfma_f32_16x16x32_bf16 v[200:203], v[168:171], v[136:139], v[200:203]
  v_add_f32 v105, v108, v109
  v_add_f32 v108, v84, v86
  v_mfma_f32_16x16x32_bf16 v[232:235], v[168:171], v[140:143], v[232:235]
  v_add_f32 v109, v85, v87
  v_add_f32 v110, v88, v90
  ds_read_b64_tr_b16 v[168:169], v16 offset:32768
  ds_read_b64_tr_b16 v[170:171], v16 offset:36864
  s_add_u32 m0, s86, 17408
  s_nop 0
  buffer_load_dwordx4 v4, s[80:83], s85 offen lds
  v_mfma_f32_16x16x32_bf16 v[204:207], v[172:175], v[136:139], v[204:207]
  v_add_f32 v111, v89, v91
  v_add_f32 v108, v108, v110
  v_mfma_f32_16x16x32_bf16 v[236:239], v[172:175], v[140:143], v[236:239]
  v_add_f32 v109, v109, v111
  v_add_f32 v106, v108, v109
  s_setprio 1
  ds_read_b64_tr_b16 v[172:173], v17 offset:32768
  ds_read_b64_tr_b16 v[174:175], v17 offset:36864
  s_waitcnt lgkmcnt(8)
  v_mfma_f32_16x16x32_bf16 v[208:211], v[176:179], v[136:139], v[208:211]
  v_add_f32 v108, v92, v94
  v_add_f32 v109, v93, v95
  v_mfma_f32_16x16x32_bf16 v[240:243], v[176:179], v[140:143], v[240:243]
  v_add_f32 v110, v96, v98
  ds_read_b64_tr_b16 v[176:177], v18 offset:32768
  ds_read_b64_tr_b16 v[178:179], v18 offset:36864
  buffer_load_dwordx4 v[128:131], v26, s[76:79], s84 offen offset:0 sc1
  v_mfma_f32_16x16x32_bf16 v[212:215], v[180:183], v[136:139], v[212:215]
  v_add_f32 v111, v97, v99
  v_add_f32 v108, v108, v110
  v_mfma_f32_16x16x32_bf16 v[244:247], v[180:183], v[140:143], v[244:247]
  v_add_f32 v109, v109, v111
  v_add_f32 v107, v108, v109
  s_setprio 0
  ds_read_b64_tr_b16 v[180:181], v19 offset:32768
  ds_read_b64_tr_b16 v[182:183], v19 offset:36864
  v_mfma_f32_16x16x32_bf16 v[216:219], v[184:187], v[136:139], v[216:219]
  v_permlane32_swap_b32 v104, v105
  v_permlane32_swap_b32 v106, v107
  v_mfma_f32_16x16x32_bf16 v[248:251], v[184:187], v[140:143], v[248:251]
  v_add_f32 v104, v104, v105
  v_add_f32 v106, v106, v107
  ds_read_b64_tr_b16 v[184:185], v20 offset:32768
  ds_read_b64_tr_b16 v[186:187], v20 offset:36864
  buffer_load_dwordx4 v[132:135], v27, s[76:79], s84 offen offset:0 sc1
  v_mfma_f32_16x16x32_bf16 v[220:223], v[188:191], v[136:139], v[220:223]
  v_permlane16_swap_b32 v104, v106
  v_add_f32 v104, v104, v106
  v_mfma_f32_16x16x32_bf16 v[252:255], v[188:191], v[140:143], v[252:255]
  v_mov_b32 v106, v104
  s_nop 1
  v_permlane16_swap_b32 v104, v106
  ds_read_b64_tr_b16 v[188:189], v21 offset:32768
  ds_read_b64_tr_b16 v[190:191], v21 offset:36864
  s_waitcnt vmcnt(12)
  s_setprio 3
  s_barrier
  s_waitcnt lgkmcnt(8)
  v_mfma_f32_16x16x32_bf16 v[192:195], v[160:163], v[144:147], v[192:195]
  v_mov_b32 v105, v104
  v_mov_b32 v107, v106
  buffer_load_dword v8, v7, s[28:31], s58 offen sc1
  v_mfma_f32_16x16x32_bf16 v[224:227], v[160:163], v[148:151], v[224:227]
  v_permlane32_swap_b32 v104, v105
  v_permlane32_swap_b32 v106, v107
  ds_read_b64_tr_b16 v[160:161], v14 offset:40960
  ds_read_b64_tr_b16 v[162:163], v14 offset:45056
  s_add_u32 m0, s86, 24576
  s_add_u32 s85, s85, 65536
  buffer_load_dwordx4 v3, s[80:83], s85 offen lds
  v_mfma_f32_16x16x32_bf16 v[196:199], v[164:167], v[144:147], v[196:199]
  v_rcp_f32 v104, v104
  v_mfma_f32_16x16x32_bf16 v[228:231], v[164:167], v[148:151], v[228:231]
  v_rcp_f32 v100, v105
  s_setprio 2
  ds_read_b64_tr_b16 v[164:165], v15 offset:40960
  ds_read_b64_tr_b16 v[166:167], v15 offset:45056
  v_mfma_f32_16x16x32_bf16 v[200:203], v[168:171], v[144:147], v[200:203]
  v_rcp_f32 v106, v106
  v_mfma_f32_16x16x32_bf16 v[232:235], v[168:171], v[148:151], v[232:235]
  v_rcp_f32 v102, v107
  ds_read_b64_tr_b16 v[168:169], v16 offset:40960
  ds_read_b64_tr_b16 v[170:171], v16 offset:45056
  s_add_u32 m0, s86, 25600
  s_nop 0
  buffer_load_dwordx4 v4, s[80:83], s85 offen lds
  v_mfma_f32_16x16x32_bf16 v[204:207], v[172:175], v[144:147], v[204:207]
  v_mul_f32 v68, v104, v68
  v_mfma_f32_16x16x32_bf16 v[236:239], v[172:175], v[148:151], v[236:239]
  v_mul_f32 v69, v104, v69
  v_mul_f32 v70, v104, v70
  s_setprio 1
  ds_read_b64_tr_b16 v[172:173], v17 offset:40960
  ds_read_b64_tr_b16 v[174:175], v17 offset:45056
  s_waitcnt lgkmcnt(8)
  v_mfma_f32_16x16x32_bf16 v[208:211], v[176:179], v[144:147], v[208:211]
  v_mul_f32 v71, v104, v71
  v_mul_f32 v72, v104, v72
  s_mul_i32 s90, s37, 98304
  v_mfma_f32_16x16x32_bf16 v[240:243], v[176:179], v[148:151], v[240:243]
  v_mul_f32 v73, v104, v73
  v_mul_f32 v74, v104, v74
  s_add_u32 s90, s90, 25165824
  ds_read_b64_tr_b16 v[176:177], v18 offset:40960
  ds_read_b64_tr_b16 v[178:179], v18 offset:45056
  buffer_load_dwordx4 v[136:139], v26, s[76:79], s84 offen offset:2048 sc1
  v_mfma_f32_16x16x32_bf16 v[212:215], v[180:183], v[144:147], v[212:215]
  v_mul_f32 v75, v104, v75
  v_cvt_pk_bf16_f32 v52, v68, v69
  s_and_b32 s91, s40, 0xfff
  v_mfma_f32_16x16x32_bf16 v[244:247], v[180:183], v[148:151], v[244:247]
  v_cvt_pk_bf16_f32 v53, v70, v71
  v_cvt_pk_bf16_f32 v54, v72, v73
  s_add_u32 s91, s91, s90
  s_setprio 0
  ds_read_b64_tr_b16 v[180:181], v19 offset:40960
  ds_read_b64_tr_b16 v[182:183], v19 offset:45056
  v_mfma_f32_16x16x32_bf16 v[216:219], v[184:187], v[144:147], v[216:219]
  v_cvt_pk_bf16_f32 v55, v74, v75
  s_add_u32 s91, s91, 8192
  v_mfma_f32_16x16x32_bf16 v[248:251], v[184:187], v[148:151], v[248:251]
  v_mul_f32 v76, v100, v76
  v_mul_f32 v77, v100, v77
  s_lshl_b32 s48, s70, 7
  s_add_u32 s91, s91, s48
  ds_read_b64_tr_b16 v[184:185], v20 offset:40960
  ds_read_b64_tr_b16 v[186:187], v20 offset:45056
  buffer_load_dwordx4 v[140:143], v27, s[76:79], s84 offen offset:2048 sc1
  s_add_u32 s84, s84, 4096
  v_mfma_f32_16x16x32_bf16 v[220:223], v[188:191], v[144:147], v[220:223]
  v_mul_f32 v78, v100, v78
  v_mul_f32 v79, v100, v79
  v_mfma_f32_16x16x32_bf16 v[252:255], v[188:191], v[148:151], v[252:255]
  v_mul_f32 v80, v100, v80
  v_mul_f32 v81, v100, v81
  s_add_u32 s90, s90, s40
  ds_read_b64_tr_b16 v[188:189], v21 offset:40960
  ds_read_b64_tr_b16 v[190:191], v21 offset:45056
  s_waitcnt vmcnt(15)
  s_setprio 3
  s_barrier
  s_waitcnt lgkmcnt(8)
  v_mfma_f32_16x16x32_bf16 v[192:195], v[160:163], v[152:155], v[192:195]
  v_mul_f32 v82, v100, v82
  v_mul_f32 v83, v100, v83
  v_and_b32 v0, 7, v1
  v_mfma_f32_16x16x32_bf16 v[224:227], v[160:163], v[156:159], v[224:227]
  v_cvt_pk_bf16_f32 v56, v76, v77
  v_cvt_pk_bf16_f32 v57, v78, v79
  ds_read_b64_tr_b16 v[160:161], v14 offset:0
  ds_read_b64_tr_b16 v[162:163], v14 offset:4096
  s_add_u32 m0, s86, 32768
  s_add_u32 s85, s85, 65536
  buffer_load_dwordx4 v3, s[80:83], s85 offen lds
  v_mfma_f32_16x16x32_bf16 v[196:199], v[164:167], v[152:155], v[196:199]
  v_cvt_pk_bf16_f32 v58, v80, v81
  v_cvt_pk_bf16_f32 v59, v82, v83
  v_mul_u32_u24 v0, 12288, v0
  v_mfma_f32_16x16x32_bf16 v[228:231], v[164:167], v[156:159], v[228:231]
  v_mul_f32 v84, v106, v84
  v_mul_f32 v85, v106, v85
  s_setprio 2
  ds_read_b64_tr_b16 v[164:165], v15 offset:0
  ds_read_b64_tr_b16 v[166:167], v15 offset:4096
  v_mfma_f32_16x16x32_bf16 v[200:203], v[168:171], v[152:155], v[200:203]
  v_mul_f32 v86, v106, v86
  v_mul_f32 v87, v106, v87
  v_lshrrev_b32 v11, 4, v1
  v_mfma_f32_16x16x32_bf16 v[232:235], v[168:171], v[156:159], v[232:235]
  v_mul_f32 v88, v106, v88
  v_mul_f32 v89, v106, v89
  ds_read_b64_tr_b16 v[168:169], v16 offset:0
  ds_read_b64_tr_b16 v[170:171], v16 offset:4096
  s_add_u32 m0, s86, 33792
  s_nop 0
  buffer_load_dwordx4 v4, s[80:83], s85 offen lds
  v_mfma_f32_16x16x32_bf16 v[204:207], v[172:175], v[152:155], v[204:207]
  v_mul_f32 v90, v106, v90
  v_lshl_add_u32 v0, v11, 4, v0
  v_mfma_f32_16x16x32_bf16 v[236:239], v[172:175], v[156:159], v[236:239]
  v_mul_f32 v91, v106, v91
  v_cvt_pk_bf16_f32 v60, v84, v85
  s_setprio 1
  ds_read_b64_tr_b16 v[172:173], v17 offset:0
  ds_read_b64_tr_b16 v[174:175], v17 offset:4096
  s_waitcnt lgkmcnt(8)
  v_mfma_f32_16x16x32_bf16 v[208:211], v[176:179], v[152:155], v[208:211]
  v_cvt_pk_bf16_f32 v61, v86, v87
  v_cvt_pk_bf16_f32 v62, v88, v89
  v_mfma_f32_16x16x32_bf16 v[240:243], v[176:179], v[156:159], v[240:243]
  v_cvt_pk_bf16_f32 v63, v90, v91
  v_mul_f32 v92, v102, v92
  ds_read_b64_tr_b16 v[176:177], v18 offset:0
  ds_read_b64_tr_b16 v[178:179], v18 offset:4096
  buffer_load_dwordx4 v[144:147], v26, s[76:79], s84 offen offset:0 sc1
  v_mfma_f32_16x16x32_bf16 v[212:215], v[180:183], v[152:155], v[212:215]
  v_mul_f32 v93, v102, v93
  v_mul_f32 v94, v102, v94
  v_mfma_f32_16x16x32_bf16 v[244:247], v[180:183], v[156:159], v[244:247]
  v_mul_f32 v95, v102, v95
  v_mul_f32 v96, v102, v96
  s_setprio 0
  ds_read_b64_tr_b16 v[180:181], v19 offset:0
  ds_read_b64_tr_b16 v[182:183], v19 offset:4096
  v_mfma_f32_16x16x32_bf16 v[216:219], v[184:187], v[152:155], v[216:219]
  v_mul_f32 v97, v102, v97
  v_mul_f32 v98, v102, v98
  v_mfma_f32_16x16x32_bf16 v[248:251], v[184:187], v[156:159], v[248:251]
  v_mul_f32 v99, v102, v99
  v_cvt_pk_bf16_f32 v64, v92, v93
  ds_read_b64_tr_b16 v[184:185], v20 offset:0
  ds_read_b64_tr_b16 v[186:187], v20 offset:4096
  buffer_load_dwordx4 v[148:151], v27, s[76:79], s84 offen offset:0 sc1
  v_mfma_f32_16x16x32_bf16 v[220:223], v[188:191], v[152:155], v[220:223]
  v_cvt_pk_bf16_f32 v65, v94, v95
  v_cvt_pk_bf16_f32 v66, v96, v97
  v_mfma_f32_16x16x32_bf16 v[252:255], v[188:191], v[156:159], v[252:255]
  v_cvt_pk_bf16_f32 v67, v98, v99
  s_waitcnt vmcnt(8)
  v_cmp_ne_u32 vcc, 1, v8
  s_mov_b32 s3, 0
  s_nop 0
  s_cmp_eq_u64 vcc, 0
  s_cbranch_scc1 Lok3
Lsp4:
  s_sleep 1
  buffer_load_dword v8, v7, s[28:31], s58 offen sc1
  s_waitcnt vmcnt(0)
  v_cmp_ne_u32 vcc, 1, v8
  s_add_u32 s3, s3, 1
  s_nop 0
  s_cmp_eq_u64 vcc, 0
  s_cbranch_scc1 Lok3
  s_cmp_lt_u32 s3, 0x40000
  s_cbranch_scc1 Lsp4
Lok3:
  ds_read_b64_tr_b16 v[188:189], v21 offset:0
  ds_read_b64_tr_b16 v[190:191], v21 offset:4096
  s_setprio 3
  s_barrier
  s_waitcnt lgkmcnt(8)
  v_mfma_f32_16x16x32_bf16 v[192:195], v[160:163], v[112:115], v[192:195]
  buffer_load_dwordx4 v[28:31], v0, s[28:31], s91 offen sc1
  v_mfma_f32_16x16x32_bf16 v[224:227], v[160:163], v[116:119], v[224:227]
  buffer_load_dwordx4 v[68:71], v2, s[28:31], s90 offen sc1
  s_add_u32 s90, s90, 12288
  ds_read_b64_tr_b16 v[160:161], v14 offset:8192
  ds_read_b64_tr_b16 v[162:163], v14 offset:12288
  s_add_u32 m0, s86, 40960
  s_add_u32 s85, s85, 65536
  buffer_load_dwordx4 v3, s[80:83], s85 offen lds
  v_mfma_f32_16x16x32_bf16 v[196:199], v[164:167], v[112:115], v[196:199]
  v_mfma_f32_16x16x32_bf16 v[228:231], v[164:167], v[116:119], v[228:231]
  s_setprio 2
  ds_read_b64_tr_b16 v[164:165], v15 offset:8192
  ds_read_b64_tr_b16 v[166:167], v15 offset:12288
  v_mfma_f32_16x16x32_bf16 v[200:203], v[168:171], v[112:115], v[200:203]
  buffer_load_dwordx4 v[72:75], v2, s[28:31], s90 offen sc1
  s_add_u32 s90, s90, 12288
  v_mfma_f32_16x16x32_bf16 v[232:235], v[168:171], v[116:119], v[232:235]
  ds_read_b64_tr_b16 v[168:169], v16 offset:8192
  ds_read_b64_tr_b16 v[170:171], v16 offset:12288
  s_add_u32 m0, s86, 41984
  s_nop 0
  buffer_load_dwordx4 v4, s[80:83], s85 offen lds
  v_mfma_f32_16x16x32_bf16 v[204:207], v[172:175], v[112:115], v[204:207]
  v_mfma_f32_16x16x32_bf16 v[236:239], v[172:175], v[116:119], v[236:239]
  buffer_load_dwordx4 v[76:79], v2, s[28:31], s90 offen sc1
  s_add_u32 s90, s90, 12288
  s_setprio 1
  ds_read_b64_tr_b16 v[172:173], v17 offset:8192
  ds_read_b64_tr_b16 v[174:175], v17 offset:12288
  s_waitcnt lgkmcnt(8)
  v_mfma_f32_16x16x32_bf16 v[208:211], v[176:179], v[112:115], v[208:211]
  v_mfma_f32_16x16x32_bf16 v[240:243], v[176:179], v[116:119], v[240:243]
  ds_read_b64_tr_b16 v[176:177], v18 offset:8192
  ds_read_b64_tr_b16 v[178:179], v18 offset:12288
  buffer_load_dwordx4 v[152:155], v26, s[76:79], s84 offen offset:2048 sc1
  v_mfma_f32_16x16x32_bf16 v[212:215], v[180:183], v[112:115], v[212:215]
  buffer_load_dwordx4 v[80:83], v2, s[28:31], s90 offen sc1
  s_add_u32 s90, s90, 12288
  v_mfma_f32_16x16x32_bf16 v[244:247], v[180:183], v[116:119], v[244:247]
  s_setprio 0
  ds_read_b64_tr_b16 v[180:181], v19 offset:8192
  ds_read_b64_tr_b16 v[182:183], v19 offset:12288
  v_mfma_f32_16x16x32_bf16 v[216:219], v[184:187], v[112:115], v[216:219]
  buffer_load_dwordx4 v[84:87], v2, s[28:31], s90 offen sc1
  s_add_u32 s90, s90, 12288
  v_mfma_f32_16x16x32_bf16 v[248:251], v[184:187], v[116:119], v[248:251]
  ds_read_b64_tr_b16 v[184:185], v20 offset:8192
  ds_read_b64_tr_b16 v[186:187], v20 offset:12288
  buffer_load_dwordx4 v[156:159], v27, s[76:79], s84 offen offset:2048 sc1
  s_add_u32 s84, s84, 4096
  v_mfma_f32_16x16x32_bf16 v[220:223], v[188:191], v[112:115], v[220:223]
  v_mfma_f32_16x16x32_bf16 v[252:255], v[188:191], v[116:119], v[252:255]
  buffer_load_dwordx4 v[88:91], v2, s[28:31], s90 offen sc1
  s_add_u32 s90, s90, 12288
  ds_read_b64_tr_b16 v[188:189], v21 offset:8192
  ds_read_b64_tr_b16 v[190:191], v21 offset:12288
  s_setprio 3
  s_barrier
  s_waitcnt lgkmcnt(8)
  v_mfma_f32_16x16x32_bf16 v[192:195], v[160:163], v[120:123], v[192:195]
  v_mfma_f32_16x16x32_bf16 v[224:227], v[160:163], v[124:127], v[224:227]
  ds_read_b64_tr_b16 v[160:161], v14 offset:16384
  ds_read_b64_tr_b16 v[162:163], v14 offset:20480
  s_add_u32 m0, s86, 0
  s_add_u32 s85, s85, 65536
  buffer_load_dwordx4 v3, s[80:83], s85 offen lds
  v_mfma_f32_16x16x32_bf16 v[196:199], v[164:167], v[120:123], v[196:199]
  buffer_load_dwordx4 v[92:95], v2, s[28:31], s90 offen sc1
  s_add_u32 s90, s90, 12288
  v_mfma_f32_16x16x32_bf16 v[228:231], v[164:167], v[124:127], v[228:231]
  s_setprio 2
  ds_read_b64_tr_b16 v[164:165], v15 offset:16384
  ds_read_b64_tr_b16 v[166:167], v15 offset:20480
  v_mfma_f32_16x16x32_bf16 v[200:203], v[168:171], v[120:123], v[200:203]
  v_mfma_f32_16x16x32_bf16 v[232:235], v[168:171], v[124:127], v[232:235]
  buffer_load_dwordx4 v[96:99], v2, s[28:31], s90 offen sc1
  s_add_u32 s90, s90, 12288
  ds_read_b64_tr_b16 v[168:169], v16 offset:16384
  ds_read_b64_tr_b16 v[170:171], v16 offset:20480
  s_add_u32 m0, s86, 1024
  s_nop 0
  buffer_load_dwordx4 v4, s[80:83], s85 offen lds
  v_mfma_f32_16x16x32_bf16 v[204:207], v[172:175], v[120:123], v[204:207]
  v_mfma_f32_16x16x32_bf16 v[236:239], v[172:175], v[124:127], v[236:239]
  s_setprio 1
  ds_read_b64_tr_b16 v[172:173], v17 offset:16384
  ds_read_b64_tr_b16 v[174:175], v17 offset:20480
  s_waitcnt lgkmcnt(8)
  v_mfma_f32_16x16x32_bf16 v[208:211], v[176:179], v[120:123], v[208:211]
  v_mfma_f32_16x16x32_bf16 v[240:243], v[176:179], v[124:127], v[240:243]
  ds_read_b64_tr_b16 v[176:177], v18 offset:16384
  ds_read_b64_tr_b16 v[178:179], v18 offset:20480
  buffer_load_dwordx4 v[112:115], v26, s[76:79], s84 offen offset:0 sc1
  v_mfma_f32_16x16x32_bf16 v[212:215], v[180:183], v[120:123], v[212:215]
  v_mfma_f32_16x16x32_bf16 v[244:247], v[180:183], v[124:127], v[244:247]
  s_setprio 0
  ds_read_b64_tr_b16 v[180:181], v19 offset:16384
  ds_read_b64_tr_b16 v[182:183], v19 offset:20480
  v_mfma_f32_16x16x32_bf16 v[216:219], v[184:187], v[120:123], v[216:219]
  v_mfma_f32_16x16x32_bf16 v[248:251], v[184:187], v[124:127], v[248:251]
  ds_read_b64_tr_b16 v[184:185], v20 offset:16384
  ds_read_b64_tr_b16 v[186:187], v20 offset:20480
  buffer_load_dwordx4 v[116:119], v27, s[76:79], s84 offen offset:0 sc1
  v_mfma_f32_16x16x32_bf16 v[220:223], v[188:191], v[120:123], v[220:223]
  v_mfma_f32_16x16x32_bf16 v[252:255], v[188:191], v[124:127], v[252:255]
  ds_read_b64_tr_b16 v[188:189], v21 offset:16384
  ds_read_b64_tr_b16 v[190:191], v21 offset:20480
  s_waitcnt vmcnt(23)
  s_setprio 3
  s_barrier
  s_waitcnt lgkmcnt(8)
  v_mfma_f32_16x16x32_bf16 v[192:195], v[160:163], v[128:131], v[192:195]
  v_mfma_f32_16x16x32_bf16 v[224:227], v[160:163], v[132:135], v[224:227]
  ds_read_b64_tr_b16 v[160:161], v14 offset:24576
  ds_read_b64_tr_b16 v[162:163], v14 offset:28672
  s_add_u32 m0, s86, 8192
  s_add_u32 s85, s85, 65536
  buffer_load_dwordx4 v3, s[80:83], s85 offen lds
  v_mfma_f32_16x16x32_bf16 v[196:199], v[164:167], v[128:131], v[196:199]
  v_mfma_f32_16x16x32_bf16 v[228:231], v[164:167], v[132:135], v[228:231]
  s_setprio 2
  ds_read_b64_tr_b16 v[164:165], v15 offset:24576
  ds_read_b64_tr_b16 v[166:167], v15 offset:28672
  v_mfma_f32_16x16x32_bf16 v[200:203], v[168:171], v[128:131], v[200:203]
  v_mfma_f32_16x16x32_bf16 v[232:235], v[168:171], v[132:135], v[232:235]
  ds_read_b64_tr_b16 v[168:169], v16 offset:24576
  ds_read_b64_tr_b16 v[170:171], v16 offset:28672
  s_add_u32 m0, s86, 9216
  s_nop 0
  buffer_load_dwordx4 v4, s[80:83], s85 offen lds
  v_mfma_f32_16x16x32_bf16 v[204:207], v[172:175], v[128:131], v[204:207]
  v_mfma_f32_16x16x32_bf16 v[236:239], v[172:175], v[132:135], v[236:239]
  s_setprio 1
  ds_read_b64_tr_b16 v[172:173], v17 offset:24576
  ds_read_b64_tr_b16 v[174:175], v17 offset:28672
  s_waitcnt lgkmcnt(8)
  v_mfma_f32_16x16x32_bf16 v[208:211], v[176:179], v[128:131], v[208:211]
  v_mfma_f32_16x16x32_bf16 v[240:243], v[176:179], v[132:135], v[240:243]
  ds_read_b64_tr_b16 v[176:177], v18 offset:24576
  ds_read_b64_tr_b16 v[178:179], v18 offset:28672
  buffer_load_dwordx4 v[120:123], v26, s[76:79], s84 offen offset:2048 sc1
  v_mfma_f32_16x16x32_bf16 v[212:215], v[180:183], v[128:131], v[212:215]
  v_mfma_f32_16x16x32_bf16 v[244:247], v[180:183], v[132:135], v[244:247]
  s_setprio 0
  ds_read_b64_tr_b16 v[180:181], v19 offset:24576
  ds_read_b64_tr_b16 v[182:183], v19 offset:28672
  v_mfma_f32_16x16x32_bf16 v[216:219], v[184:187], v[128:131], v[216:219]
  v_mfma_f32_16x16x32_bf16 v[248:251], v[184:187], v[132:135], v[248:251]
  ds_read_b64_tr_b16 v[184:185], v20 offset:24576
  ds_read_b64_tr_b16 v[186:187], v20 offset:28672
  buffer_load_dwordx4 v[124:127], v27, s[76:79], s84 offen offset:2048 sc1
  s_add_u32 s84, s84, 4096
  v_mfma_f32_16x16x32_bf16 v[220:223], v[188:191], v[128:131], v[220:223]
  v_mfma_f32_16x16x32_bf16 v[252:255], v[188:191], v[132:135], v[252:255]
  ds_read_b64_tr_b16 v[188:189], v21 offset:24576
  ds_read_b64_tr_b16 v[190:191], v21 offset:28672
  s_waitcnt vmcnt(23)
  s_setprio 3
  s_barrier
  s_waitcnt lgkmcnt(8)
  v_mfma_f32_16x16x32_bf16 v[192:195], v[160:163], v[136:139], v[192:195]
  s_lshr_b32 s49, s36, 1
  s_lshl_b32 s49, s49, 10
  s_and_b32 s50, s36, 1
  s_lshl_b32 s50, s50, 3
  s_add_u32 s49, s49, s50
  s_add_u32 s49, s49, 0
  s_waitcnt vmcnt(20)
  v_add_u32 v0, s49, v2
  s_and_b32 s49, s49, 4294965247
  v_add_u32 v11, s49, v2
  v_mfma_f32_16x16x32_bf16 v[224:227], v[160:163], v[140:143], v[224:227]
  ds_read_b64_tr_b16 v[160:161], v14 offset:32768
  ds_read_b64_tr_b16 v[162:163], v14 offset:36864
  s_add_u32 m0, s86, 16384
  s_add_u32 s85, s85, 65536
  buffer_load_dwordx4 v3, s[80:83], s85 offen lds
  v_mfma_f32_16x16x32_bf16 v[196:199], v[164:167], v[136:139], v[196:199]
  v_mfma_f32_16x16x32_bf16 v[228:231], v[164:167], v[140:143], v[228:231]
  v_add_f32 v28, v28, v28 row_ror:4
  v_add_f32 v29, v29, v29 row_ror:4
  s_setprio 2
  ds_read_b64_tr_b16 v[164:165], v15 offset:32768
  ds_read_b64_tr_b16 v[166:167], v15 offset:36864
  v_mfma_f32_16x16x32_bf16 v[200:203], v[168:171], v[136:139], v[200:203]
  v_add_f32 v30, v30, v30 row_ror:4
  v_add_f32 v31, v31, v31 row_ror:4
  v_mfma_f32_16x16x32_bf16 v[232:235], v[168:171], v[140:143], v[232:235]
  v_add_f32 v28, v28, v28 row_ror:2
  v_add_f32 v29, v29, v29 row_ror:2
  ds_read_b64_tr_b16 v[168:169], v16 offset:32768
  ds_read_b64_tr_b16 v[170:171], v16 offset:36864
  s_add_u32 m0, s86, 17408
  s_nop 0
  buffer_load_dwordx4 v4, s[80:83], s85 offen lds
  v_mfma_f32_16x16x32_bf16 v[204:207], v[172:175], v[136:139], v[204:207]
  v_add_f32 v30, v30, v30 row_ror:2
  v_add_f32 v31, v31, v31 row_ror:2
  v_mfma_f32_16x16x32_bf16 v[236:239], v[172:175], v[140:143], v[236:239]
  v_add_f32 v28, v28, v28 row_ror:1
  v_add_f32 v29, v29, v29 row_ror:1
  s_setprio 1
  ds_read_b64_tr_b16 v[172:173], v17 offset:32768
  ds_read_b64_tr_b16 v[174:175], v17 offset:36864
  s_waitcnt lgkmcnt(8)
  v_mfma_f32_16x16x32_bf16 v[208:211], v[176:179], v[136:139], v[208:211]
  v_add_f32 v30, v30, v30 row_ror:1
  v_add_f32 v31, v31, v31 row_ror:1
  v_mfma_f32_16x16x32_bf16 v[240:243], v[176:179], v[140:143], v[240:243]
  v_cvt_pk_bf16_f32 v28, v28, v29
  v_cvt_pk_bf16_f32 v29, v30, v31
  ds_read_b64_tr_b16 v[176:177], v18 offset:32768
  ds_read_b64_tr_b16 v[178:179], v18 offset:36864
  buffer_load_dwordx4 v[128:131], v26, s[76:79], s84 offen offset:0 sc1
  v_mfma_f32_16x16x32_bf16 v[212:215], v[180:183], v[136:139], v[212:215]
  ds_write_b64 v11, v[28:29] offset:4096
  s_waitcnt vmcnt(20)
  v_add_f32 v68, v68, v72
  v_mfma_f32_16x16x32_bf16 v[244:247], v[180:183], v[140:143], v[244:247]
  v_add_f32 v69, v69, v73
  v_add_f32 v70, v70, v74
  s_setprio 0
  ds_read_b64_tr_b16 v[180:181], v19 offset:32768
  ds_read_b64_tr_b16 v[182:183], v19 offset:36864
  v_mfma_f32_16x16x32_bf16 v[216:219], v[184:187], v[136:139], v[216:219]
  v_add_f32 v71, v71, v75
  s_waitcnt vmcnt(18)
  v_mfma_f32_16x16x32_bf16 v[248:251], v[184:187], v[140:143], v[248:251]
  v_add_f32 v68, v68, v76
  v_add_f32 v69, v69, v77
  ds_read_b64_tr_b16 v[184:185], v20 offset:32768
  ds_read_b64_tr_b16 v[186:187], v20 offset:36864
  buffer_load_dwordx4 v[132:135], v27, s[76:79], s84 offen offset:0 sc1
  v_mfma_f32_16x16x32_bf16 v[220:223], v[188:191], v[136:139], v[220:223]
  v_add_f32 v70, v70, v78
  v_add_f32 v71, v71, v79
  v_mfma_f32_16x16x32_bf16 v[252:255], v[188:191], v[140:143], v[252:255]
  s_waitcnt vmcnt(17)
  v_add_f32 v68, v68, v80
  v_add_f32 v69, v69, v81
  ds_read_b64_tr_b16 v[188:189], v21 offset:32768
  ds_read_b64_tr_b16 v[190:191], v21 offset:36864
  s_setprio 3
  s_barrier
  s_waitcnt lgkmcnt(9)
  v_mfma_f32_16x16x32_bf16 v[192:195], v[160:163], v[144:147], v[192:195]
  v_add_f32 v70, v70, v82
  v_add_f32 v71, v71, v83
  v_mfma_f32_16x16x32_bf16 v[224:227], v[160:163], v[148:151], v[224:227]
  s_waitcnt vmcnt(16)
  v_add_f32 v68, v68, v84
  ds_read_b64_tr_b16 v[160:161], v14 offset:40960
  ds_read_b64_tr_b16 v[162:163], v14 offset:45056
  s_add_u32 m0, s86, 24576
  s_add_u32 s85, s85, 65536
  buffer_load_dwordx4 v3, s[80:83], s85 offen lds
  v_mfma_f32_16x16x32_bf16 v[196:199], v[164:167], v[144:147], v[196:199]
  v_add_f32 v69, v69, v85
  v_add_f32 v70, v70, v86
  v_mfma_f32_16x16x32_bf16 v[228:231], v[164:167], v[148:151], v[228:231]
  v_add_f32 v71, v71, v87
  s_waitcnt vmcnt(15)
  v_add_f32 v68, v68, v88
  s_setprio 2
  ds_read_b64_tr_b16 v[164:165], v15 offset:40960
  ds_read_b64_tr_b16 v[166:167], v15 offset:45056
  v_mfma_f32_16x16x32_bf16 v[200:203], v[168:171], v[144:147], v[200:203]
  v_add_f32 v69, v69, v89
  v_add_f32 v70, v70, v90
  v_mfma_f32_16x16x32_bf16 v[232:235], v[168:171], v[148:151], v[232:235]
  v_add_f32 v71, v71, v91
  s_waitcnt vmcnt(13)
  ds_read_b64_tr_b16 v[168:169], v16 offset:40960
  ds_read_b64_tr_b16 v[170:171], v16 offset:45056
  s_add_u32 m0, s86, 25600
  s_nop 0
  buffer_load_dwordx4 v4, s[80:83], s85 offen lds
  v_mfma_f32_16x16x32_bf16 v[204:207], v[172:175], v[144:147], v[204:207]
  v_add_f32 v68, v68, v92
  v_add_f32 v69, v69, v93
  v_mfma_f32_16x16x32_bf16 v[236:239], v[172:175], v[148:151], v[236:239]
  v_add_f32 v70, v70, v94
  v_add_f32 v71, v71, v95
  s_setprio 1
  ds_read_b64_tr_b16 v[172:173], v17 offset:40960
  ds_read_b64_tr_b16 v[174:175], v17 offset:45056
  s_waitcnt lgkmcnt(8)
  v_mfma_f32_16x16x32_bf16 v[208:211], v[176:179], v[144:147], v[208:211]
  s_waitcnt vmcnt(13)
  v_add_f32 v68, v68, v96
  v_add_f32 v69, v69, v97
  v_mfma_f32_16x16x32_bf16 v[240:243], v[176:179], v[148:151], v[240:243]
  v_add_f32 v70, v70, v98
  v_add_f32 v71, v71, v99
  ds_read_b64_tr_b16 v[176:177], v18 offset:40960
  ds_read_b64_tr_b16 v[178:179], v18 offset:45056
  buffer_load_dwordx4 v[136:139], v26, s[76:79], s84 offen offset:2048 sc1
  v_mfma_f32_16x16x32_bf16 v[212:215], v[180:183], v[144:147], v[212:215]
  v_cvt_pk_bf16_f32 v68, v68, v69
  v_cvt_pk_bf16_f32 v69, v70, v71
  v_mfma_f32_16x16x32_bf16 v[244:247], v[180:183], v[148:151], v[244:247]
  ds_write_b64 v0, v[68:69]
  s_setprio 0
  ds_read_b64_tr_b16 v[180:181], v19 offset:40960
  ds_read_b64_tr_b16 v[182:183], v19 offset:45056
  v_mfma_f32_16x16x32_bf16 v[216:219], v[184:187], v[144:147], v[216:219]
  v_mfma_f32_16x16x32_bf16 v[248:251], v[184:187], v[148:151], v[248:251]
  ds_read_b64_tr_b16 v[184:185], v20 offset:40960
  ds_read_b64_tr_b16 v[186:187], v20 offset:45056
  buffer_load_dwordx4 v[140:143], v27, s[76:79], s84 offen offset:2048 sc1
  s_add_u32 s84, s84, 4096
  v_mfma_f32_16x16x32_bf16 v[220:223], v[188:191], v[144:147], v[220:223]
  v_mfma_f32_16x16x32_bf16 v[252:255], v[188:191], v[148:151], v[252:255]
  ds_read_b64_tr_b16 v[188:189], v21 offset:40960
  ds_read_b64_tr_b16 v[190:191], v21 offset:45056
  s_waitcnt lgkmcnt(6)
  s_waitcnt vmcnt(14)
  s_setprio 3
  s_barrier
  v_mfma_f32_16x16x32_bf16 v[192:195], v[160:163], v[152:155], v[192:195]
  v_add_u32 v108, 0, v2
  ds_read_b128 v[68:71], v108 offset:0
  v_mfma_f32_16x16x32_bf16 v[224:227], v[160:163], v[156:159], v[224:227]
  ds_read_b128 v[72:75], v108 offset:1024
  ds_read_b128 v[76:79], v108 offset:2048
  ds_read_b64_tr_b16 v[160:161], v14 offset:0
  ds_read_b64_tr_b16 v[162:163], v14 offset:4096
  s_add_u32 m0, s86, 32768
  s_add_u32 s85, s85, 65536
  buffer_load_dwordx4 v3, s[80:83], s85 offen lds
  v_mfma_f32_16x16x32_bf16 v[196:199], v[164:167], v[152:155], v[196:199]
  ds_read_b128 v[80:83], v108 offset:3072
  ds_read_b128 v[84:87], v108 offset:4096
  v_mfma_f32_16x16x32_bf16 v[228:231], v[164:167], v[156:159], v[228:231]
  ds_read_b128 v[88:91], v108 offset:5120
  s_setprio 2
  ds_read_b64_tr_b16 v[164:165], v15 offset:0
  ds_read_b64_tr_b16 v[166:167], v15 offset:4096
  v_mfma_f32_16x16x32_bf16 v[200:203], v[168:171], v[152:155], v[200:203]
  v_mfma_f32_16x16x32_bf16 v[232:235], v[168:171], v[156:159], v[232:235]
  s_waitcnt lgkmcnt(2)
  v_mfma_f32_16x16x32_bf16 v[28:31], v[68:71], v[52:55], 0
  ds_read_b64_tr_b16 v[168:169], v16 offset:0
  ds_read_b64_tr_b16 v[170:171], v16 offset:4096
  s_add_u32 m0, s86, 33792
  s_nop 0
  buffer_load_dwordx4 v4, s[80:83], s85 offen lds
  v_mfma_f32_16x16x32_bf16 v[204:207], v[172:175], v[152:155], v[204:207]
  v_mfma_f32_16x16x32_bf16 v[236:239], v[172:175], v[156:159], v[236:239]
  v_mfma_f32_16x16x32_bf16 v[32:35], v[76:79], v[52:55], 0
  s_setprio 1
  ds_read_b64_tr_b16 v[172:173], v17 offset:0
  ds_read_b64_tr_b16 v[174:175], v17 offset:4096
  v_mfma_f32_16x16x32_bf16 v[208:211], v[176:179], v[152:155], v[208:211]
  v_mfma_f32_16x16x32_bf16 v[36:39], v[84:87], v[52:55], 0
  v_mfma_f32_16x16x32_bf16 v[240:243], v[176:179], v[156:159], v[240:243]
  v_mfma_f32_16x16x32_bf16 v[92:95], v[68:71], v[60:63], 0
  ds_read_b64_tr_b16 v[176:177], v18 offset:0
  ds_read_b64_tr_b16 v[178:179], v18 offset:4096
  buffer_load_dwordx4 v[144:147], v26, s[76:79], s84 offen offset:0 sc1
  v_mfma_f32_16x16x32_bf16 v[212:215], v[180:183], v[152:155], v[212:215]
  v_mfma_f32_16x16x32_bf16 v[96:99], v[76:79], v[60:63], 0
  v_mfma_f32_16x16x32_bf16 v[244:247], v[180:183], v[156:159], v[244:247]
  v_mfma_f32_16x16x32_bf16 v[100:103], v[84:87], v[60:63], 0
  s_setprio 0
  ds_read_b64_tr_b16 v[180:181], v19 offset:0
  ds_read_b64_tr_b16 v[182:183], v19 offset:4096
  v_mfma_f32_16x16x32_bf16 v[216:219], v[184:187], v[152:155], v[216:219]
  v_mfma_f32_16x16x32_bf16 v[28:31], v[72:75], v[56:59], v[28:31]
  v_mfma_f32_16x16x32_bf16 v[248:251], v[184:187], v[156:159], v[248:251]
  v_mfma_f32_16x16x32_bf16 v[32:35], v[80:83], v[56:59], v[32:35]
  ds_read_b64_tr_b16 v[184:185], v20 offset:0
  ds_read_b64_tr_b16 v[186:187], v20 offset:4096
  buffer_load_dwordx4 v[148:151], v27, s[76:79], s84 offen offset:0 sc1
  v_mfma_f32_16x16x32_bf16 v[220:223], v[188:191], v[152:155], v[220:223]
  v_mfma_f32_16x16x32_bf16 v[36:39], v[88:91], v[56:59], v[36:39]
  v_mfma_f32_16x16x32_bf16 v[252:255], v[188:191], v[156:159], v[252:255]
  v_mfma_f32_16x16x32_bf16 v[92:95], v[72:75], v[64:67], v[92:95]
  ds_read_b64_tr_b16 v[188:189], v21 offset:0
  ds_read_b64_tr_b16 v[190:191], v21 offset:4096
  s_waitcnt vmcnt(14)
  s_setprio 3
  s_barrier
  s_waitcnt lgkmcnt(8)
  v_mfma_f32_16x16x32_bf16 v[192:195], v[160:163], v[112:115], v[192:195]
  v_mfma_f32_16x16x32_bf16 v[96:99], v[80:83], v[64:67], v[96:99]
  v_mfma_f32_16x16x32_bf16 v[224:227], v[160:163], v[116:119], v[224:227]
  v_mfma_f32_16x16x32_bf16 v[100:103], v[88:91], v[64:67], v[100:103]
  ds_read_b64_tr_b16 v[160:161], v14 offset:8192
  ds_read_b64_tr_b16 v[162:163], v14 offset:12288
  s_add_u32 m0, s86, 40960
  s_add_u32 s85, s85, 65536
  buffer_load_dwordx4 v3, s[80:83], s85 offen lds
  v_mfma_f32_16x16x32_bf16 v[196:199], v[164:167], v[112:115], v[196:199]
  s_lshl_b32 s50, s37, 11
  s_add_u32 s50, s50, s59
  v_mfma_f32_16x16x32_bf16 v[228:231], v[164:167], v[116:119], v[228:231]
  s_setprio 2
  ds_read_b64_tr_b16 v[164:165], v15 offset:8192
  ds_read_b64_tr_b16 v[166:167], v15 offset:12288
  v_mfma_f32_16x16x32_bf16 v[200:203], v[168:171], v[112:115], v[200:203]
  v_mfma_f32_16x16x32_bf16 v[232:235], v[168:171], v[116:119], v[232:235]
  v_cvt_pk_bf16_f32 v36, 0, v36
  v_add_f32 v36, 0x358637bd, v36
  ds_read_b64_tr_b16 v[168:169], v16 offset:8192
  ds_read_b64_tr_b16 v[170:171], v16 offset:12288
  s_add_u32 m0, s86, 41984
  s_nop 0
  buffer_load_dwordx4 v4, s[80:83], s85 offen lds
  v_mfma_f32_16x16x32_bf16 v[204:207], v[172:175], v[112:115], v[204:207]
  v_cvt_pk_bf16_f32 v36, 0, v36
  v_rcp_f32 v36, v36
  v_mfma_f32_16x16x32_bf16 v[236:239], v[172:175], v[116:119], v[236:239]
  v_cvt_pk_bf16_f32 v28, 0, v28
  s_setprio 1
  ds_read_b64_tr_b16 v[172:173], v17 offset:8192
  ds_read_b64_tr_b16 v[174:175], v17 offset:12288
  s_waitcnt lgkmcnt(8)
  v_mfma_f32_16x16x32_bf16 v[208:211], v[176:179], v[112:115], v[208:211]
  v_cvt_pk_bf16_f32 v29, 0, v29
  v_cvt_pk_bf16_f32 v30, 0, v30
  v_mfma_f32_16x16x32_bf16 v[240:243], v[176:179], v[116:119], v[240:243]
  v_cvt_pk_bf16_f32 v31, 0, v31
  v_cvt_pk_bf16_f32 v32, 0, v32
  ds_read_b64_tr_b16 v[176:177], v18 offset:8192
  ds_read_b64_tr_b16 v[178:179], v18 offset:12288
  buffer_load_dwordx4 v[152:155], v26, s[76:79], s84 offen offset:2048 sc1
  v_mfma_f32_16x16x32_bf16 v[212:215], v[180:183], v[112:115], v[212:215]
  v_cvt_pk_bf16_f32 v33, 0, v33
  v_cvt_pk_bf16_f32 v34, 0, v34
  v_mfma_f32_16x16x32_bf16 v[244:247], v[180:183], v[116:119], v[244:247]
  v_cvt_pk_bf16_f32 v35, 0, v35
  v_mul_f32 v28, v36, v28
  s_setprio 0
  ds_read_b64_tr_b16 v[180:181], v19 offset:8192
  ds_read_b64_tr_b16 v[182:183], v19 offset:12288
  v_mfma_f32_16x16x32_bf16 v[216:219], v[184:187], v[112:115], v[216:219]
  v_mul_f32 v29, v36, v29
  v_mul_f32 v30, v36, v30
  v_mfma_f32_16x16x32_bf16 v[248:251], v[184:187], v[116:119], v[248:251]
  v_mul_f32 v31, v36, v31
  v_mul_f32 v32, v36, v32
  ds_read_b64_tr_b16 v[184:185], v20 offset:8192
  ds_read_b64_tr_b16 v[186:187], v20 offset:12288
  buffer_load_dwordx4 v[156:159], v27, s[76:79], s84 offen offset:2048 sc1
  s_add_u32 s84, s84, 4096
  v_mfma_f32_16x16x32_bf16 v[220:223], v[188:191], v[112:115], v[220:223]
  v_mul_f32 v33, v36, v33
  v_mul_f32 v34, v36, v34
  v_mfma_f32_16x16x32_bf16 v[252:255], v[188:191], v[116:119], v[252:255]
  v_mul_f32 v35, v36, v35
  v_cvt_pk_bf16_f32 v40, v28, v29
  ds_read_b64_tr_b16 v[188:189], v21 offset:8192
  ds_read_b64_tr_b16 v[190:191], v21 offset:12288
  s_waitcnt vmcnt(14)
  s_setprio 3
  s_barrier
  s_waitcnt lgkmcnt(8)
  v_mfma_f32_16x16x32_bf16 v[192:195], v[160:163], v[120:123], v[192:195]
  v_cvt_pk_bf16_f32 v41, v30, v31
  v_cvt_pk_bf16_f32 v42, v32, v33
  v_mfma_f32_16x16x32_bf16 v[224:227], v[160:163], v[124:127], v[224:227]
  v_cvt_pk_bf16_f32 v43, v34, v35
  buffer_store_dwordx4 v[40:43], v2, s[28:31], s50 offen offset:0 sc1
  ds_read_b64_tr_b16 v[160:161], v14 offset:16384
  ds_read_b64_tr_b16 v[162:163], v14 offset:20480
  s_add_u32 m0, s86, 0
  s_add_u32 s85, s85, 65536
  buffer_load_dwordx4 v3, s[80:83], s85 offen lds
  v_mfma_f32_16x16x32_bf16 v[196:199], v[164:167], v[120:123], v[196:199]
  v_cvt_pk_bf16_f32 v100, 0, v100
  v_mfma_f32_16x16x32_bf16 v[228:231], v[164:167], v[124:127], v[228:231]
  v_add_f32 v100, 0x358637bd, v100
  v_cvt_pk_bf16_f32 v100, 0, v100
  s_setprio 2
  ds_read_b64_tr_b16 v[164:165], v15 offset:16384
  ds_read_b64_tr_b16 v[166:167], v15 offset:20480
  v_mfma_f32_16x16x32_bf16 v[200:203], v[168:171], v[120:123], v[200:203]
  v_rcp_f32 v100, v100
  v_mfma_f32_16x16x32_bf16 v[232:235], v[168:171], v[124:127], v[232:235]
  v_cvt_pk_bf16_f32 v92, 0, v92
  v_cvt_pk_bf16_f32 v93, 0, v93
  ds_read_b64_tr_b16 v[168:169], v16 offset:16384
  ds_read_b64_tr_b16 v[170:171], v16 offset:20480
  s_add_u32 m0, s86, 1024
  s_nop 0
  buffer_load_dwordx4 v4, s[80:83], s85 offen lds
  v_mfma_f32_16x16x32_bf16 v[204:207], v[172:175], v[120:123], v[204:207]
  v_cvt_pk_bf16_f32 v94, 0, v94
  v_cvt_pk_bf16_f32 v95, 0, v95
  v_mfma_f32_16x16x32_bf16 v[236:239], v[172:175], v[124:127], v[236:239]
  v_cvt_pk_bf16_f32 v96, 0, v96
  v_cvt_pk_bf16_f32 v97, 0, v97
  s_setprio 1
  ds_read_b64_tr_b16 v[172:173], v17 offset:16384
  ds_read_b64_tr_b16 v[174:175], v17 offset:20480
  s_waitcnt lgkmcnt(8)
  v_mfma_f32_16x16x32_bf16 v[208:211], v[176:179], v[120:123], v[208:211]
  v_cvt_pk_bf16_f32 v98, 0, v98
  v_cvt_pk_bf16_f32 v99, 0, v99
  v_mfma_f32_16x16x32_bf16 v[240:243], v[176:179], v[124:127], v[240:243]
  v_mul_f32 v92, v100, v92
  v_mul_f32 v93, v100, v93
  ds_read_b64_tr_b16 v[176:177], v18 offset:16384
  ds_read_b64_tr_b16 v[178:179], v18 offset:20480
  buffer_load_dwordx4 v[112:115], v26, s[76:79], s84 offen offset:0 sc1
  v_mfma_f32_16x16x32_bf16 v[212:215], v[180:183], v[120:123], v[212:215]
  v_mul_f32 v94, v100, v94
  v_mul_f32 v95, v100, v95
  v_mfma_f32_16x16x32_bf16 v[244:247], v[180:183], v[124:127], v[244:247]
  v_mul_f32 v96, v100, v96
  v_mul_f32 v97, v100, v97
  s_setprio 0
  ds_read_b64_tr_b16 v[180:181], v19 offset:16384
  ds_read_b64_tr_b16 v[182:183], v19 offset:20480
  v_mfma_f32_16x16x32_bf16 v[216:219], v[184:187], v[120:123], v[216:219]
  v_mul_f32 v98, v100, v98
  v_mul_f32 v99, v100, v99
  v_mfma_f32_16x16x32_bf16 v[248:251], v[184:187], v[124:127], v[248:251]
  v_cvt_pk_bf16_f32 v44, v92, v93
  v_cvt_pk_bf16_f32 v45, v94, v95
  ds_read_b64_tr_b16 v[184:185], v20 offset:16384
  ds_read_b64_tr_b16 v[186:187], v20 offset:20480
  buffer_load_dwordx4 v[116:119], v27, s[76:79], s84 offen offset:0 sc1
  v_mfma_f32_16x16x32_bf16 v[220:223], v[188:191], v[120:123], v[220:223]
  v_cvt_pk_bf16_f32 v46, v96, v97
  v_cvt_pk_bf16_f32 v47, v98, v99
  v_mfma_f32_16x16x32_bf16 v[252:255], v[188:191], v[124:127], v[252:255]
  buffer_store_dwordx4 v[44:47], v2, s[28:31], s50 offen offset:1024 sc1
  ds_read_b64_tr_b16 v[188:189], v21 offset:16384
  ds_read_b64_tr_b16 v[190:191], v21 offset:20480
  s_waitcnt vmcnt(16)
  s_setprio 3
  s_barrier
  s_waitcnt lgkmcnt(8)
  v_mfma_f32_16x16x32_bf16 v[192:195], v[160:163], v[128:131], v[192:195]
  v_mfma_f32_16x16x32_bf16 v[224:227], v[160:163], v[132:135], v[224:227]
  ds_read_b64_tr_b16 v[160:161], v14 offset:24576
  ds_read_b64_tr_b16 v[162:163], v14 offset:28672
  s_add_u32 m0, s86, 8192
  s_add_u32 s85, s85, 65536
  buffer_load_dwordx4 v3, s[80:83], s85 offen lds
  v_mfma_f32_16x16x32_bf16 v[196:199], v[164:167], v[128:131], v[196:199]
  v_mfma_f32_16x16x32_bf16 v[228:231], v[164:167], v[132:135], v[228:231]
  s_setprio 2
  ds_read_b64_tr_b16 v[164:165], v15 offset:24576
  ds_read_b64_tr_b16 v[166:167], v15 offset:28672
  v_mfma_f32_16x16x32_bf16 v[200:203], v[168:171], v[128:131], v[200:203]
  v_mfma_f32_16x16x32_bf16 v[232:235], v[168:171], v[132:135], v[232:235]
  ds_read_b64_tr_b16 v[168:169], v16 offset:24576
  ds_read_b64_tr_b16 v[170:171], v16 offset:28672
  s_add_u32 m0, s86, 9216
  s_nop 0
  buffer_load_dwordx4 v4, s[80:83], s85 offen lds
  v_mfma_f32_16x16x32_bf16 v[204:207], v[172:175], v[128:131], v[204:207]
  v_mfma_f32_16x16x32_bf16 v[236:239], v[172:175], v[132:135], v[236:239]
  s_setprio 1
  ds_read_b64_tr_b16 v[172:173], v17 offset:24576
  ds_read_b64_tr_b16 v[174:175], v17 offset:28672
  s_waitcnt lgkmcnt(8)
  v_mfma_f32_16x16x32_bf16 v[208:211], v[176:179], v[128:131], v[208:211]
  v_mfma_f32_16x16x32_bf16 v[240:243], v[176:179], v[132:135], v[240:243]
  ds_read_b64_tr_b16 v[176:177], v18 offset:24576
  ds_read_b64_tr_b16 v[178:179], v18 offset:28672
  buffer_load_dwordx4 v[120:123], v26, s[76:79], s84 offen offset:2048 sc1
  v_mfma_f32_16x16x32_bf16 v[212:215], v[180:183], v[128:131], v[212:215]
  v_mfma_f32_16x16x32_bf16 v[244:247], v[180:183], v[132:135], v[244:247]
  s_setprio 0
  ds_read_b64_tr_b16 v[180:181], v19 offset:24576
  ds_read_b64_tr_b16 v[182:183], v19 offset:28672
  v_mfma_f32_16x16x32_bf16 v[216:219], v[184:187], v[128:131], v[216:219]
  v_mfma_f32_16x16x32_bf16 v[248:251], v[184:187], v[132:135], v[248:251]
  ds_read_b64_tr_b16 v[184:185], v20 offset:24576
  ds_read_b64_tr_b16 v[186:187], v20 offset:28672
  buffer_load_dwordx4 v[124:127], v27, s[76:79], s84 offen offset:2048 sc1
  s_add_u32 s84, s84, 4096
  v_mfma_f32_16x16x32_bf16 v[220:223], v[188:191], v[128:131], v[220:223]
  v_mfma_f32_16x16x32_bf16 v[252:255], v[188:191], v[132:135], v[252:255]
  ds_read_b64_tr_b16 v[188:189], v21 offset:24576
  ds_read_b64_tr_b16 v[190:191], v21 offset:28672
  s_waitcnt vmcnt(16)
  s_setprio 3
  s_barrier
  s_waitcnt lgkmcnt(8)
  v_mfma_f32_16x16x32_bf16 v[192:195], v[160:163], v[136:139], v[192:195]
  v_mfma_f32_16x16x32_bf16 v[224:227], v[160:163], v[140:143], v[224:227]
  ds_read_b64_tr_b16 v[160:161], v14 offset:32768
  ds_read_b64_tr_b16 v[162:163], v14 offset:36864
  s_add_u32 m0, s86, 16384
  s_add_u32 s85, s85, 65536
  buffer_load_dwordx4 v3, s[80:83], s85 offen lds
  v_mfma_f32_16x16x32_bf16 v[196:199], v[164:167], v[136:139], v[196:199]
  v_mfma_f32_16x16x32_bf16 v[228:231], v[164:167], v[140:143], v[228:231]
  s_setprio 2
  ds_read_b64_tr_b16 v[164:165], v15 offset:32768
  ds_read_b64_tr_b16 v[166:167], v15 offset:36864
  v_mfma_f32_16x16x32_bf16 v[200:203], v[168:171], v[136:139], v[200:203]
  v_mfma_f32_16x16x32_bf16 v[232:235], v[168:171], v[140:143], v[232:235]
  ds_read_b64_tr_b16 v[168:169], v16 offset:32768
  ds_read_b64_tr_b16 v[170:171], v16 offset:36864
  s_add_u32 m0, s86, 17408
  s_nop 0
  buffer_load_dwordx4 v4, s[80:83], s85 offen lds
  v_mfma_f32_16x16x32_bf16 v[204:207], v[172:175], v[136:139], v[204:207]
  v_mfma_f32_16x16x32_bf16 v[236:239], v[172:175], v[140:143], v[236:239]
  s_setprio 1
  ds_read_b64_tr_b16 v[172:173], v17 offset:32768
  ds_read_b64_tr_b16 v[174:175], v17 offset:36864
  s_waitcnt lgkmcnt(8)
  v_mfma_f32_16x16x32_bf16 v[208:211], v[176:179], v[136:139], v[208:211]
  v_mfma_f32_16x16x32_bf16 v[240:243], v[176:179], v[140:143], v[240:243]
  ds_read_b64_tr_b16 v[176:177], v18 offset:32768
  ds_read_b64_tr_b16 v[178:179], v18 offset:36864
  buffer_load_dwordx4 v[128:131], v26, s[76:79], s84 offen offset:0 sc1
  v_mfma_f32_16x16x32_bf16 v[212:215], v[180:183], v[136:139], v[212:215]
  v_mfma_f32_16x16x32_bf16 v[244:247], v[180:183], v[140:143], v[244:247]
  s_setprio 0
  ds_read_b64_tr_b16 v[180:181], v19 offset:32768
  ds_read_b64_tr_b16 v[182:183], v19 offset:36864
  v_mfma_f32_16x16x32_bf16 v[216:219], v[184:187], v[136:139], v[216:219]
  v_mfma_f32_16x16x32_bf16 v[248:251], v[184:187], v[140:143], v[248:251]
  ds_read_b64_tr_b16 v[184:185], v20 offset:32768
  ds_read_b64_tr_b16 v[186:187], v20 offset:36864
  buffer_load_dwordx4 v[132:135], v27, s[76:79], s84 offen offset:0 sc1
  v_mfma_f32_16x16x32_bf16 v[220:223], v[188:191], v[136:139], v[220:223]
  v_mfma_f32_16x16x32_bf16 v[252:255], v[188:191], v[140:143], v[252:255]
  ds_read_b64_tr_b16 v[188:189], v21 offset:32768
  ds_read_b64_tr_b16 v[190:191], v21 offset:36864
  s_waitcnt vmcnt(16)
  s_setprio 3
  s_barrier
  s_waitcnt lgkmcnt(8)
  v_mfma_f32_16x16x32_bf16 v[192:195], v[160:163], v[144:147], v[192:195]
  s_waitcnt vmcnt(8)
  buffer_store_dword v5, v6, s[28:31], s94 offen sc1
  v_mfma_f32_16x16x32_bf16 v[224:227], v[160:163], v[148:151], v[224:227]
  ds_read_b64_tr_b16 v[160:161], v14 offset:40960
  ds_read_b64_tr_b16 v[162:163], v14 offset:45056
  s_add_u32 m0, s86, 24576
  s_add_u32 s85, s85, 65536
  buffer_load_dwordx4 v3, s[80:83], s85 offen lds
  v_mfma_f32_16x16x32_bf16 v[196:199], v[164:167], v[144:147], v[196:199]
  v_mfma_f32_16x16x32_bf16 v[228:231], v[164:167], v[148:151], v[228:231]
  s_setprio 2
  ds_read_b64_tr_b16 v[164:165], v15 offset:40960
  ds_read_b64_tr_b16 v[166:167], v15 offset:45056
  v_mfma_f32_16x16x32_bf16 v[200:203], v[168:171], v[144:147], v[200:203]
  v_mfma_f32_16x16x32_bf16 v[232:235], v[168:171], v[148:151], v[232:235]
  ds_read_b64_tr_b16 v[168:169], v16 offset:40960
  ds_read_b64_tr_b16 v[170:171], v16 offset:45056
  s_add_u32 m0, s86, 25600
  s_nop 0
  buffer_load_dwordx4 v4, s[80:83], s85 offen lds
  v_mfma_f32_16x16x32_bf16 v[204:207], v[172:175], v[144:147], v[204:207]
  v_mfma_f32_16x16x32_bf16 v[236:239], v[172:175], v[148:151], v[236:239]
  s_setprio 1
  ds_read_b64_tr_b16 v[172:173], v17 offset:40960
  ds_read_b64_tr_b16 v[174:175], v17 offset:45056
  s_waitcnt lgkmcnt(8)
  v_mfma_f32_16x16x32_bf16 v[208:211], v[176:179], v[144:147], v[208:211]
  v_mfma_f32_16x16x32_bf16 v[240:243], v[176:179], v[148:151], v[240:243]
  ds_read_b64_tr_b16 v[176:177], v18 offset:40960
  ds_read_b64_tr_b16 v[178:179], v18 offset:45056
  buffer_load_dwordx4 v[136:139], v26, s[76:79], s84 offen offset:2048 sc1
  v_mfma_f32_16x16x32_bf16 v[212:215], v[180:183], v[144:147], v[212:215]
  v_mfma_f32_16x16x32_bf16 v[244:247], v[180:183], v[148:151], v[244:247]
  s_setprio 0
  ds_read_b64_tr_b16 v[180:181], v19 offset:40960
  ds_read_b64_tr_b16 v[182:183], v19 offset:45056
  v_mfma_f32_16x16x32_bf16 v[216:219], v[184:187], v[144:147], v[216:219]
  v_mfma_f32_16x16x32_bf16 v[248:251], v[184:187], v[148:151], v[248:251]
  ds_read_b64_tr_b16 v[184:185], v20 offset:40960
  ds_read_b64_tr_b16 v[186:187], v20 offset:45056
  buffer_load_dwordx4 v[140:143], v27, s[76:79], s84 offen offset:2048 sc1
  s_add_u32 s84, s84, 4096
  v_mfma_f32_16x16x32_bf16 v[220:223], v[188:191], v[144:147], v[220:223]
  v_mfma_f32_16x16x32_bf16 v[252:255], v[188:191], v[148:151], v[252:255]
  ds_read_b64_tr_b16 v[188:189], v21 offset:40960
  ds_read_b64_tr_b16 v[190:191], v21 offset:45056
  s_setprio 3
  s_barrier
  s_waitcnt lgkmcnt(8)
  v_mfma_f32_16x16x32_bf16 v[192:195], v[160:163], v[152:155], v[192:195]
  v_mfma_f32_16x16x32_bf16 v[224:227], v[160:163], v[156:159], v[224:227]
  ds_read_b64_tr_b16 v[160:161], v14 offset:0
  ds_read_b64_tr_b16 v[162:163], v14 offset:4096
  s_add_u32 m0, s86, 32768
  s_add_u32 s85, s85, 65536
  buffer_load_dwordx4 v3, s[80:83], s85 offen lds
  v_mfma_f32_16x16x32_bf16 v[196:199], v[164:167], v[152:155], v[196:199]
  v_mfma_f32_16x16x32_bf16 v[228:231], v[164:167], v[156:159], v[228:231]
  s_setprio 2
  ds_read_b64_tr_b16 v[164:165], v15 offset:0
  ds_read_b64_tr_b16 v[166:167], v15 offset:4096
  v_mfma_f32_16x16x32_bf16 v[200:203], v[168:171], v[152:155], v[200:203]
  v_mfma_f32_16x16x32_bf16 v[232:235], v[168:171], v[156:159], v[232:235]
  ds_read_b64_tr_b16 v[168:169], v16 offset:0
  ds_read_b64_tr_b16 v[170:171], v16 offset:4096
  s_add_u32 m0, s86, 33792
  s_nop 0
  buffer_load_dwordx4 v4, s[80:83], s85 offen lds
  v_mfma_f32_16x16x32_bf16 v[204:207], v[172:175], v[152:155], v[204:207]
  v_mfma_f32_16x16x32_bf16 v[236:239], v[172:175], v[156:159], v[236:239]
  s_setprio 1
  ds_read_b64_tr_b16 v[172:173], v17 offset:0
  ds_read_b64_tr_b16 v[174:175], v17 offset:4096
  s_waitcnt lgkmcnt(8)
  v_mfma_f32_16x16x32_bf16 v[208:211], v[176:179], v[152:155], v[208:211]
  v_mfma_f32_16x16x32_bf16 v[240:243], v[176:179], v[156:159], v[240:243]
  ds_read_b64_tr_b16 v[176:177], v18 offset:0
  ds_read_b64_tr_b16 v[178:179], v18 offset:4096
  buffer_load_dwordx4 v[144:147], v26, s[76:79], s84 offen offset:0 sc1
  v_mfma_f32_16x16x32_bf16 v[212:215], v[180:183], v[152:155], v[212:215]
  v_mfma_f32_16x16x32_bf16 v[244:247], v[180:183], v[156:159], v[244:247]
  s_setprio 0
  ds_read_b64_tr_b16 v[180:181], v19 offset:0
  ds_read_b64_tr_b16 v[182:183], v19 offset:4096
  v_mfma_f32_16x16x32_bf16 v[216:219], v[184:187], v[152:155], v[216:219]
  v_mfma_f32_16x16x32_bf16 v[248:251], v[184:187], v[156:159], v[248:251]
  ds_read_b64_tr_b16 v[184:185], v20 offset:0
  ds_read_b64_tr_b16 v[186:187], v20 offset:4096
  buffer_load_dwordx4 v[148:151], v27, s[76:79], s84 offen offset:0 sc1
  v_mfma_f32_16x16x32_bf16 v[220:223], v[188:191], v[152:155], v[220:223]
  v_mfma_f32_16x16x32_bf16 v[252:255], v[188:191], v[156:159], v[252:255]
  ds_read_b64_tr_b16 v[188:189], v21 offset:0
  ds_read_b64_tr_b16 v[190:191], v21 offset:4096
  s_waitcnt vmcnt(15)
  s_setprio 3
  s_barrier
  s_waitcnt lgkmcnt(8)
  v_mfma_f32_16x16x32_bf16 v[192:195], v[160:163], v[112:115], v[192:195]
  v_mfma_f32_16x16x32_bf16 v[224:227], v[160:163], v[116:119], v[224:227]
  ds_read_b64_tr_b16 v[160:161], v14 offset:8192
  ds_read_b64_tr_b16 v[162:163], v14 offset:12288
  s_add_u32 m0, s86, 40960
  s_add_u32 s85, s85, 65536
  buffer_load_dwordx4 v3, s[80:83], s85 offen lds
  v_mfma_f32_16x16x32_bf16 v[196:199], v[164:167], v[112:115], v[196:199]
  v_mfma_f32_16x16x32_bf16 v[228:231], v[164:167], v[116:119], v[228:231]
  s_setprio 2
  ds_read_b64_tr_b16 v[164:165], v15 offset:8192
  ds_read_b64_tr_b16 v[166:167], v15 offset:12288
  v_mfma_f32_16x16x32_bf16 v[200:203], v[168:171], v[112:115], v[200:203]
  v_mfma_f32_16x16x32_bf16 v[232:235], v[168:171], v[116:119], v[232:235]
  ds_read_b64_tr_b16 v[168:169], v16 offset:8192
  ds_read_b64_tr_b16 v[170:171], v16 offset:12288
  s_add_u32 m0, s86, 41984
  s_nop 0
  buffer_load_dwordx4 v4, s[80:83], s85 offen lds
  v_mfma_f32_16x16x32_bf16 v[204:207], v[172:175], v[112:115], v[204:207]
  v_mfma_f32_16x16x32_bf16 v[236:239], v[172:175], v[116:119], v[236:239]
  s_setprio 1
  ds_read_b64_tr_b16 v[172:173], v17 offset:8192
  ds_read_b64_tr_b16 v[174:175], v17 offset:12288
  s_waitcnt lgkmcnt(8)
  v_mfma_f32_16x16x32_bf16 v[208:211], v[176:179], v[112:115], v[208:211]
  v_mfma_f32_16x16x32_bf16 v[240:243], v[176:179], v[116:119], v[240:243]
  ds_read_b64_tr_b16 v[176:177], v18 offset:8192
  ds_read_b64_tr_b16 v[178:179], v18 offset:12288
  buffer_load_dwordx4 v[152:155], v26, s[76:79], s84 offen offset:2048 sc1
  v_mfma_f32_16x16x32_bf16 v[212:215], v[180:183], v[112:115], v[212:215]
  v_mfma_f32_16x16x32_bf16 v[244:247], v[180:183], v[116:119], v[244:247]
  s_setprio 0
  ds_read_b64_tr_b16 v[180:181], v19 offset:8192
  ds_read_b64_tr_b16 v[182:183], v19 offset:12288
  v_mfma_f32_16x16x32_bf16 v[216:219], v[184:187], v[112:115], v[216:219]
  v_mfma_f32_16x16x32_bf16 v[248:251], v[184:187], v[116:119], v[248:251]
  ds_read_b64_tr_b16 v[184:185], v20 offset:8192
  ds_read_b64_tr_b16 v[186:187], v20 offset:12288
  buffer_load_dwordx4 v[156:159], v27, s[76:79], s84 offen offset:2048 sc1
  s_add_u32 s84, s84, 4096
  v_mfma_f32_16x16x32_bf16 v[220:223], v[188:191], v[112:115], v[220:223]
  v_mfma_f32_16x16x32_bf16 v[252:255], v[188:191], v[116:119], v[252:255]
  ds_read_b64_tr_b16 v[188:189], v21 offset:8192
  ds_read_b64_tr_b16 v[190:191], v21 offset:12288
  s_waitcnt vmcnt(15)
  s_setprio 3
  s_barrier
  s_waitcnt lgkmcnt(8)
  v_mfma_f32_16x16x32_bf16 v[192:195], v[160:163], v[120:123], v[192:195]
  v_mfma_f32_16x16x32_bf16 v[224:227], v[160:163], v[124:127], v[224:227]
  ds_read_b64_tr_b16 v[160:161], v14 offset:16384
  ds_read_b64_tr_b16 v[162:163], v14 offset:20480
  s_lshl_b32 s85, s75, 18
  s_add_u32 s85, s85, 6225920
  s_add_u32 m0, s86, 0
  s_add_u32 s85, s85, 65536
  buffer_load_dwordx4 v3, s[80:83], s85 offen lds
  v_mfma_f32_16x16x32_bf16 v[196:199], v[164:167], v[120:123], v[196:199]
  v_mfma_f32_16x16x32_bf16 v[228:231], v[164:167], v[124:127], v[228:231]
  s_setprio 2
  ds_read_b64_tr_b16 v[164:165], v15 offset:16384
  ds_read_b64_tr_b16 v[166:167], v15 offset:20480
  v_mfma_f32_16x16x32_bf16 v[200:203], v[168:171], v[120:123], v[200:203]
  v_mfma_f32_16x16x32_bf16 v[232:235], v[168:171], v[124:127], v[232:235]
  ds_read_b64_tr_b16 v[168:169], v16 offset:16384
  ds_read_b64_tr_b16 v[170:171], v16 offset:20480
  s_add_u32 m0, s86, 1024
  s_nop 0
  buffer_load_dwordx4 v4, s[80:83], s85 offen lds
  v_mfma_f32_16x16x32_bf16 v[204:207], v[172:175], v[120:123], v[204:207]
  v_mfma_f32_16x16x32_bf16 v[236:239], v[172:175], v[124:127], v[236:239]
  s_setprio 1
  ds_read_b64_tr_b16 v[172:173], v17 offset:16384
  ds_read_b64_tr_b16 v[174:175], v17 offset:20480
  s_waitcnt lgkmcnt(8)
  v_mfma_f32_16x16x32_bf16 v[208:211], v[176:179], v[120:123], v[208:211]
  buffer_load_dword v8, v12, s[28:31], s95 offen sc1
  v_mfma_f32_16x16x32_bf16 v[240:243], v[176:179], v[124:127], v[240:243]
  ds_read_b64_tr_b16 v[176:177], v18 offset:16384
  ds_read_b64_tr_b16 v[178:179], v18 offset:20480
  s_lshl_b32 s84, s75, 13
  s_add_u32 s84, s84, 262144
  buffer_load_dwordx4 v[112:115], v26, s[76:79], s84 offen offset:0 sc1
  v_mfma_f32_16x16x32_bf16 v[212:215], v[180:183], v[120:123], v[212:215]
  v_mfma_f32_16x16x32_bf16 v[244:247], v[180:183], v[124:127], v[244:247]
  s_setprio 0
  ds_read_b64_tr_b16 v[180:181], v19 offset:16384
  ds_read_b64_tr_b16 v[182:183], v19 offset:20480
  v_mfma_f32_16x16x32_bf16 v[216:219], v[184:187], v[120:123], v[216:219]
  v_mfma_f32_16x16x32_bf16 v[248:251], v[184:187], v[124:127], v[248:251]
  ds_read_b64_tr_b16 v[184:185], v20 offset:16384
  ds_read_b64_tr_b16 v[186:187], v20 offset:20480
  buffer_load_dwordx4 v[116:119], v27, s[76:79], s84 offen offset:0 sc1
  v_mfma_f32_16x16x32_bf16 v[220:223], v[188:191], v[120:123], v[220:223]
  v_mfma_f32_16x16x32_bf16 v[252:255], v[188:191], v[124:127], v[252:255]
  ds_read_b64_tr_b16 v[188:189], v21 offset:16384
  ds_read_b64_tr_b16 v[190:191], v21 offset:20480
  s_waitcnt vmcnt(15)
  s_setprio 3
  s_barrier
  s_waitcnt lgkmcnt(8)
  v_mfma_f32_16x16x32_bf16 v[192:195], v[160:163], v[128:131], v[192:195]
  v_mfma_f32_16x16x32_bf16 v[224:227], v[160:163], v[132:135], v[224:227]
  ds_read_b64_tr_b16 v[160:161], v14 offset:24576
  ds_read_b64_tr_b16 v[162:163], v14 offset:28672
  s_add_u32 m0, s86, 8192
  s_add_u32 s85, s85, 65536
  buffer_load_dwordx4 v3, s[80:83], s85 offen lds
  v_mfma_f32_16x16x32_bf16 v[196:199], v[164:167], v[128:131], v[196:199]
  v_mfma_f32_16x16x32_bf16 v[228:231], v[164:167], v[132:135], v[228:231]
  s_setprio 2
  ds_read_b64_tr_b16 v[164:165], v15 offset:24576
  ds_read_b64_tr_b16 v[166:167], v15 offset:28672
  v_mfma_f32_16x16x32_bf16 v[200:203], v[168:171], v[128:131], v[200:203]
  v_mfma_f32_16x16x32_bf16 v[232:235], v[168:171], v[132:135], v[232:235]
  ds_read_b64_tr_b16 v[168:169], v16 offset:24576
  ds_read_b64_tr_b16 v[170:171], v16 offset:28672
  s_add_u32 m0, s86, 9216
  s_nop 0
  buffer_load_dwordx4 v4, s[80:83], s85 offen lds
  v_mfma_f32_16x16x32_bf16 v[204:207], v[172:175], v[128:131], v[204:207]
  v_mfma_f32_16x16x32_bf16 v[236:239], v[172:175], v[132:135], v[236:239]
  s_setprio 1
  ds_read_b64_tr_b16 v[172:173], v17 offset:24576
  ds_read_b64_tr_b16 v[174:175], v17 offset:28672
  s_waitcnt lgkmcnt(8)
  v_mfma_f32_16x16x32_bf16 v[208:211], v[176:179], v[128:131], v[208:211]
  v_mfma_f32_16x16x32_bf16 v[240:243], v[176:179], v[132:135], v[240:243]
  ds_read_b64_tr_b16 v[176:177], v18 offset:24576
  ds_read_b64_tr_b16 v[178:179], v18 offset:28672
  buffer_load_dwordx4 v[120:123], v26, s[76:79], s84 offen offset:2048 sc1
  v_mfma_f32_16x16x32_bf16 v[212:215], v[180:183], v[128:131], v[212:215]
  v_mfma_f32_16x16x32_bf16 v[244:247], v[180:183], v[132:135], v[244:247]
  s_setprio 0
  ds_read_b64_tr_b16 v[180:181], v19 offset:24576
  ds_read_b64_tr_b16 v[182:183], v19 offset:28672
  v_mfma_f32_16x16x32_bf16 v[216:219], v[184:187], v[128:131], v[216:219]
  v_mfma_f32_16x16x32_bf16 v[248:251], v[184:187], v[132:135], v[248:251]
  ds_read_b64_tr_b16 v[184:185], v20 offset:24576
  ds_read_b64_tr_b16 v[186:187], v20 offset:28672
  buffer_load_dwordx4 v[124:127], v27, s[76:79], s84 offen offset:2048 sc1
  s_add_u32 s84, s84, 4096
  v_mfma_f32_16x16x32_bf16 v[220:223], v[188:191], v[128:131], v[220:223]
  v_mfma_f32_16x16x32_bf16 v[252:255], v[188:191], v[132:135], v[252:255]
  ds_read_b64_tr_b16 v[188:189], v21 offset:24576
  ds_read_b64_tr_b16 v[190:191], v21 offset:28672
  s_waitcnt vmcnt(15)
  s_setprio 3
  s_barrier
  s_waitcnt lgkmcnt(8)
  v_mfma_f32_16x16x32_bf16 v[192:195], v[160:163], v[136:139], v[192:195]
  s_mov_b32 s32, s62
  s_mov_b32 s33, s63
  v_mfma_f32_16x16x32_bf16 v[224:227], v[160:163], v[140:143], v[224:227]
  s_mov_b32 s34, 4194304
  ds_read_b64_tr_b16 v[160:161], v14 offset:32768
  ds_read_b64_tr_b16 v[162:163], v14 offset:36864
  s_add_u32 m0, s86, 16384
  s_add_u32 s85, s85, 65536
  buffer_load_dwordx4 v3, s[80:83], s85 offen lds
  v_mfma_f32_16x16x32_bf16 v[196:199], v[164:167], v[136:139], v[196:199]
  s_mov_b32 s35, 0x20000
  v_mfma_f32_16x16x32_bf16 v[228:231], v[164:167], v[140:143], v[228:231]
  s_mov_b32 s52, s64
  s_mov_b32 s53, s65
  s_setprio 2
  ds_read_b64_tr_b16 v[164:165], v15 offset:32768
  ds_read_b64_tr_b16 v[166:167], v15 offset:36864
  v_mfma_f32_16x16x32_bf16 v[200:203], v[168:171], v[136:139], v[200:203]
  s_mov_b32 s54, 2048
  v_mfma_f32_16x16x32_bf16 v[232:235], v[168:171], v[140:143], v[232:235]
  s_mov_b32 s55, 0x20000
  ds_read_b64_tr_b16 v[168:169], v16 offset:32768
  ds_read_b64_tr_b16 v[170:171], v16 offset:36864
  s_add_u32 m0, s86, 17408
  s_nop 0
  buffer_load_dwordx4 v4, s[80:83], s85 offen lds
  v_mfma_f32_16x16x32_bf16 v[204:207], v[172:175], v[136:139], v[204:207]
  s_lshl_b32 s48, s88, 5
  v_mfma_f32_16x16x32_bf16 v[236:239], v[172:175], v[140:143], v[236:239]
  s_lshl_b32 s49, s70, 4
  s_add_u32 s48, s48, s49
  s_setprio 1
  ds_read_b64_tr_b16 v[172:173], v17 offset:32768
  ds_read_b64_tr_b16 v[174:175], v17 offset:36864
  s_waitcnt lgkmcnt(8)
  v_mfma_f32_16x16x32_bf16 v[208:211], v[176:179], v[136:139], v[208:211]
  v_lshrrev_b32 v88, 3, v1
  v_mfma_f32_16x16x32_bf16 v[240:243], v[176:179], v[140:143], v[240:243]
  ds_read_b64_tr_b16 v[176:177], v18 offset:32768
  ds_read_b64_tr_b16 v[178:179], v18 offset:36864
  buffer_load_dwordx4 v[128:131], v26, s[76:79], s84 offen offset:0 sc1
  v_mfma_f32_16x16x32_bf16 v[212:215], v[180:183], v[136:139], v[212:215]
  v_and_b32 v89, 7, v1
  v_mfma_f32_16x16x32_bf16 v[244:247], v[180:183], v[140:143], v[244:247]
  v_xor_b32 v89, v89, v88
  s_setprio 0
  ds_read_b64_tr_b16 v[180:181], v19 offset:32768
  ds_read_b64_tr_b16 v[182:183], v19 offset:36864
  v_mfma_f32_16x16x32_bf16 v[216:219], v[184:187], v[136:139], v[216:219]
  v_mfma_f32_16x16x32_bf16 v[248:251], v[184:187], v[140:143], v[248:251]
  v_add_u32 v88, s48, v88
  ds_read_b64_tr_b16 v[184:185], v20 offset:32768
  ds_read_b64_tr_b16 v[186:187], v20 offset:36864
  buffer_load_dwordx4 v[132:135], v27, s[76:79], s84 offen offset:0 sc1
  v_mfma_f32_16x16x32_bf16 v[220:223], v[188:191], v[136:139], v[220:223]
  v_lshlrev_b32 v88, 11, v88
  v_mfma_f32_16x16x32_bf16 v[252:255], v[188:191], v[140:143], v[252:255]
  ds_read_b64_tr_b16 v[188:189], v21 offset:32768
  ds_read_b64_tr_b16 v[190:191], v21 offset:36864
  s_waitcnt vmcnt(15)
  s_setprio 3
  s_barrier
  s_waitcnt lgkmcnt(8)
  v_mfma_f32_16x16x32_bf16 v[192:195], v[160:163], v[144:147], v[192:195]
  v_add_u32 v88, s89, v88
  v_mfma_f32_16x16x32_bf16 v[224:227], v[160:163], v[148:151], v[224:227]
  ds_read_b64_tr_b16 v[160:161], v14 offset:40960
  ds_read_b64_tr_b16 v[162:163], v14 offset:45056
  s_add_u32 m0, s86, 24576
  s_add_u32 s85, s85, 65536
  buffer_load_dwordx4 v3, s[80:83], s85 offen lds
  v_mfma_f32_16x16x32_bf16 v[196:199], v[164:167], v[144:147], v[196:199]
  v_lshl_add_u32 v10, v89, 4, v88
  v_mfma_f32_16x16x32_bf16 v[228:231], v[164:167], v[148:151], v[228:231]
  v_lshrrev_b32 v89, 4, v1
  s_setprio 2
  ds_read_b64_tr_b16 v[164:165], v15 offset:40960
  ds_read_b64_tr_b16 v[166:167], v15 offset:45056
  v_mfma_f32_16x16x32_bf16 v[200:203], v[168:171], v[144:147], v[200:203]
  v_mfma_f32_16x16x32_bf16 v[232:235], v[168:171], v[148:151], v[232:235]
  v_lshlrev_b32 v88, 3, v89
  ds_read_b64_tr_b16 v[168:169], v16 offset:40960
  ds_read_b64_tr_b16 v[170:171], v16 offset:45056
  s_add_u32 m0, s86, 25600
  s_nop 0
  buffer_load_dwordx4 v4, s[80:83], s85 offen lds
  v_mfma_f32_16x16x32_bf16 v[204:207], v[172:175], v[144:147], v[204:207]
  buffer_load_dwordx2 v[76:77], v88, s[52:55], s89 offen offset:0
  v_mfma_f32_16x16x32_bf16 v[236:239], v[172:175], v[148:151], v[236:239]
  s_setprio 1
  ds_read_b64_tr_b16 v[172:173], v17 offset:40960
  ds_read_b64_tr_b16 v[174:175], v17 offset:45056
  s_waitcnt lgkmcnt(8)
  v_mfma_f32_16x16x32_bf16 v[208:211], v[176:179], v[144:147], v[208:211]
  buffer_load_dwordx2 v[78:79], v88, s[52:55], s89 offen offset:32
  v_mfma_f32_16x16x32_bf16 v[240:243], v[176:179], v[148:151], v[240:243]
  ds_read_b64_tr_b16 v[176:177], v18 offset:40960
  ds_read_b64_tr_b16 v[178:179], v18 offset:45056
  buffer_load_dwordx4 v[136:139], v26, s[76:79], s84 offen offset:2048 sc1
  v_mfma_f32_16x16x32_bf16 v[212:215], v[180:183], v[144:147], v[212:215]
  buffer_load_dwordx2 v[80:81], v88, s[52:55], s89 offen offset:64
  v_mfma_f32_16x16x32_bf16 v[244:247], v[180:183], v[148:151], v[244:247]
  buffer_load_dwordx2 v[82:83], v88, s[52:55], s89 offen offset:96
  s_setprio 0
  ds_read_b64_tr_b16 v[180:181], v19 offset:40960
  ds_read_b64_tr_b16 v[182:183], v19 offset:45056
  v_mfma_f32_16x16x32_bf16 v[216:219], v[184:187], v[144:147], v[216:219]
  v_mfma_f32_16x16x32_bf16 v[248:251], v[184:187], v[148:151], v[248:251]
  s_lshr_b32 s48, s71, 1
  s_lshl_b32 s48, s48, 13
  s_waitcnt vmcnt(17)
  v_cmp_ne_u32 vcc, 1, v8
  s_mov_b32 s3, 0
  s_nop 0
  s_cmp_eq_u64 vcc, 0
  s_cbranch_scc1 Lok5
Lsp6:
  s_sleep 1
  buffer_load_dword v8, v12, s[28:31], s95 offen sc1
  s_waitcnt vmcnt(0)
  v_cmp_ne_u32 vcc, 1, v8
  s_add_u32 s3, s3, 1
  s_nop 0
  s_cmp_eq_u64 vcc, 0
  s_cbranch_scc1 Lok5
  s_cmp_lt_u32 s3, 0x40000
  s_cbranch_scc1 Lsp6
Lok5:
  ds_read_b64_tr_b16 v[184:185], v20 offset:40960
  ds_read_b64_tr_b16 v[186:187], v20 offset:45056
  buffer_load_dwordx4 v[140:143], v27, s[76:79], s84 offen offset:2048 sc1
  s_add_u32 s84, s84, 4096
  v_mfma_f32_16x16x32_bf16 v[220:223], v[188:191], v[144:147], v[220:223]
  s_and_b32 s49, s71, 1
  v_mfma_f32_16x16x32_bf16 v[252:255], v[188:191], v[148:151], v[252:255]
  s_lshl_b32 s49, s49, 11
  ds_read_b64_tr_b16 v[188:189], v21 offset:40960
  ds_read_b64_tr_b16 v[190:191], v21 offset:45056
  s_setprio 3
  s_barrier
  s_waitcnt lgkmcnt(8)
  v_mfma_f32_16x16x32_bf16 v[192:195], v[160:163], v[152:155], v[192:195]
  s_add_u32 s48, s48, s49
  v_mfma_f32_16x16x32_bf16 v[224:227], v[160:163], v[156:159], v[224:227]
  s_add_u32 s48, s48, s87
  s_add_u32 s69, s48, 4096
  ds_read_b64_tr_b16 v[160:161], v14 offset:0
  ds_read_b64_tr_b16 v[162:163], v14 offset:4096
  s_mov_b32 s80, s60
  s_mov_b32 s81, s61
  s_mov_b32 s82, 2097152
  s_lshl_b32 s85, s70, 20
  s_sub_u32 s85, s85, 65536
  s_lshl_b32 s86, s71, 10
  s_add_u32 s86, s86, s87
  s_add_u32 m0, s86, 32768
  s_add_u32 s85, s85, 65536
  buffer_load_dwordx4 v9, s[80:83], s85 offen lds
  v_mfma_f32_16x16x32_bf16 v[196:199], v[164:167], v[152:155], v[196:199]
  s_mov_b32 s68, 16384
  v_mfma_f32_16x16x32_bf16 v[228:231], v[164:167], v[156:159], v[228:231]
  v_lshrrev_b32 v88, 1, v89
  s_setprio 2
  ds_read_b64_tr_b16 v[164:165], v15 offset:0
  ds_read_b64_tr_b16 v[166:167], v15 offset:4096
  v_mfma_f32_16x16x32_bf16 v[200:203], v[168:171], v[152:155], v[200:203]
  v_mfma_f32_16x16x32_bf16 v[232:235], v[168:171], v[156:159], v[232:235]
  v_and_b32 v90, 7, v1
  ds_read_b64_tr_b16 v[168:169], v16 offset:0
  ds_read_b64_tr_b16 v[170:171], v16 offset:4096
  s_lshl_b32 s84, s70, 15
  buffer_load_dwordx4 v[144:147], v26, s[76:79], s84 offen offset:0 sc1
  v_mfma_f32_16x16x32_bf16 v[204:207], v[172:175], v[152:155], v[204:207]
  v_xor_b32 v88, v88, v90
  v_mfma_f32_16x16x32_bf16 v[236:239], v[172:175], v[156:159], v[236:239]
  s_setprio 1
  ds_read_b64_tr_b16 v[172:173], v17 offset:0
  ds_read_b64_tr_b16 v[174:175], v17 offset:4096
  s_waitcnt lgkmcnt(8)
  v_mfma_f32_16x16x32_bf16 v[208:211], v[176:179], v[152:155], v[208:211]
  v_lshlrev_b32 v88, 4, v88
  v_mfma_f32_16x16x32_bf16 v[240:243], v[176:179], v[156:159], v[240:243]
  v_and_b32 v89, 1, v89
  ds_read_b64_tr_b16 v[176:177], v18 offset:0
  ds_read_b64_tr_b16 v[178:179], v18 offset:4096
  v_mfma_f32_16x16x32_bf16 v[212:215], v[180:183], v[152:155], v[212:215]
  v_mfma_f32_16x16x32_bf16 v[244:247], v[180:183], v[156:159], v[244:247]
  v_lshl_add_u32 v88, v89, 3, v88
  s_setprio 0
  ds_read_b64_tr_b16 v[180:181], v19 offset:0
  ds_read_b64_tr_b16 v[182:183], v19 offset:4096
  buffer_load_dwordx4 v[148:151], v27, s[76:79], s84 offen offset:0 sc1
  v_mfma_f32_16x16x32_bf16 v[216:219], v[184:187], v[152:155], v[216:219]
  v_and_b32 v89, 15, v1
  v_mfma_f32_16x16x32_bf16 v[248:251], v[184:187], v[156:159], v[248:251]
  ds_read_b64_tr_b16 v[184:185], v20 offset:0
  ds_read_b64_tr_b16 v[186:187], v20 offset:4096
  v_mfma_f32_16x16x32_bf16 v[220:223], v[188:191], v[152:155], v[220:223]
  v_lshl_add_u32 v88, v89, 7, v88
  v_mfma_f32_16x16x32_bf16 v[252:255], v[188:191], v[156:159], v[252:255]
  ds_read_b64_tr_b16 v[188:189], v21 offset:0
  ds_read_b64_tr_b16 v[190:191], v21 offset:4096
  s_waitcnt vmcnt(17)
  v_swap_b32 v114, v116
  v_swap_b32 v115, v117
  s_setprio 3
  s_barrier
  s_waitcnt lgkmcnt(8)
  v_mfma_f32_16x16x32_bf16 v[192:195], v[160:163], v[112:115], v[192:195]
  v_add_u32 v68, s69, v88
  v_mfma_f32_16x16x32_bf16 v[224:227], v[160:163], v[116:119], v[224:227]
  v_xor_b32 v69, 32, v68
  ds_read_b64_tr_b16 v[160:161], v14 offset:8192
  ds_read_b64_tr_b16 v[162:163], v14 offset:12288
  s_add_u32 m0, s86, 40960
  s_add_u32 s85, s85, 65536
  buffer_load_dwordx4 v9, s[80:83], s85 offen lds
  v_mfma_f32_16x16x32_bf16 v[196:199], v[164:167], v[112:115], v[196:199]
  v_mfma_f32_16x16x32_bf16 v[228:231], v[164:167], v[116:119], v[228:231]
  v_xor_b32 v70, 64, v68
  s_setprio 2
  ds_read_b64_tr_b16 v[164:165], v15 offset:8192
  ds_read_b64_tr_b16 v[166:167], v15 offset:12288
  v_mfma_f32_16x16x32_bf16 v[200:203], v[168:171], v[112:115], v[200:203]
  v_xor_b32 v71, 96, v68
  v_mfma_f32_16x16x32_bf16 v[232:235], v[168:171], v[116:119], v[232:235]
  ds_read_b64_tr_b16 v[168:169], v16 offset:8192
  ds_read_b64_tr_b16 v[170:171], v16 offset:12288
  buffer_load_dwordx4 v[152:155], v26, s[76:79], s84 offen offset:2048 sc1
  v_mfma_f32_16x16x32_bf16 v[204:207], v[172:175], v[112:115], v[204:207]
  v_add_u32 v72, s69, v2
  v_mfma_f32_16x16x32_bf16 v[236:239], v[172:175], v[116:119], v[236:239]
  s_setprio 1
  ds_read_b64_tr_b16 v[172:173], v17 offset:8192
  ds_read_b64_tr_b16 v[174:175], v17 offset:12288
  s_waitcnt lgkmcnt(8)
  v_mfma_f32_16x16x32_bf16 v[208:211], v[176:179], v[112:115], v[208:211]
  v_mfma_f32_16x16x32_bf16 v[240:243], v[176:179], v[116:119], v[240:243]
  ds_read_b64_tr_b16 v[176:177], v18 offset:8192
  ds_read_b64_tr_b16 v[178:179], v18 offset:12288
  v_mfma_f32_16x16x32_bf16 v[212:215], v[180:183], v[112:115], v[212:215]
  v_mfma_f32_16x16x32_bf16 v[244:247], v[180:183], v[116:119], v[244:247]
  s_setprio 0
  ds_read_b64_tr_b16 v[180:181], v19 offset:8192
  ds_read_b64_tr_b16 v[182:183], v19 offset:12288
  buffer_load_dwordx4 v[156:159], v27, s[76:79], s84 offen offset:2048 sc1
  s_add_u32 s84, s84, 4096
  v_mfma_f32_16x16x32_bf16 v[216:219], v[184:187], v[112:115], v[216:219]
  v_mfma_f32_16x16x32_bf16 v[248:251], v[184:187], v[116:119], v[248:251]
  ds_read_b64_tr_b16 v[184:185], v20 offset:8192
  ds_read_b64_tr_b16 v[186:187], v20 offset:12288
  v_mfma_f32_16x16x32_bf16 v[220:223], v[188:191], v[112:115], v[220:223]
  v_mfma_f32_16x16x32_bf16 v[252:255], v[188:191], v[116:119], v[252:255]
  ds_read_b64_tr_b16 v[188:189], v21 offset:8192
  ds_read_b64_tr_b16 v[190:191], v21 offset:12288
  s_waitcnt vmcnt(16)
  v_swap_b32 v122, v124
  v_swap_b32 v123, v125
  s_setprio 3
  s_barrier
  s_waitcnt lgkmcnt(8)
  v_mfma_f32_16x16x32_bf16 v[192:195], v[160:163], v[120:123], v[192:195]
  s_lshl_b32 s48, s71, 14
  v_mfma_f32_16x16x32_bf16 v[224:227], v[160:163], v[124:127], v[224:227]
  s_lshl_b32 s49, s70, 13
  ds_read_b64_tr_b16 v[160:161], v14 offset:16384
  ds_read_b64_tr_b16 v[162:163], v14 offset:20480
  s_add_u32 m0, s86, 0
  s_add_u32 s85, s85, 65536
  buffer_load_dwordx4 v9, s[80:83], s85 offen lds
  v_mfma_f32_16x16x32_bf16 v[196:199], v[164:167], v[120:123], v[196:199]
  s_add_u32 s48, s48, s49
  v_mfma_f32_16x16x32_bf16 v[228:231], v[164:167], v[124:127], v[228:231]
  v_add_u32 v11, s48, v2
  s_setprio 2
  ds_read_b64_tr_b16 v[164:165], v15 offset:16384
  ds_read_b64_tr_b16 v[166:167], v15 offset:20480
  v_mfma_f32_16x16x32_bf16 v[200:203], v[168:171], v[120:123], v[200:203]
  v_mfma_f32_16x16x32_bf16 v[232:235], v[168:171], v[124:127], v[232:235]
  ds_read_b64_tr_b16 v[168:169], v16 offset:16384
  ds_read_b64_tr_b16 v[170:171], v16 offset:20480
  buffer_load_dwordx4 v[112:115], v26, s[76:79], s84 offen offset:0 sc1
  v_mfma_f32_16x16x32_bf16 v[204:207], v[172:175], v[120:123], v[204:207]
  v_xor_b32 v84, 0x2000, v11
  v_mfma_f32_16x16x32_bf16 v[236:239], v[172:175], v[124:127], v[236:239]
  s_setprio 1
  ds_read_b64_tr_b16 v[172:173], v17 offset:16384
  ds_read_b64_tr_b16 v[174:175], v17 offset:20480
  s_waitcnt lgkmcnt(8)
  v_mfma_f32_16x16x32_bf16 v[208:211], v[176:179], v[120:123], v[208:211]
  s_lshl_b32 s48, s72, 3
  v_mfma_f32_16x16x32_bf16 v[240:243], v[176:179], v[124:127], v[240:243]
  s_add_u32 s48, s48, s73
  ds_read_b64_tr_b16 v[176:177], v18 offset:16384
  ds_read_b64_tr_b16 v[178:179], v18 offset:20480
  v_mfma_f32_16x16x32_bf16 v[212:215], v[180:183], v[120:123], v[212:215]
  v_mfma_f32_16x16x32_bf16 v[244:247], v[180:183], v[124:127], v[244:247]
  s_lshl_b32 s48, s48, 1
  s_setprio 0
  ds_read_b64_tr_b16 v[180:181], v19 offset:16384
  ds_read_b64_tr_b16 v[182:183], v19 offset:20480
  buffer_load_dwordx4 v[116:119], v27, s[76:79], s84 offen offset:0 sc1
  v_mfma_f32_16x16x32_bf16 v[216:219], v[184:187], v[120:123], v[216:219]
  s_add_u32 s49, s48, s74
  v_mfma_f32_16x16x32_bf16 v[248:251], v[184:187], v[124:127], v[248:251]
  s_xor_b32 s48, s49, 1
  ds_read_b64_tr_b16 v[184:185], v20 offset:16384
  ds_read_b64_tr_b16 v[186:187], v20 offset:20480
  v_mfma_f32_16x16x32_bf16 v[220:223], v[188:191], v[120:123], v[220:223]
  s_lshl_b32 s48, s48, 3
  v_mfma_f32_16x16x32_bf16 v[252:255], v[188:191], v[124:127], v[252:255]
  ds_read_b64_tr_b16 v[188:189], v21 offset:16384
  ds_read_b64_tr_b16 v[190:191], v21 offset:20480
  s_waitcnt vmcnt(15)
  v_swap_b32 v130, v132
  v_swap_b32 v131, v133
  s_setprio 3
  s_barrier
  s_waitcnt lgkmcnt(8)
  v_mfma_f32_16x16x32_bf16 v[192:195], v[160:163], v[128:131], v[192:195]
  s_add_u32 s48, s48, s36
  v_mfma_f32_16x16x32_bf16 v[224:227], v[160:163], v[132:135], v[224:227]
  s_lshl_b32 s49, s49, 3
  ds_read_b64_tr_b16 v[160:161], v14 offset:24576
  ds_read_b64_tr_b16 v[162:163], v14 offset:28672
  s_add_u32 m0, s86, 8192
  s_add_u32 s85, s85, 65536
  buffer_load_dwordx4 v9, s[80:83], s85 offen lds
  v_mfma_f32_16x16x32_bf16 v[196:199], v[164:167], v[128:131], v[196:199]
  s_add_u32 s49, s49, s36
  v_mfma_f32_16x16x32_bf16 v[228:231], v[164:167], v[132:135], v[228:231]
  s_lshl_b32 s90, s48, 12
  s_setprio 2
  ds_read_b64_tr_b16 v[164:165], v15 offset:24576
  ds_read_b64_tr_b16 v[166:167], v15 offset:28672
  v_mfma_f32_16x16x32_bf16 v[200:203], v[168:171], v[128:131], v[200:203]
  s_mov_b32 m0, s69
  s_nop 0
  buffer_load_dwordx4 v10, s[32:35], 0 offen lds
  s_add_u32 s90, s90, 33554432
  v_mfma_f32_16x16x32_bf16 v[232:235], v[168:171], v[132:135], v[232:235]
  ds_read_b64_tr_b16 v[168:169], v16 offset:24576
  ds_read_b64_tr_b16 v[170:171], v16 offset:28672
  buffer_load_dwordx4 v[120:123], v26, s[76:79], s84 offen offset:2048 sc1
  v_mfma_f32_16x16x32_bf16 v[204:207], v[172:175], v[128:131], v[204:207]
  s_lshl_b32 s91, s49, 12
  v_mfma_f32_16x16x32_bf16 v[236:239], v[172:175], v[132:135], v[236:239]
  s_add_u32 s91, s91, 33554432
  s_setprio 1
  ds_read_b64_tr_b16 v[172:173], v17 offset:24576
  ds_read_b64_tr_b16 v[174:175], v17 offset:28672
  s_waitcnt lgkmcnt(8)
  v_mfma_f32_16x16x32_bf16 v[208:211], v[176:179], v[128:131], v[208:211]
  s_lshl_b32 s92, s48, 2
  v_mfma_f32_16x16x32_bf16 v[240:243], v[176:179], v[132:135], v[240:243]
  s_add_u32 s92, s92, 29384704
  ds_read_b64_tr_b16 v[176:177], v18 offset:24576
  ds_read_b64_tr_b16 v[178:179], v18 offset:28672
  v_mfma_f32_16x16x32_bf16 v[212:215], v[180:183], v[128:131], v[212:215]
  v_mfma_f32_16x16x32_bf16 v[244:247], v[180:183], v[132:135], v[244:247]
  s_lshl_b32 s93, s49, 2
  s_setprio 0
  ds_read_b64_tr_b16 v[180:181], v19 offset:24576
  ds_read_b64_tr_b16 v[182:183], v19 offset:28672
  buffer_load_dwordx4 v[124:127], v27, s[76:79], s84 offen offset:2048 sc1
  s_add_u32 s84, s84, 4096
  v_mfma_f32_16x16x32_bf16 v[216:219], v[184:187], v[128:131], v[216:219]
  s_add_u32 s93, s93, 29384704
  v_mfma_f32_16x16x32_bf16 v[248:251], v[184:187], v[132:135], v[248:251]
  v_mov_b32 v86, 0
  ds_read_b64_tr_b16 v[184:185], v20 offset:24576
  ds_read_b64_tr_b16 v[186:187], v20 offset:28672
  v_mfma_f32_16x16x32_bf16 v[220:223], v[188:191], v[128:131], v[220:223]
  v_mfma_f32_16x16x32_bf16 v[252:255], v[188:191], v[132:135], v[252:255]
  ds_read_b64_tr_b16 v[188:189], v21 offset:24576
  ds_read_b64_tr_b16 v[190:191], v21 offset:28672
  s_waitcnt vmcnt(12)
  v_swap_b32 v138, v140
  v_swap_b32 v139, v141
  s_setprio 3
  s_barrier
  s_waitcnt lgkmcnt(8)
  v_mfma_f32_16x16x32_bf16 v[192:195], v[160:163], v[136:139], v[192:195]
  v_mfma_f32_16x16x32_bf16 v[224:227], v[160:163], v[140:143], v[224:227]
  ds_read_b64_tr_b16 v[160:161], v22 offset:32768
  ds_read_b64_tr_b16 v[162:163], v22 offset:34816
  s_add_u32 m0, s86, 16384
  s_add_u32 s85, s85, 65536
  buffer_load_dwordx4 v9, s[80:83], s85 offen lds
  v_mfma_f32_16x16x32_bf16 v[196:199], v[164:167], v[136:139], v[196:199]
  v_mfma_f32_16x16x32_bf16 v[228:231], v[164:167], v[140:143], v[228:231]
  s_add_u32 m0, s69, 1024
  s_nop 0
  buffer_load_dwordx4 v10, s[32:35], s68 offen lds
  s_setprio 2
  ds_read_b64_tr_b16 v[164:165], v23 offset:32768
  ds_read_b64_tr_b16 v[166:167], v23 offset:34816
  v_mfma_f32_16x16x32_bf16 v[200:203], v[168:171], v[136:139], v[200:203]
  v_mfma_f32_16x16x32_bf16 v[232:235], v[168:171], v[140:143], v[232:235]
  ds_read_b64_tr_b16 v[168:169], v24 offset:32768
  ds_read_b64_tr_b16 v[170:171], v24 offset:34816
  buffer_load_dwordx4 v[128:131], v26, s[76:79], s84 offen offset:0 sc1
  v_mfma_f32_16x16x32_bf16 v[204:207], v[172:175], v[136:139], v[204:207]
  v_mfma_f32_16x16x32_bf16 v[236:239], v[172:175], v[140:143], v[236:239]
  s_setprio 1
  ds_read_b64_tr_b16 v[172:173], v25 offset:32768
  ds_read_b64_tr_b16 v[174:175], v25 offset:34816
  s_waitcnt lgkmcnt(8)
  v_mfma_f32_16x16x32_bf16 v[208:211], v[176:179], v[136:139], v[208:211]
  s_mov_b32 s32, s66
  v_mfma_f32_16x16x32_bf16 v[240:243], v[176:179], v[140:143], v[240:243]
  s_mov_b32 s33, s67
  v_mfma_f32_16x16x32_bf16 v[212:215], v[180:183], v[136:139], v[212:215]
  s_mov_b32 s34, 4194304
  v_mfma_f32_16x16x32_bf16 v[244:247], v[180:183], v[140:143], v[244:247]
  s_mov_b32 s35, 0x20000
  s_setprio 0
  buffer_load_dwordx4 v[132:135], v27, s[76:79], s84 offen offset:0 sc1
  v_mfma_f32_16x16x32_bf16 v[216:219], v[184:187], v[136:139], v[216:219]
  v_mfma_f32_16x16x32_bf16 v[248:251], v[184:187], v[140:143], v[248:251]
  v_mfma_f32_16x16x32_bf16 v[220:223], v[188:191], v[136:139], v[220:223]
  v_mfma_f32_16x16x32_bf16 v[252:255], v[188:191], v[140:143], v[252:255]
  s_waitcnt vmcnt(13)
  s_setprio 3
  s_barrier
  s_waitcnt lgkmcnt(4)
  v_mfma_f32_16x16x32_bf16 v[36:39], v[160:163], v[144:147], 0
  v_mfma_f32_16x16x32_bf16 v[52:55], v[160:163], v[148:151], 0
  s_setprio 2
  ds_read_b64_tr_b16 v[160:161], v22 offset:40960
  ds_read_b64_tr_b16 v[162:163], v22 offset:43008
  s_add_u32 m0, s86, 24576
  s_add_u32 s85, s85, 65536
  buffer_load_dwordx4 v9, s[80:83], s85 offen lds
  v_mfma_f32_16x16x32_bf16 v[40:43], v[164:167], v[144:147], 0
  ds_write_b128 v84, v[240:243] offset:4096
  v_mfma_f32_16x16x32_bf16 v[56:59], v[164:167], v[148:151], 0
  ds_write_b128 v84, v[244:247] offset:5120
  s_setprio 1
  ds_read_b64_tr_b16 v[164:165], v23 offset:40960
  ds_read_b64_tr_b16 v[166:167], v23 offset:43008
  buffer_load_dwordx4 v[136:139], v26, s[76:79], s84 offen offset:2048 sc1
  s_waitcnt lgkmcnt(6)
  v_mfma_f32_16x16x32_bf16 v[44:47], v[168:171], v[144:147], 0
  ds_write_b128 v84, v[248:251] offset:6144
  v_mfma_f32_16x16x32_bf16 v[60:63], v[168:171], v[148:151], 0
  ds_write_b128 v84, v[252:255] offset:7168
  s_setprio 0
  ds_read_b64_tr_b16 v[168:169], v24 offset:40960
  ds_read_b64_tr_b16 v[170:171], v24 offset:43008
  buffer_load_dwordx4 v[140:143], v27, s[76:79], s84 offen offset:2048 sc1
  s_add_u32 s84, s84, 4096
  v_mfma_f32_16x16x32_bf16 v[48:51], v[172:175], v[144:147], 0
  v_mfma_f32_16x16x32_bf16 v[64:67], v[172:175], v[148:151], 0
  ds_read_b64_tr_b16 v[172:173], v25 offset:40960
  ds_read_b64_tr_b16 v[174:175], v25 offset:43008
  s_waitcnt lgkmcnt(4)
  s_waitcnt vmcnt(13)
  s_setprio 3
  s_barrier
  v_mfma_f32_16x16x32_bf16 v[36:39], v[160:163], v[152:155], v[36:39]
  ds_read_b128 v[240:243], v11 offset:4096
  ds_read_b128 v[244:247], v11 offset:5120
  ds_read_b128 v[248:251], v11 offset:6144
  ds_read_b128 v[252:255], v11 offset:7168
  v_mfma_f32_16x16x32_bf16 v[52:55], v[160:163], v[156:159], v[52:55]
  s_setprio 2
  ds_read_b64_tr_b16 v[160:161], v22 offset:0
  ds_read_b64_tr_b16 v[162:163], v22 offset:2048
  s_add_u32 m0, s86, 32768
  s_add_u32 s85, s85, 65536
  buffer_load_dwordx4 v9, s[80:83], s85 offen lds
  v_mfma_f32_16x16x32_bf16 v[40:43], v[164:167], v[152:155], v[40:43]
  s_waitcnt lgkmcnt(5)
  v_add_f32 v208, v208, v240
  v_add_f32 v209, v209, v241
  v_add_f32 v210, v210, v242
  v_mfma_f32_16x16x32_bf16 v[56:59], v[164:167], v[156:159], v[56:59]
  v_add_f32 v211, v211, v243
  buffer_store_dwordx4 v[208:211], v2, s[28:31], s90 offen offset:0 sc1
  s_waitcnt lgkmcnt(4)
  v_add_f32 v212, v212, v244
  s_setprio 1
  ds_read_b64_tr_b16 v[164:165], v23 offset:0
  ds_read_b64_tr_b16 v[166:167], v23 offset:2048
  buffer_load_dwordx4 v[144:147], v26, s[76:79], s84 offen offset:0 sc1
  v_mfma_f32_16x16x32_bf16 v[44:47], v[168:171], v[152:155], v[44:47]
  v_add_f32 v213, v213, v245
  v_add_f32 v214, v214, v246
  v_add_f32 v215, v215, v247
  buffer_store_dwordx4 v[212:215], v2, s[28:31], s90 offen offset:1024 sc1
  v_mfma_f32_16x16x32_bf16 v[60:63], v[168:171], v[156:159], v[60:63]
  s_waitcnt lgkmcnt(5)
  v_add_f32 v216, v216, v248
  v_add_f32 v217, v217, v249
  v_add_f32 v218, v218, v250
  s_setprio 0
  ds_read_b64_tr_b16 v[168:169], v24 offset:0
  ds_read_b64_tr_b16 v[170:171], v24 offset:2048
  buffer_load_dwordx4 v[148:151], v27, s[76:79], s84 offen offset:0 sc1
  v_mfma_f32_16x16x32_bf16 v[48:51], v[172:175], v[152:155], v[48:51]
  v_add_f32 v219, v219, v251
  buffer_store_dwordx4 v[216:219], v2, s[28:31], s90 offen offset:2048 sc1
  s_waitcnt lgkmcnt(6)
  v_add_f32 v220, v220, v252
  v_add_f32 v221, v221, v253
  v_mfma_f32_16x16x32_bf16 v[64:67], v[172:175], v[156:159], v[64:67]
  v_add_f32 v222, v222, v254
  v_add_f32 v223, v223, v255
  buffer_store_dwordx4 v[220:223], v2, s[28:31], s90 offen offset:3072 sc1
  ds_read_b64_tr_b16 v[172:173], v25 offset:0
  ds_read_b64_tr_b16 v[174:175], v25 offset:2048
  s_waitcnt vmcnt(17)
  s_setprio 3
  s_barrier
  s_waitcnt lgkmcnt(4)
  v_mfma_f32_16x16x32_bf16 v[36:39], v[160:163], v[112:115], v[36:39]
  ds_write_b128 v84, v[224:227] offset:0
  v_mfma_f32_16x16x32_bf16 v[52:55], v[160:163], v[116:119], v[52:55]
  s_setprio 2
  ds_read_b64_tr_b16 v[160:161], v22 offset:8192
  ds_read_b64_tr_b16 v[162:163], v22 offset:10240
  s_add_u32 m0, s86, 40960
  s_add_u32 s85, s85, 65536
  buffer_load_dwordx4 v9, s[80:83], s85 offen lds
  v_mfma_f32_16x16x32_bf16 v[40:43], v[164:167], v[112:115], v[40:43]
  v_mfma_f32_16x16x32_bf16 v[56:59], v[164:167], v[116:119], v[56:59]
  s_setprio 1
  ds_read_b64_tr_b16 v[164:165], v23 offset:8192
  ds_read_b64_tr_b16 v[166:167], v23 offset:10240
  buffer_load_dwordx4 v[152:155], v26, s[76:79], s84 offen offset:2048 sc1
  s_waitcnt lgkmcnt(5)
  v_mfma_f32_16x16x32_bf16 v[44:47], v[168:171], v[112:115], v[44:47]
  ds_write_b128 v84, v[228:231] offset:1024
  v_mfma_f32_16x16x32_bf16 v[60:63], v[168:171], v[116:119], v[60:63]
  s_setprio 0
  ds_read_b64_tr_b16 v[168:169], v24 offset:8192
  ds_read_b64_tr_b16 v[170:171], v24 offset:10240
  buffer_load_dwordx4 v[156:159], v27, s[76:79], s84 offen offset:2048 sc1
  s_add_u32 s84, s84, 4096
  v_mfma_f32_16x16x32_bf16 v[48:51], v[172:175], v[112:115], v[48:51]
  v_mfma_f32_16x16x32_bf16 v[64:67], v[172:175], v[116:119], v[64:67]
  ds_read_b64_tr_b16 v[172:173], v25 offset:8192
  ds_read_b64_tr_b16 v[174:175], v25 offset:10240
  s_waitcnt vmcnt(16)
  s_setprio 3
  s_barrier
  s_waitcnt lgkmcnt(5)
  v_mfma_f32_16x16x32_bf16 v[36:39], v[160:163], v[120:123], v[36:39]
  ds_write_b128 v84, v[232:235] offset:2048
  v_mfma_f32_16x16x32_bf16 v[52:55], v[160:163], v[124:127], v[52:55]
  s_setprio 2
  ds_read_b64_tr_b16 v[160:161], v22 offset:16384
  ds_read_b64_tr_b16 v[162:163], v22 offset:18432
  s_add_u32 m0, s86, 0
  s_add_u32 s85, s85, 65536
  buffer_load_dwordx4 v9, s[80:83], s85 offen lds
  v_mfma_f32_16x16x32_bf16 v[40:43], v[164:167], v[120:123], v[40:43]
  v_mfma_f32_16x16x32_bf16 v[56:59], v[164:167], v[124:127], v[56:59]
  s_setprio 1
  ds_read_b64_tr_b16 v[164:165], v23 offset:16384
  ds_read_b64_tr_b16 v[166:167], v23 offset:18432
  buffer_load_dwordx4 v[112:115], v26, s[76:79], s84 offen offset:0 sc1
  s_waitcnt lgkmcnt(5)
  v_mfma_f32_16x16x32_bf16 v[44:47], v[168:171], v[120:123], v[44:47]
  ds_write_b128 v84, v[236:239] offset:3072
  v_mfma_f32_16x16x32_bf16 v[60:63], v[168:171], v[124:127], v[60:63]
  s_setprio 0
  ds_read_b64_tr_b16 v[168:169], v24 offset:16384
  ds_read_b64_tr_b16 v[170:171], v24 offset:18432
  buffer_load_dwordx4 v[116:119], v27, s[76:79], s84 offen offset:0 sc1
  v_mfma_f32_16x16x32_bf16 v[48:51], v[172:175], v[120:123], v[48:51]
  v_mfma_f32_16x16x32_bf16 v[64:67], v[172:175], v[124:127], v[64:67]
  ds_read_b64_tr_b16 v[172:173], v25 offset:16384
  ds_read_b64_tr_b16 v[174:175], v25 offset:18432
  s_waitcnt vmcnt(15)
  s_setprio 3
  s_barrier
  s_waitcnt lgkmcnt(5)
  v_mfma_f32_16x16x32_bf16 v[36:39], v[160:163], v[128:131], v[36:39]
  v_mfma_f32_16x16x32_bf16 v[52:55], v[160:163], v[132:135], v[52:55]
  s_setprio 2
  ds_read_b64_tr_b16 v[160:161], v22 offset:24576
  ds_read_b64_tr_b16 v[162:163], v22 offset:26624
  s_add_u32 m0, s86, 8192
  s_add_u32 s85, s85, 65536
  buffer_load_dwordx4 v9, s[80:83], s85 offen lds
  v_mfma_f32_16x16x32_bf16 v[40:43], v[164:167], v[128:131], v[40:43]
  v_mfma_f32_16x16x32_bf16 v[56:59], v[164:167], v[132:135], v[56:59]
  s_setprio 1
  ds_read_b64_tr_b16 v[164:165], v23 offset:24576
  ds_read_b64_tr_b16 v[166:167], v23 offset:26624
  buffer_load_dwordx4 v[120:123], v26, s[76:79], s84 offen offset:2048 sc1
  s_waitcnt lgkmcnt(4)
  v_mfma_f32_16x16x32_bf16 v[44:47], v[168:171], v[128:131], v[44:47]
  v_mfma_f32_16x16x32_bf16 v[60:63], v[168:171], v[132:135], v[60:63]
  s_setprio 0
  ds_read_b64_tr_b16 v[168:169], v24 offset:24576
  ds_read_b64_tr_b16 v[170:171], v24 offset:26624
  buffer_load_dwordx4 v[124:127], v27, s[76:79], s84 offen offset:2048 sc1
  s_add_u32 s84, s84, 4096
  v_mfma_f32_16x16x32_bf16 v[48:51], v[172:175], v[128:131], v[48:51]
  v_mfma_f32_16x16x32_bf16 v[64:67], v[172:175], v[132:135], v[64:67]
  ds_read_b64_tr_b16 v[172:173], v25 offset:24576
  ds_read_b64_tr_b16 v[174:175], v25 offset:26624
  s_waitcnt vmcnt(15)
  s_setprio 3
  s_barrier
  s_waitcnt lgkmcnt(4)
  v_mfma_f32_16x16x32_bf16 v[36:39], v[160:163], v[136:139], v[36:39]
  ds_read_b128 v[224:227], v11 offset:0
  ds_read_b128 v[228:231], v11 offset:1024
  s_waitcnt vmcnt(9)
  buffer_store_dword v5, v6, s[28:31], s92 offen sc1
  v_mfma_f32_16x16x32_bf16 v[52:55], v[160:163], v[140:143], v[52:55]
  ds_read_b128 v[232:235], v11 offset:2048
  ds_read_b128 v[236:239], v11 offset:3072
  s_setprio 2
  ds_read_b64_tr_b16 v[160:161], v22 offset:32768
  ds_read_b64_tr_b16 v[162:163], v22 offset:34816
  s_add_u32 m0, s86, 16384
  s_add_u32 s85, s85, 65536
  buffer_load_dwordx4 v9, s[80:83], s85 offen lds
  v_mfma_f32_16x16x32_bf16 v[40:43], v[164:167], v[136:139], v[40:43]
  v_mfma_f32_16x16x32_bf16 v[56:59], v[164:167], v[140:143], v[56:59]
  s_setprio 1
  ds_read_b64_tr_b16 v[164:165], v23 offset:32768
  ds_read_b64_tr_b16 v[166:167], v23 offset:34816
  buffer_load_dwordx4 v[128:131], v26, s[76:79], s84 offen offset:0 sc1
  s_waitcnt lgkmcnt(8)
  v_mfma_f32_16x16x32_bf16 v[44:47], v[168:171], v[136:139], v[44:47]
  s_waitcnt lgkmcnt(7)
  v_mfma_f32_16x16x32_bf16 v[60:63], v[168:171], v[140:143], v[60:63]
  v_add_f32 v192, v192, v224
  v_add_f32 v193, v193, v225
  s_setprio 0
  ds_read_b64_tr_b16 v[168:169], v24 offset:32768
  ds_read_b64_tr_b16 v[170:171], v24 offset:34816
  buffer_load_dwordx4 v[132:135], v27, s[76:79], s84 offen offset:0 sc1
  v_mfma_f32_16x16x32_bf16 v[48:51], v[172:175], v[136:139], v[48:51]
  v_add_f32 v194, v194, v226
  v_mfma_f32_16x16x32_bf16 v[64:67], v[172:175], v[140:143], v[64:67]
  v_add_f32 v195, v195, v227
  s_waitcnt lgkmcnt(8)
  ds_read_b64_tr_b16 v[172:173], v25 offset:32768
  ds_read_b64_tr_b16 v[174:175], v25 offset:34816
  s_waitcnt vmcnt(12)
  s_setprio 3
  s_barrier
  s_waitcnt lgkmcnt(4)
  v_mfma_f32_16x16x32_bf16 v[36:39], v[160:163], v[144:147], v[36:39]
  v_add_f32 v196, v196, v228
  v_add_f32 v197, v197, v229
  v_mfma_f32_16x16x32_bf16 v[52:55], v[160:163], v[148:151], v[52:55]
  v_add_f32 v198, v198, v230
  v_add_f32 v199, v199, v231
  s_setprio 2
  ds_read_b64_tr_b16 v[160:161], v22 offset:40960
  ds_read_b64_tr_b16 v[162:163], v22 offset:43008
  s_add_u32 m0, s86, 24576
  s_add_u32 s85, s85, 65536
  buffer_load_dwordx4 v9, s[80:83], s85 offen lds
  v_mfma_f32_16x16x32_bf16 v[40:43], v[164:167], v[144:147], v[40:43]
  v_add_f32 v200, v200, v232
  v_mfma_f32_16x16x32_bf16 v[56:59], v[164:167], v[148:151], v[56:59]
  v_add_f32 v201, v201, v233
  s_setprio 1
  ds_read_b64_tr_b16 v[164:165], v23 offset:40960
  ds_read_b64_tr_b16 v[166:167], v23 offset:43008
  buffer_load_dwordx4 v[136:139], v26, s[76:79], s84 offen offset:2048 sc1
  s_waitcnt lgkmcnt(4)
  v_mfma_f32_16x16x32_bf16 v[44:47], v[168:171], v[144:147], v[44:47]
  v_add_f32 v202, v202, v234
  v_add_f32 v203, v203, v235
  v_mfma_f32_16x16x32_bf16 v[60:63], v[168:171], v[148:151], v[60:63]
  v_add_f32 v204, v204, v236
  s_setprio 0
  ds_read_b64_tr_b16 v[168:169], v24 offset:40960
  ds_read_b64_tr_b16 v[170:171], v24 offset:43008
  buffer_load_dwordx4 v[140:143], v27, s[76:79], s84 offen offset:2048 sc1
  s_add_u32 s84, s84, 4096
  v_mfma_f32_16x16x32_bf16 v[48:51], v[172:175], v[144:147], v[48:51]
  v_add_f32 v205, v205, v237
  v_add_f32 v206, v206, v238
  v_mfma_f32_16x16x32_bf16 v[64:67], v[172:175], v[148:151], v[64:67]
  v_add_f32 v207, v207, v239
  ds_read_b64_tr_b16 v[172:173], v25 offset:40960
  ds_read_b64_tr_b16 v[174:175], v25 offset:43008
  s_waitcnt vmcnt(12)
  s_setprio 3
  s_barrier
  s_waitcnt lgkmcnt(4)
  v_mfma_f32_16x16x32_bf16 v[36:39], v[160:163], v[152:155], v[36:39]
  v_mfma_f32_16x16x32_bf16 v[52:55], v[160:163], v[156:159], v[52:55]
  s_setprio 2
  ds_read_b64_tr_b16 v[160:161], v22 offset:0
  ds_read_b64_tr_b16 v[162:163], v22 offset:2048
  s_add_u32 m0, s86, 32768
  s_add_u32 s85, s85, 65536
  buffer_load_dwordx4 v9, s[80:83], s85 offen lds
  v_mfma_f32_16x16x32_bf16 v[40:43], v[164:167], v[152:155], v[40:43]
  v_mfma_f32_16x16x32_bf16 v[56:59], v[164:167], v[156:159], v[56:59]
  s_setprio 1
  ds_read_b64_tr_b16 v[164:165], v23 offset:0
  ds_read_b64_tr_b16 v[166:167], v23 offset:2048
  buffer_load_dwordx4 v[144:147], v26, s[76:79], s84 offen offset:0 sc1
  s_waitcnt lgkmcnt(4)
  v_mfma_f32_16x16x32_bf16 v[44:47], v[168:171], v[152:155], v[44:47]
  v_mfma_f32_16x16x32_bf16 v[60:63], v[168:171], v[156:159], v[60:63]
  s_setprio 0
  ds_read_b64_tr_b16 v[168:169], v24 offset:0
  ds_read_b64_tr_b16 v[170:171], v24 offset:2048
  buffer_load_dwordx4 v[148:151], v27, s[76:79], s84 offen offset:0 sc1
  v_mfma_f32_16x16x32_bf16 v[48:51], v[172:175], v[152:155], v[48:51]
  v_mfma_f32_16x16x32_bf16 v[64:67], v[172:175], v[156:159], v[64:67]
  ds_read_b64_tr_b16 v[172:173], v25 offset:0
  ds_read_b64_tr_b16 v[174:175], v25 offset:2048
  s_waitcnt vmcnt(12)
  s_setprio 3
  s_barrier
  s_waitcnt lgkmcnt(4)
  v_mfma_f32_16x16x32_bf16 v[36:39], v[160:163], v[112:115], v[36:39]
  ds_read_b64 v[176:177], v68
  v_mfma_f32_16x16x32_bf16 v[52:55], v[160:163], v[116:119], v[52:55]
  ds_read_b64 v[178:179], v69
  s_setprio 2
  ds_read_b64_tr_b16 v[160:161], v22 offset:8192
  ds_read_b64_tr_b16 v[162:163], v22 offset:10240
  s_add_u32 m0, s86, 40960
  s_add_u32 s85, s85, 65536
  buffer_load_dwordx4 v9, s[80:83], s85 offen lds
  v_mfma_f32_16x16x32_bf16 v[40:43], v[164:167], v[112:115], v[40:43]
  ds_read_b64 v[180:181], v70
  v_mfma_f32_16x16x32_bf16 v[56:59], v[164:167], v[116:119], v[56:59]
  ds_read_b64 v[182:183], v71
  v_lshlrev_b32 v224, 16, v76
  s_setprio 1
  ds_read_b64_tr_b16 v[164:165], v23 offset:8192
  ds_read_b64_tr_b16 v[166:167], v23 offset:10240
  buffer_load_dwordx4 v[152:155], v26, s[76:79], s84 offen offset:2048 sc1
  s_waitcnt lgkmcnt(8)
  v_mfma_f32_16x16x32_bf16 v[44:47], v[168:171], v[112:115], v[44:47]
  v_and_b32 v225, s57, v76
  v_mfma_f32_16x16x32_bf16 v[60:63], v[168:171], v[116:119], v[60:63]
  v_lshlrev_b32 v226, 16, v77
  s_setprio 0
  ds_read_b64_tr_b16 v[168:169], v24 offset:8192
  ds_read_b64_tr_b16 v[170:171], v24 offset:10240
  buffer_load_dwordx4 v[156:159], v27, s[76:79], s84 offen offset:2048 sc1
  s_add_u32 s84, s84, 4096
  v_mfma_f32_16x16x32_bf16 v[48:51], v[172:175], v[112:115], v[48:51]
  v_and_b32 v227, s57, v77
  v_mfma_f32_16x16x32_bf16 v[64:67], v[172:175], v[116:119], v[64:67]
  v_lshlrev_b32 v228, 16, v78
  ds_read_b64_tr_b16 v[172:173], v25 offset:8192
  ds_read_b64_tr_b16 v[174:175], v25 offset:10240
  s_waitcnt vmcnt(11)
  s_setprio 3
  s_barrier
  s_waitcnt lgkmcnt(4)
  v_mfma_f32_16x16x32_bf16 v[36:39], v[160:163], v[120:123], v[36:39]
  v_and_b32 v229, s57, v78
  v_mfma_f32_16x16x32_bf16 v[52:55], v[160:163], v[124:127], v[52:55]
  v_lshlrev_b32 v230, 16, v79
  v_and_b32 v231, s57, v79
  s_setprio 2
  ds_read_b64_tr_b16 v[160:161], v22 offset:16384
  ds_read_b64_tr_b16 v[162:163], v22 offset:18432
  s_add_u32 m0, s86, 0
  s_add_u32 s85, s85, 65536
  buffer_load_dwordx4 v9, s[80:83], s85 offen lds
  v_mfma_f32_16x16x32_bf16 v[40:43], v[164:167], v[120:123], v[40:43]
  v_lshlrev_b32 v232, 16, v80
  v_mfma_f32_16x16x32_bf16 v[56:59], v[164:167], v[124:127], v[56:59]
  v_and_b32 v233, s57, v80
  s_setprio 1
  ds_read_b64_tr_b16 v[164:165], v23 offset:16384
  ds_read_b64_tr_b16 v[166:167], v23 offset:18432
  buffer_load_dwordx4 v[112:115], v26, s[76:79], s84 offen offset:0 sc1
  s_waitcnt lgkmcnt(4)
  v_mfma_f32_16x16x32_bf16 v[44:47], v[168:171], v[120:123], v[44:47]
  v_lshlrev_b32 v234, 16, v81
  v_mfma_f32_16x16x32_bf16 v[60:63], v[168:171], v[124:127], v[60:63]
  v_and_b32 v235, s57, v81
  s_setprio 0
  ds_read_b64_tr_b16 v[168:169], v24 offset:16384
  ds_read_b64_tr_b16 v[170:171], v24 offset:18432
  buffer_load_dwordx4 v[116:119], v27, s[76:79], s84 offen offset:0 sc1
  v_mfma_f32_16x16x32_bf16 v[48:51], v[172:175], v[120:123], v[48:51]
  v_lshlrev_b32 v236, 16, v82
  v_mfma_f32_16x16x32_bf16 v[64:67], v[172:175], v[124:127], v[64:67]
  v_and_b32 v237, s57, v82
  ds_read_b64_tr_b16 v[172:173], v25 offset:16384
  ds_read_b64_tr_b16 v[174:175], v25 offset:18432
  s_waitcnt vmcnt(11)
  s_setprio 3
  s_barrier
  s_waitcnt lgkmcnt(4)
  v_mfma_f32_16x16x32_bf16 v[36:39], v[160:163], v[128:131], v[36:39]
  buffer_load_dword v85, v86, s[28:31], s93 offen sc1
  v_lshlrev_b32 v238, 16, v83
  v_and_b32 v239, s57, v83
  v_mfma_f32_16x16x32_bf16 v[52:55], v[160:163], v[132:135], v[52:55]
  s_setprio 2
  ds_read_b64_tr_b16 v[160:161], v22 offset:24576
  ds_read_b64_tr_b16 v[162:163], v22 offset:26624
  s_add_u32 m0, s86, 8192
  s_add_u32 s85, s85, 65536
  buffer_load_dwordx4 v9, s[80:83], s85 offen lds
  v_mfma_f32_16x16x32_bf16 v[40:43], v[164:167], v[128:131], v[40:43]
  v_lshlrev_b32 v96, 16, v176
  v_mfma_f32_16x16x32_bf16 v[56:59], v[164:167], v[132:135], v[56:59]
  v_and_b32 v97, s57, v176
  v_lshlrev_b32 v98, 16, v177
  s_setprio 1
  ds_read_b64_tr_b16 v[164:165], v23 offset:24576
  ds_read_b64_tr_b16 v[166:167], v23 offset:26624
  buffer_load_dwordx4 v[120:123], v26, s[76:79], s84 offen offset:2048 sc1
  s_waitcnt lgkmcnt(4)
  v_mfma_f32_16x16x32_bf16 v[44:47], v[168:171], v[128:131], v[44:47]
  v_and_b32 v99, s57, v177
  v_mfma_f32_16x16x32_bf16 v[60:63], v[168:171], v[132:135], v[60:63]
  v_lshlrev_b32 v100, 16, v178
  s_setprio 0
  ds_read_b64_tr_b16 v[168:169], v24 offset:24576
  ds_read_b64_tr_b16 v[170:171], v24 offset:26624
  buffer_load_dwordx4 v[124:127], v27, s[76:79], s84 offen offset:2048 sc1
  s_add_u32 s84, s84, 4096
  v_mfma_f32_16x16x32_bf16 v[48:51], v[172:175], v[128:131], v[48:51]
  v_and_b32 v101, s57, v178
  v_mfma_f32_16x16x32_bf16 v[64:67], v[172:175], v[132:135], v[64:67]
  v_lshlrev_b32 v102, 16, v179
  ds_read_b64_tr_b16 v[172:173], v25 offset:24576
  ds_read_b64_tr_b16 v[174:175], v25 offset:26624
  s_waitcnt vmcnt(12)
  s_setprio 3
  s_barrier
  s_waitcnt lgkmcnt(4)
  v_mfma_f32_16x16x32_bf16 v[36:39], v[160:163], v[136:139], v[36:39]
  v_and_b32 v103, s57, v179
  v_mfma_f32_16x16x32_bf16 v[52:55], v[160:163], v[140:143], v[52:55]
  v_lshlrev_b32 v104, 16, v180
  v_and_b32 v105, s57, v180
  s_setprio 2
  ds_read_b64_tr_b16 v[160:161], v22 offset:32768
  ds_read_b64_tr_b16 v[162:163], v22 offset:34816
  v_mfma_f32_16x16x32_bf16 v[40:43], v[164:167], v[136:139], v[40:43]
  v_lshlrev_b32 v106, 16, v181
  v_mfma_f32_16x16x32_bf16 v[56:59], v[164:167], v[140:143], v[56:59]
  v_and_b32 v107, s57, v181
  s_setprio 1
  ds_read_b64_tr_b16 v[164:165], v23 offset:32768
  ds_read_b64_tr_b16 v[166:167], v23 offset:34816
  s_waitcnt lgkmcnt(4)
  v_mfma_f32_16x16x32_bf16 v[44:47], v[168:171], v[136:139], v[44:47]
  v_lshlrev_b32 v108, 16, v182
  v_mfma_f32_16x16x32_bf16 v[60:63], v[168:171], v[140:143], v[60:63]
  v_and_b32 v109, s57, v182
  s_setprio 0
  ds_read_b64_tr_b16 v[168:169], v24 offset:32768
  ds_read_b64_tr_b16 v[170:171], v24 offset:34816
  v_mfma_f32_16x16x32_bf16 v[48:51], v[172:175], v[136:139], v[48:51]
  v_lshlrev_b32 v110, 16, v183
  v_mfma_f32_16x16x32_bf16 v[64:67], v[172:175], v[140:143], v[64:67]
  v_and_b32 v111, s57, v183
  ds_read_b64_tr_b16 v[172:173], v25 offset:32768
  ds_read_b64_tr_b16 v[174:175], v25 offset:34816
  s_waitcnt vmcnt(9)
  s_setprio 3
  s_barrier
  s_waitcnt lgkmcnt(4)
  v_mfma_f32_16x16x32_bf16 v[36:39], v[160:163], v[144:147], v[36:39]
  s_waitcnt vmcnt(3)
  v_cmp_ne_u32 vcc, 1, v85
  s_mov_b32 s3, 0
  s_nop 0
  s_cmp_eq_u64 vcc, 0
  s_cbranch_scc1 Lok7
Lsp8:
  s_sleep 1
  buffer_load_dword v85, v86, s[28:31], s93 offen sc1
  s_waitcnt vmcnt(0)
  v_cmp_ne_u32 vcc, 1, v85
  s_add_u32 s3, s3, 1
  s_nop 0
  s_cmp_eq_u64 vcc, 0
  s_cbranch_scc1 Lok7
  s_cmp_lt_u32 s3, 0x40000
  s_cbranch_scc1 Lsp8
Lok7:
  buffer_load_dwordx4 v[240:243], v2, s[28:31], s91 offen offset:0 sc1
  buffer_load_dwordx4 v[244:247], v2, s[28:31], s91 offen offset:1024 sc1
  buffer_load_dwordx4 v[248:251], v2, s[28:31], s91 offen offset:2048 sc1
  buffer_load_dwordx4 v[252:255], v2, s[28:31], s91 offen offset:3072 sc1
  v_mfma_f32_16x16x32_bf16 v[52:55], v[160:163], v[148:151], v[52:55]
  s_setprio 2
  ds_read_b64_tr_b16 v[160:161], v22 offset:40960
  ds_read_b64_tr_b16 v[162:163], v22 offset:43008
  v_mfma_f32_16x16x32_bf16 v[40:43], v[164:167], v[144:147], v[40:43]
  v_mfma_f32_16x16x32_bf16 v[56:59], v[164:167], v[148:151], v[56:59]
  s_setprio 1
  ds_read_b64_tr_b16 v[164:165], v23 offset:40960
  ds_read_b64_tr_b16 v[166:167], v23 offset:43008
  s_waitcnt lgkmcnt(4)
  v_mfma_f32_16x16x32_bf16 v[44:47], v[168:171], v[144:147], v[44:47]
  v_mfma_f32_16x16x32_bf16 v[60:63], v[168:171], v[148:151], v[60:63]
  s_setprio 0
  ds_read_b64_tr_b16 v[168:169], v24 offset:40960
  ds_read_b64_tr_b16 v[170:171], v24 offset:43008
  v_mfma_f32_16x16x32_bf16 v[48:51], v[172:175], v[144:147], v[48:51]
  v_mfma_f32_16x16x32_bf16 v[64:67], v[172:175], v[148:151], v[64:67]
  ds_read_b64_tr_b16 v[172:173], v25 offset:40960
  ds_read_b64_tr_b16 v[174:175], v25 offset:43008
  s_setprio 3
  s_barrier
  s_waitcnt lgkmcnt(4)
  v_mfma_f32_16x16x32_bf16 v[36:39], v[160:163], v[152:155], v[36:39]
  v_mfma_f32_16x16x32_bf16 v[52:55], v[160:163], v[156:159], v[52:55]
  s_setprio 2
  ds_read_b64_tr_b16 v[160:161], v22 offset:0
  ds_read_b64_tr_b16 v[162:163], v22 offset:2048
  v_mfma_f32_16x16x32_bf16 v[40:43], v[164:167], v[152:155], v[40:43]
  v_mfma_f32_16x16x32_bf16 v[56:59], v[164:167], v[156:159], v[56:59]
  s_setprio 1
  ds_read_b64_tr_b16 v[164:165], v23 offset:0
  ds_read_b64_tr_b16 v[166:167], v23 offset:2048
  s_waitcnt lgkmcnt(4)
  v_mfma_f32_16x16x32_bf16 v[44:47], v[168:171], v[152:155], v[44:47]
  v_mfma_f32_16x16x32_bf16 v[60:63], v[168:171], v[156:159], v[60:63]
  s_setprio 0
  ds_read_b64_tr_b16 v[168:169], v24 offset:0
  ds_read_b64_tr_b16 v[170:171], v24 offset:2048
  v_mfma_f32_16x16x32_bf16 v[48:51], v[172:175], v[152:155], v[48:51]
  v_mfma_f32_16x16x32_bf16 v[64:67], v[172:175], v[156:159], v[64:67]
  ds_read_b64_tr_b16 v[172:173], v25 offset:0
  ds_read_b64_tr_b16 v[174:175], v25 offset:2048
  s_waitcnt vmcnt(6)
  s_setprio 3
  s_barrier
  s_waitcnt lgkmcnt(4)
  v_mfma_f32_16x16x32_bf16 v[36:39], v[160:163], v[112:115], v[36:39]
  v_mfma_f32_16x16x32_bf16 v[52:55], v[160:163], v[116:119], v[52:55]
  s_setprio 2
  ds_read_b64_tr_b16 v[160:161], v22 offset:8192
  ds_read_b64_tr_b16 v[162:163], v22 offset:10240
  v_mfma_f32_16x16x32_bf16 v[40:43], v[164:167], v[112:115], v[40:43]
  v_mfma_f32_16x16x32_bf16 v[56:59], v[164:167], v[116:119], v[56:59]
  s_setprio 1
  ds_read_b64_tr_b16 v[164:165], v23 offset:8192
  ds_read_b64_tr_b16 v[166:167], v23 offset:10240
  s_waitcnt lgkmcnt(4)
  v_mfma_f32_16x16x32_bf16 v[44:47], v[168:171], v[112:115], v[44:47]
  v_mfma_f32_16x16x32_bf16 v[60:63], v[168:171], v[116:119], v[60:63]
  s_setprio 0
  ds_read_b64_tr_b16 v[168:169], v24 offset:8192
  ds_read_b64_tr_b16 v[170:171], v24 offset:10240
  v_mfma_f32_16x16x32_bf16 v[48:51], v[172:175], v[112:115], v[48:51]
  v_mfma_f32_16x16x32_bf16 v[64:67], v[172:175], v[116:119], v[64:67]
  ds_read_b64_tr_b16 v[172:173], v25 offset:8192
  ds_read_b64_tr_b16 v[174:175], v25 offset:10240
  s_waitcnt vmcnt(4)
  s_setprio 3
  s_barrier
  s_waitcnt lgkmcnt(4)
  v_mfma_f32_16x16x32_bf16 v[52:55], v[160:163], v[124:127], v[52:55]
  v_mfma_f32_16x16x32_bf16 v[56:59], v[164:167], v[124:127], v[56:59]
  s_waitcnt lgkmcnt(0)
  v_mfma_f32_16x16x32_bf16 v[60:63], v[168:171], v[124:127], v[60:63]
  v_mfma_f32_16x16x32_bf16 v[64:67], v[172:175], v[124:127], v[64:67]
  v_mfma_f32_16x16x32_bf16 v[36:39], v[160:163], v[120:123], v[36:39]
  s_nop 2
  ds_write_b128 v84, v[52:55] offset:0
  v_mfma_f32_16x16x32_bf16 v[40:43], v[164:167], v[120:123], v[40:43]
  ds_write_b128 v84, v[56:59] offset:1024
  v_mfma_f32_16x16x32_bf16 v[44:47], v[168:171], v[120:123], v[44:47]
  ds_write_b128 v84, v[60:63] offset:2048
  v_mfma_f32_16x16x32_bf16 v[48:51], v[172:175], v[120:123], v[48:51]
  ds_write_b128 v84, v[64:67] offset:3072
  s_setprio 0
  s_waitcnt vmcnt(0)
  v_pk_add_f32 v[192:193], v[192:193], v[240:241]
  v_pk_add_f32 v[194:195], v[194:195], v[242:243]
  v_pk_add_f32 v[196:197], v[196:197], v[244:245]
  v_pk_add_f32 v[198:199], v[198:199], v[246:247]
  v_pk_add_f32 v[200:201], v[200:201], v[248:249]
  v_pk_add_f32 v[202:203], v[202:203], v[250:251]
  v_pk_add_f32 v[204:205], v[204:205], v[252:253]
  v_pk_add_f32 v[206:207], v[206:207], v[254:255]
  v_cvt_pk_bf16_f32 v192, 0, v192
  v_cvt_pk_bf16_f32 v193, 0, v193
  v_cvt_pk_bf16_f32 v194, 0, v194
  v_cvt_pk_bf16_f32 v195, 0, v195
  v_pk_add_f32 v[192:193], v[192:193], v[224:225]
  v_pk_add_f32 v[194:195], v[194:195], v[226:227]
  v_cvt_pk_bf16_f32 v192, 0, v192
  v_cvt_pk_bf16_f32 v193, 0, v193
  v_cvt_pk_bf16_f32 v194, 0, v194
  v_cvt_pk_bf16_f32 v195, 0, v195
  v_cvt_pk_bf16_f32 v196, 0, v196
  v_cvt_pk_bf16_f32 v197, 0, v197
  v_cvt_pk_bf16_f32 v198, 0, v198
  v_cvt_pk_bf16_f32 v199, 0, v199
  v_pk_add_f32 v[196:197], v[196:197], v[228:229]
  v_pk_add_f32 v[198:199], v[198:199], v[230:231]
  v_cvt_pk_bf16_f32 v196, 0, v196
  v_cvt_pk_bf16_f32 v197, 0, v197
  v_cvt_pk_bf16_f32 v198, 0, v198
  v_cvt_pk_bf16_f32 v199, 0, v199
  v_cvt_pk_bf16_f32 v200, 0, v200
  v_cvt_pk_bf16_f32 v201, 0, v201
  v_cvt_pk_bf16_f32 v202, 0, v202
  v_cvt_pk_bf16_f32 v203, 0, v203
  v_pk_add_f32 v[200:201], v[200:201], v[232:233]
  v_pk_add_f32 v[202:203], v[202:203], v[234:235]
  v_cvt_pk_bf16_f32 v200, 0, v200
  v_cvt_pk_bf16_f32 v201, 0, v201
  v_cvt_pk_bf16_f32 v202, 0, v202
  v_cvt_pk_bf16_f32 v203, 0, v203
  v_cvt_pk_bf16_f32 v204, 0, v204
  v_cvt_pk_bf16_f32 v205, 0, v205
  v_cvt_pk_bf16_f32 v206, 0, v206
  v_cvt_pk_bf16_f32 v207, 0, v207
  v_pk_add_f32 v[204:205], v[204:205], v[236:237]
  v_pk_add_f32 v[206:207], v[206:207], v[238:239]
  v_cvt_pk_bf16_f32 v204, 0, v204
  v_cvt_pk_bf16_f32 v205, 0, v205
  v_cvt_pk_bf16_f32 v206, 0, v206
  v_cvt_pk_bf16_f32 v207, 0, v207
  s_waitcnt lgkmcnt(0)
  s_barrier
  ds_read_b128 v[52:55], v11 offset:0
  ds_read_b128 v[56:59], v11 offset:1024
  ds_read_b128 v[60:63], v11 offset:2048
  ds_read_b128 v[64:67], v11 offset:3072
  s_waitcnt lgkmcnt(3)
  v_pk_add_f32 v[36:37], v[36:37], v[52:53]
  v_pk_add_f32 v[38:39], v[38:39], v[54:55]
  v_cvt_pk_bf16_f32 v36, 0, v36
  v_cvt_pk_bf16_f32 v37, 0, v37
  v_cvt_pk_bf16_f32 v38, 0, v38
  v_cvt_pk_bf16_f32 v39, 0, v39
  v_pk_add_f32 v[36:37], v[36:37], v[96:97]
  v_pk_add_f32 v[38:39], v[38:39], v[98:99]
  v_cvt_pk_bf16_f32 v36, 0, v36
  v_cvt_pk_bf16_f32 v37, 0, v37
  v_cvt_pk_bf16_f32 v38, 0, v38
  v_cvt_pk_bf16_f32 v39, 0, v39
  v_pk_add_f32 v[36:37], v[36:37], v[192:193]
  v_pk_add_f32 v[38:39], v[38:39], v[194:195]
  v_cvt_pk_bf16_f32 v160, v36, v37
  v_cvt_pk_bf16_f32 v161, v38, v39
  ds_write_b64 v68, v[160:161]
  s_waitcnt lgkmcnt(3)
  v_pk_add_f32 v[40:41], v[40:41], v[56:57]
  v_pk_add_f32 v[42:43], v[42:43], v[58:59]
  v_cvt_pk_bf16_f32 v40, 0, v40
  v_cvt_pk_bf16_f32 v41, 0, v41
  v_cvt_pk_bf16_f32 v42, 0, v42
  v_cvt_pk_bf16_f32 v43, 0, v43
  v_pk_add_f32 v[40:41], v[40:41], v[100:101]
  v_pk_add_f32 v[42:43], v[42:43], v[102:103]
  v_cvt_pk_bf16_f32 v40, 0, v40
  v_cvt_pk_bf16_f32 v41, 0, v41
  v_cvt_pk_bf16_f32 v42, 0, v42
  v_cvt_pk_bf16_f32 v43, 0, v43
  v_pk_add_f32 v[40:41], v[40:41], v[196:197]
  v_pk_add_f32 v[42:43], v[42:43], v[198:199]
  v_cvt_pk_bf16_f32 v162, v40, v41
  v_cvt_pk_bf16_f32 v163, v42, v43
  ds_write_b64 v69, v[162:163]
  s_waitcnt lgkmcnt(3)
  v_pk_add_f32 v[44:45], v[44:45], v[60:61]
  v_pk_add_f32 v[46:47], v[46:47], v[62:63]
  v_cvt_pk_bf16_f32 v44, 0, v44
  v_cvt_pk_bf16_f32 v45, 0, v45
  v_cvt_pk_bf16_f32 v46, 0, v46
  v_cvt_pk_bf16_f32 v47, 0, v47
  v_pk_add_f32 v[44:45], v[44:45], v[104:105]
  v_pk_add_f32 v[46:47], v[46:47], v[106:107]
  v_cvt_pk_bf16_f32 v44, 0, v44
  v_cvt_pk_bf16_f32 v45, 0, v45
  v_cvt_pk_bf16_f32 v46, 0, v46
  v_cvt_pk_bf16_f32 v47, 0, v47
  v_pk_add_f32 v[44:45], v[44:45], v[200:201]
  v_pk_add_f32 v[46:47], v[46:47], v[202:203]
  v_cvt_pk_bf16_f32 v164, v44, v45
  v_cvt_pk_bf16_f32 v165, v46, v47
  ds_write_b64 v70, v[164:165]
  s_waitcnt lgkmcnt(3)
  v_pk_add_f32 v[48:49], v[48:49], v[64:65]
  v_pk_add_f32 v[50:51], v[50:51], v[66:67]
  v_cvt_pk_bf16_f32 v48, 0, v48
  v_cvt_pk_bf16_f32 v49, 0, v49
  v_cvt_pk_bf16_f32 v50, 0, v50
  v_cvt_pk_bf16_f32 v51, 0, v51
  v_pk_add_f32 v[48:49], v[48:49], v[108:109]
  v_pk_add_f32 v[50:51], v[50:51], v[110:111]
  v_cvt_pk_bf16_f32 v48, 0, v48
  v_cvt_pk_bf16_f32 v49, 0, v49
  v_cvt_pk_bf16_f32 v50, 0, v50
  v_cvt_pk_bf16_f32 v51, 0, v51
  v_pk_add_f32 v[48:49], v[48:49], v[204:205]
  v_pk_add_f32 v[50:51], v[50:51], v[206:207]
  v_cvt_pk_bf16_f32 v166, v48, v49
  v_cvt_pk_bf16_f32 v167, v50, v51
  ds_write_b64 v71, v[166:167]
  ds_read_b128 v[168:171], v72
  ds_read_b128 v[172:175], v72 offset:1024
  s_waitcnt lgkmcnt(1)
  buffer_store_dwordx4 v[168:171], v10, s[32:35], 0 offen sc1
  s_waitcnt lgkmcnt(0)
  buffer_store_dwordx4 v[172:175], v10, s[32:35], s68 offen sc1
L1_end:
  s_endpgm
.section .rodata,"a"
.p2align 6
.amdhsa_kernel parallel_sum__linear_kernel_hedgehog__dense_activation_squared_relu__prompt_kernel
  .amdhsa_next_free_vgpr 256
  .amdhsa_next_free_sgpr 102
  .amdhsa_accum_offset 256
  .amdhsa_group_segment_fixed_size 0
  .amdhsa_kernarg_size 96
  .amdhsa_user_sgpr_count 2
  .amdhsa_user_sgpr_kernarg_segment_ptr 1
  .amdhsa_system_sgpr_workgroup_id_x 1
.end_amdhsa_kernel
```
